```python
import torch

def _softmax(x, axis=-1):
    return torch.softmax(x, dim=axis)
def _gelu(x):
    return torch.nn.functional.gelu(x, approximate="tanh")
def _silu(x):
    return torch.nn.functional.silu(x)
def _sigmoid(x):
    return torch.sigmoid(x)
def _layernorm(x, axis=-1, eps=1e-5):
    m = x.mean(dim=axis, keepdim=True)
    v = x.var(dim=axis, keepdim=True, unbiased=False)
    return (x - m) / torch.sqrt(v + eps)
def _scatter_add(tgt, idx, src, axis=0):
    return tgt.clone().index_add_(axis, idx, src)
def _segment_sum(src, seg, n):
    out = torch.zeros((n,) + src.shape[1:], dtype=src.dtype)
    return out.index_add_(0, seg, src)
def _pad(x, pw):
    flat = tuple(v for pair in reversed(pw) for v in pair)
    return torch.nn.functional.pad(x, flat)

kernel_name = 'concat_heads__sliding_local_dilated__compressed_kv_cla__prompt'

def setup_inputs():

    _w = (lambda a: (lambda t: t.to(torch.bfloat16) if t.is_floating_point() else t)(torch.as_tensor(a)))
    def _A_setup():
        B, S, D = 1, 2048, 1024
        return {
            "x": _w((lambda *s: torch.randn(*s, dtype=torch.bfloat16) * 0.2)(B, S, D)),
            "wqkv": _w((lambda *s: torch.randn(*s, dtype=torch.bfloat16) * 0.2)(D, 3 * D)),
            "wo": _w((lambda *s: torch.randn(*s, dtype=torch.bfloat16) * 0.05)(D, D)),
        }
    _A_in = _A_setup()

    def _B_setup():
        B, H, Sq, Sk, D, M = 1, 32, 2048, 2048, 128, 1024
        Dc = 4 * D
        return {
            "x": _w((lambda *s: torch.randn(*s, dtype=torch.bfloat16) * 0.2)(B, Sq, M)),
            "c_kv": _w((lambda *s: torch.randn(*s, dtype=torch.bfloat16) * 1.6)(B, Sk, Dc)),
            "w_q": _w((lambda *s: torch.randn(*s, dtype=torch.bfloat16) * 3.2)(M, H, D) * (M ** -0.5)),
            "w_uk": _w((lambda *s: torch.randn(*s, dtype=torch.bfloat16) * 3.2)(Dc, H, D) * (Dc ** -0.5)),
            "w_uv": _w((lambda *s: torch.randn(*s, dtype=torch.bfloat16) * 1.6)(Dc, H, D) * (Dc ** -0.5)),
            "w_o": _w((lambda *s: torch.randn(*s, dtype=torch.bfloat16) * 1.6)(H, D, M) * ((H * D) ** -0.5)),
        }
    _B_in = _B_setup()

    return {
        "A_x": _A_in["x"],
        "A_wqkv": _A_in["wqkv"],
        "A_wo": _A_in["wo"],
        "B_x": _B_in["x"],
        "B_c_kv": _B_in["c_kv"],
        "B_w_q": _B_in["w_q"],
        "B_w_uk": _B_in["w_uk"],
        "B_w_uv": _B_in["w_uv"],
        "B_w_o": _B_in["w_o"],
    }

def reference(A_x, A_wqkv, A_wo, B_x, B_c_kv, B_w_q, B_w_uk, B_w_uv, B_w_o):
    def _A_ref(x, wqkv, wo):
        B, S, D = x.shape
        H = 32; Dh = D // H
        W, dil = 8, 2
        qkv = (lambda x, *d: x.permute(*d))((x @ wqkv).reshape(B, S, 3, H, Dh), 2, 0, 3, 1, 4)
        q, k, v = qkv[0], qkv[1], qkv[2]
        scale = Dh ** -0.5
        pos = torch.arange(S)
        off = torch.arange(W) * dil
        idx = pos[:, None] - off[None, :]
        mask = idx >= 0
        idx_c = torch.where(mask, idx, 0).reshape(-1)
        kg = k[:, :, idx_c, :].reshape(B, H, S, W, Dh)
        vg = v[:, :, idx_c, :].reshape(B, H, S, W, Dh)
        logits = torch.einsum("bhsd,bhswd->bhsw", q, kg) * scale
        logits = torch.where(mask[None, None, :, :], logits, -1e9)
        attn = _softmax(logits, axis=-1)
        o = torch.einsum("bhsw,bhswd->bhsd", attn, vg)
        return (lambda x, *d: x.permute(*d))(o, 0, 2, 1, 3).reshape(B, S, D) @ wo

    def _B_ref(x, c_kv, w_q, w_uk, w_uv, w_o):
        B, Sq, M = x.shape[0], x.shape[1], x.shape[2]
        Sk = c_kv.shape[1]
        H, D = w_q.shape[1], w_q.shape[2]
        q = torch.einsum("bqm,mhd->bhqd", x, w_q)
        k = torch.einsum("bkc,chd->bhkd", c_kv, w_uk)
        v = torch.einsum("bkc,chd->bhkd", c_kv, w_uv)
        scores = torch.einsum("bhqd,bhkd->bhqk", q, k) * (D ** -0.5)
        off = Sk - Sq
        qi = torch.arange(Sq)[:, None]
        kj = torch.arange(Sk)[None, :]
        cmask = kj <= (qi + off)
        scores = torch.where(cmask[None, None], scores, -1e9)
        p = _softmax(scores, axis=-1)
        ctx = torch.einsum("bhqk,bhkd->bhqd", p, v)
        return torch.einsum("bhqd,hdm->bqm", ctx, w_o)

    a = _A_ref(A_x, A_wqkv, A_wo)
    b = _B_ref(B_x, B_c_kv, B_w_q, B_w_uk, B_w_uv, B_w_o)
    return torch.concatenate([a, b], axis=-1)
```

```asm
; @launch grid=(256,1,1) block=(256,1,1) lds=163840
.amdgcn_target "amdgcn-amd-amdhsa--gfx950"
.text
.globl concat_heads__sliding_local_dilated__compressed_kv_cla__prompt_kernel
.p2align 8
.type concat_heads__sliding_local_dilated__compressed_kv_cla__prompt_kernel,@function
concat_heads__sliding_local_dilated__compressed_kv_cla__prompt_kernel:
    s_cmp_ge_u32 s2, 256
    s_cbranch_scc1 m_end1
    s_load_dwordx16 s[24:39], s[0:1], 0
    s_load_dwordx4 s[4:7], s[0:1], 80
    v_and_b32 v1, 63, v0
    v_lshrrev_b32 v24, 6, v0
    s_nop 0
    v_readfirstlane_b32 s16, v24
    s_lshr_b32 s68, s2, 3
    s_lshr_b32 s57, s16, 1
    s_and_b32 s58, s16, 1
    s_mov_b32 s43, 0x20000
    s_mov_b32 s47, 0x20000
    s_cmp_lt_u32 s68, 28
    s_cbranch_scc1 m_ncp2
    s_sub_u32 s91, s68, 28
    s_lshl_b32 s91, s91, 2
    s_add_u32 s91, s91, s16
    s_getpc_b64 s[8:9]
m_pc3:
    s_sub_u32 s8, s8, m_pc3-concat_heads__sliding_local_dilated__compressed_kv_cla__prompt_kernel
    s_subb_u32 s9, s9, 0
    s_lshl_b32 s90, s91, 13
    v_lshlrev_b32 v24, 7, v1
    v_add_u32 v24, s90, v24
    v_min_u32 v24, concat_heads__sliding_local_dilated__compressed_kv_cla__prompt_kernel_end-concat_heads__sliding_local_dilated__compressed_kv_cla__prompt_kernel-4, v24
    v_mov_b32 v25, s9
    v_add_co_u32 v24, vcc, s8, v24
    s_nop 1
    v_addc_co_u32 v25, vcc, 0, v25, vcc
    global_load_dword v22, v[24:25], off
m_ncp2:
    s_lshl_b32 s61, s16, 13
    s_add_u32 s62, s61, 98304
    s_cmp_ge_u32 s68, 16
    s_cbranch_scc1 m_typea4
    s_and_b32 s69, s68, 3
    s_and_b32 s90, s2, 1
    s_lshl_b32 s90, s90, 2
    s_add_u32 s69, s69, s90
    s_bfe_u32 s90, s2, 0x20001
    s_mul_i32 s90, s90, 4
    s_bfe_u32 s91, s68, 0x20002
    s_add_u32 s90, s90, s91
    s_mov_b32 s76, 8388608
    s_mov_b32 s78, 8192
    s_mov_b32 s81, 0
    s_mov_b32 s73, 4194304
    s_mov_b32 s77, 2048
    s_mov_b32 s82, 16
    s_lshl_b32 s80, s90, 9
    s_lshl_b32 s79, s69, 19
    s_lshl_b32 s88, s90, 4
    s_add_u32 s88, s88, s69
    s_lshl_b32 s88, s88, 3
    s_mov_b32 s83, 0
    s_mov_b32 s84, 1040356334
    s_lshl_b32 s91, s90, 1
    s_add_u32 s91, s91, s58
    s_lshl_b32 s91, s91, 19
    s_lshl_b32 s92, s69, 1
    s_add_u32 s92, s92, s57
    s_lshl_b32 s92, s92, 15
    s_add_u32 s85, s91, s92
    s_add_u32 s85, s85, 0
    s_mov_b32 s86, 1024
    s_mov_b32 s87, 4096
    s_branch m_go15
m_typea4:
    s_bfe_u32 s69, s68, 0x20002
    s_add_u32 s69, s69, 0
    s_and_b32 s90, s2, 7
    s_lshl_b32 s90, s90, 2
    s_and_b32 s91, s68, 3
    s_add_u32 s90, s90, s91
    s_cmp_lt_u32 s90, 16
    s_cselect_b32 s83, 0, 1
    s_mov_b32 s91, 33554432
    s_cselect_b32 s85, 16777216, s91
    s_mov_b32 s91, 8192
    s_cselect_b32 s86, 1024, s91
    s_mov_b32 s91, 1024
    s_cselect_b32 s87, 4096, s91
    s_mov_b32 s73, 2097152
    s_mov_b32 s77, 1024
    s_mov_b32 s82, 8
    s_mov_b32 s81, 0
    s_mov_b32 s76, 4194304
    s_mov_b32 s78, 8192
    s_mov_b32 s84, 0
    s_and_b32 s90, s90, 15
    s_lshl_b32 s80, s90, 9
    s_lshl_b32 s79, s69, 18
    s_lshl_b32 s91, s83, 2
    s_add_u32 s91, s91, s69
    s_cmp_ge_u32 s69, 4
    s_cselect_b32 s92, 508, 8
    s_add_u32 s91, s91, s92
    s_lshl_b32 s88, s90, 4
    s_add_u32 s88, s88, s91
    s_lshl_b32 s88, s88, 3
    s_lshl_b32 s91, s90, 1
    s_add_u32 s91, s91, s58
    s_lshl_b32 s91, s91, 19
    s_lshl_b32 s92, s69, 1
    s_add_u32 s92, s92, s57
    s_lshl_b32 s92, s92, 15
    s_add_u32 s85, s85, s91
    s_add_u32 s85, s85, s92
m_go15:
    s_mov_b32 s42, s73
    s_lshl_b32 s90, s77, 4
    s_lshl_b32 s90, s90, s81
    s_mov_b32 s48, s79
    s_mul_i32 s91, s90, 1
    s_add_u32 s49, s91, s79
    s_sub_u32 s49, s49, 2048
    s_mul_i32 s91, s90, 2
    s_add_u32 s50, s91, s79
    s_mul_i32 s91, s90, 3
    s_add_u32 s51, s91, s79
    s_sub_u32 s51, s51, 2048
    s_lshl_b32 s90, s58, 7
    s_add_u32 s90, s90, s57
    s_lshl_b32 s91, s16, 6
    s_cmp_eq_u32 s81, 1
    s_cselect_b32 s90, s90, s91
    v_lshrrev_b32 v24, 3, v1
    v_lshlrev_b32 v24, s81, v24
    v_add_u32 v24, s90, v24
    v_mul_lo_u32 v24, v24, s77
    v_lshrrev_b32 v25, 4, v1
    v_and_b32 v26, 7, v1
    v_xor_b32 v25, v25, v26
    v_lshl_add_u32 v16, v25, 4, v24
    v_xor_b32 v25, 4, v25
    v_lshl_add_u32 v17, v25, 4, v24
    s_lshl_b32 s90, s77, 3
    s_lshl_b32 s90, s90, s81
    s_sub_u32 s90, s90, 1024
    v_add_u32 v17, s90, v17
    s_mov_b32 s46, s76
    s_mov_b32 s52, s80
    s_lshl_b32 s90, s78, 2
    s_mul_i32 s91, s90, 1
    s_add_u32 s53, s91, s80
    s_sub_u32 s53, s53, 2048
    s_mul_i32 s91, s90, 2
    s_add_u32 s54, s91, s80
    s_mul_i32 s91, s90, 3
    s_add_u32 s55, s91, s80
    s_sub_u32 s55, s55, 2048
    s_lshl_b32 s56, s78, 6
    v_lshrrev_b32 v24, 5, v1
    s_lshl_b32 s90, s16, 4
    v_add_u32 v25, s90, v24
    v_mul_lo_u32 v25, v25, s78
    v_lshlrev_b32 v24, 1, v24
    v_and_b32 v26, 31, v1
    v_xor_b32 v24, v24, v26
    s_lshl_b32 s90, s78, 1
    s_sub_u32 s90, s90, 1024
    v_add_u32 v27, s90, v25
    v_xor_b32 v26, 0, v24
    v_lshl_add_u32 v18, v26, 4, v25
    v_xor_b32 v26, 4, v24
    v_lshl_add_u32 v19, v26, 4, v27
    v_xor_b32 v26, 8, v24
    v_lshl_add_u32 v20, v26, 4, v25
    v_xor_b32 v26, 12, v24
    v_lshl_add_u32 v21, v26, 4, v27
    s_cmp_eq_u32 s83, 0
    s_waitcnt lgkmcnt(0)
    s_cselect_b32 s44, s36, s38
    s_cselect_b32 s45, s37, s39
    s_cmp_lt_u32 s68, 16
    s_cselect_b32 s44, s34, s44
    s_cselect_b32 s45, s35, s45
    s_cselect_b32 s40, s30, s32
    s_cselect_b32 s41, s31, s33
    s_cmp_ge_u32 s68, 28
    s_cselect_b32 s70, 1, 0
    s_cbranch_scc1 m_pf7
m_nopf6:
    s_add_u32 m0, s61, 0
    s_nop 0
    buffer_load_dwordx4 v16, s[40:43], s48 offen offset:0 sc1 lds
    buffer_load_dwordx4 v17, s[40:43], s48 offen offset:1024 sc1 lds
    s_add_u32 s48, s48, 128
    buffer_load_dwordx4 v16, s[40:43], s49 offen offset:2048 sc1 lds
    buffer_load_dwordx4 v17, s[40:43], s49 offen offset:3072 sc1 lds
    s_add_u32 s49, s49, 128
    s_add_u32 m0, s61, 4096
    s_nop 0
    buffer_load_dwordx4 v16, s[40:43], s50 offen offset:0 sc1 lds
    buffer_load_dwordx4 v17, s[40:43], s50 offen offset:1024 sc1 lds
    s_add_u32 s50, s50, 128
    buffer_load_dwordx4 v16, s[40:43], s51 offen offset:2048 sc1 lds
    buffer_load_dwordx4 v17, s[40:43], s51 offen offset:3072 sc1 lds
    s_add_u32 s51, s51, 128
    s_add_u32 s61, s61, 32768
    s_cmp_ge_u32 s61, 98304
    s_cselect_b32 s90, 98304, 0
    s_sub_u32 s61, s61, s90
    s_add_u32 m0, s62, 0
    s_nop 0
    buffer_load_dwordx4 v18, s[44:47], s52 offen offset:0 sc1 lds
    buffer_load_dwordx4 v19, s[44:47], s52 offen offset:1024 sc1 lds
    s_add_u32 s52, s52, s56
    buffer_load_dwordx4 v18, s[44:47], s53 offen offset:2048 sc1 lds
    buffer_load_dwordx4 v19, s[44:47], s53 offen offset:3072 sc1 lds
    s_add_u32 s53, s53, s56
    s_add_u32 m0, s62, 4096
    s_nop 0
    buffer_load_dwordx4 v20, s[44:47], s54 offen offset:0 sc1 lds
    buffer_load_dwordx4 v21, s[44:47], s54 offen offset:1024 sc1 lds
    s_add_u32 s54, s54, s56
    buffer_load_dwordx4 v20, s[44:47], s55 offen offset:2048 sc1 lds
    buffer_load_dwordx4 v21, s[44:47], s55 offen offset:3072 sc1 lds
    s_add_u32 s55, s55, s56
    s_xor_b32 s62, s62, 229376
    s_mov_b32 s95, s82
    s_mov_b32 s96, s83
    s_mov_b32 s97, s84
    s_mov_b32 s98, s85
    s_mov_b32 s99, s86
    s_mov_b32 s100, s87
    s_mov_b32 s101, s88
    v_and_b32 v24, 15, v1
    v_lshrrev_b32 v25, 4, v1
    v_bfe_u32 v26, v1, 1, 3
    v_xor_b32 v26, v26, v25
    s_lshl_b32 s90, s57, 14
    v_lshlrev_b32 v27, 7, v24
    v_add_u32 v27, s90, v27
    v_xor_b32 v28, 0, v26
    v_lshl_add_u32 v6, v28, 4, v27
    v_xor_b32 v28, 4, v26
    v_lshl_add_u32 v7, v28, 4, v27
    v_bfe_u32 v26, v1, 2, 2
    v_lshl_add_u32 v27, v25, 3, v26
    v_lshlrev_b32 v27, 9, v27
    v_and_b32 v28, 3, v1
    v_lshlrev_b32 v28, 3, v28
    v_add_u32 v27, v27, v28
    s_lshl_b32 s90, s58, 8
    s_add_u32 s90, s90, 98304
    v_add_u32 v27, s90, v27
    v_bfe_u32 v26, v1, 2, 3
    v_xor_b32 v28, 0, v26
    v_lshl_add_u32 v8, v28, 5, v27
    v_xor_b32 v28, 1, v26
    v_lshl_add_u32 v9, v28, 5, v27
    v_xor_b32 v28, 2, v26
    v_lshl_add_u32 v10, v28, 5, v27
    v_xor_b32 v28, 3, v26
    v_lshl_add_u32 v11, v28, 5, v27
    v_xor_b32 v28, 4, v26
    v_lshl_add_u32 v12, v28, 5, v27
    v_xor_b32 v28, 5, v26
    v_lshl_add_u32 v13, v28, 5, v27
    v_xor_b32 v28, 6, v26
    v_lshl_add_u32 v14, v28, 5, v27
    v_xor_b32 v28, 7, v26
    v_lshl_add_u32 v15, v28, 5, v27
    v_lshlrev_b32 v2, 4, v1
    s_mov_b32 s64, 0
    s_mov_b32 s59, 32768
    s_mov_b32 s60, 229376
    s_mov_b32 s8, s6
    s_mov_b32 s9, s7
    s_mov_b32 s10, 268435456
    s_mov_b32 s11, 0x20000
    s_cmp_ge_u32 s68, 16
    s_cbranch_scc1 m_typea8
    s_bfe_u32 s69, s68, 0x20002
    s_add_u32 s69, s69, 4
    s_and_b32 s90, s2, 7
    s_lshl_b32 s90, s90, 2
    s_and_b32 s91, s68, 3
    s_add_u32 s90, s90, s91
    s_cmp_lt_u32 s90, 16
    s_cselect_b32 s83, 0, 1
    s_mov_b32 s91, 33554432
    s_cselect_b32 s85, 16777216, s91
    s_mov_b32 s91, 8192
    s_cselect_b32 s86, 1024, s91
    s_mov_b32 s91, 1024
    s_cselect_b32 s87, 4096, s91
    s_cselect_b32 s74, s36, s38
    s_cselect_b32 s75, s37, s39
    s_mov_b32 s71, s32
    s_mov_b32 s72, s33
    s_mov_b32 s73, 2097152
    s_mov_b32 s77, 1024
    s_mov_b32 s82, 8
    s_mov_b32 s81, 0
    s_mov_b32 s76, 4194304
    s_mov_b32 s78, 8192
    s_mov_b32 s84, 0
    s_and_b32 s90, s90, 15
    s_lshl_b32 s80, s90, 9
    s_lshl_b32 s79, s69, 18
    s_lshl_b32 s91, s83, 2
    s_add_u32 s91, s91, s69
    s_cmp_ge_u32 s69, 4
    s_cselect_b32 s92, 508, 8
    s_add_u32 s91, s91, s92
    s_lshl_b32 s88, s90, 4
    s_add_u32 s88, s88, s91
    s_lshl_b32 s88, s88, 3
    s_lshl_b32 s91, s90, 1
    s_add_u32 s91, s91, s58
    s_lshl_b32 s91, s91, 19
    s_lshl_b32 s92, s69, 1
    s_add_u32 s92, s92, s57
    s_lshl_b32 s92, s92, 15
    s_add_u32 s85, s85, s91
    s_add_u32 s85, s85, s92
    s_branch m_go29
m_typea8:
    s_and_b32 s69, s68, 3
    s_and_b32 s90, s2, 1
    s_lshl_b32 s90, s90, 2
    s_add_u32 s69, s69, s90
    s_bfe_u32 s90, s2, 0x20001
    s_mul_i32 s90, s90, 3
    s_bfe_u32 s91, s68, 0x20002
    s_add_u32 s90, s90, s91
    s_mov_b32 s76, 6291456
    s_mov_b32 s78, 6144
    s_mov_b32 s81, 1
    s_mov_b32 s73, 4194304
    s_mov_b32 s77, 2048
    s_mov_b32 s82, 16
    s_lshl_b32 s80, s90, 9
    s_lshl_b32 s79, s69, 19
    s_and_b32 s92, s90, 3
    s_lshr_b32 s91, s90, 2
    s_lshl_b32 s88, s92, 2
    s_add_u32 s88, s88, s91
    s_lshl_b32 s88, s88, 3
    s_add_u32 s88, s88, s69
    s_lshl_b32 s88, s88, 3
    s_add_u32 s88, s88, 6144
    s_cmp_eq_u32 s91, 0
    s_cselect_b32 s84, 1048744942, 0
    s_lshl_b32 s93, s91, 22
    s_add_u32 s85, s93, 50331648
    s_lshl_b32 s92, s92, 1
    s_add_u32 s92, s92, s58
    s_lshl_b32 s92, s92, 19
    s_add_u32 s85, s85, s92
    s_lshl_b32 s92, s57, 3
    s_add_u32 s92, s92, s69
    s_cmp_eq_u32 s91, 2
    s_cselect_b32 s83, 1, 0
    s_cselect_b32 s93, 12, 13
    s_mov_b32 s91, 131072
    s_cselect_b32 s86, 1024, s91
    s_mov_b32 s91, 1024
    s_cselect_b32 s87, 65536, s91
    s_lshl_b32 s92, s92, s93
    s_add_u32 s85, s85, s92
    s_mov_b32 s71, s24
    s_mov_b32 s72, s25
    s_mov_b32 s74, s26
    s_mov_b32 s75, s27
m_go29:
    s_and_b32 s92, s2, 7
    s_lshl_b32 s92, s92, 2
    s_bfe_u32 s93, s2, 0x20003
    s_add_u32 s92, s92, s93
    s_lshr_b32 s93, s2, 5
    s_lshl_b32 s93, s93, 2
    s_or_b32 s93, s93, 0x40000
    s_lshr_b32 s37, s92, 1
    s_lshl_b32 s37, s37, 7
    s_add_u32 s37, s37, 117440512
    s_lshl_b32 s92, s92, 19
    s_lshl_b32 s91, s58, 13
    s_add_u32 s90, s92, s91
    s_cmp_eq_u32 s57, 0
    s_mov_b32 s91, 33538048
    s_cselect_b32 s91, 16777216, s91
    s_add_u32 s32, s90, s91
    s_bfe_u32 s90, 4225674377, s93
    s_lshl_b32 s90, s90, 3
    s_lshl_b32 s91, s16, 1
    s_add_u32 s90, s90, s91
    s_lshl_b32 s90, s90, 12
    s_add_u32 s90, s90, s92
    s_add_u32 s33, s90, 0
    s_add_u32 s34, s90, 4096
    s_bfe_u32 s90, 873484918, s93
    s_lshl_b32 s90, s90, 3
    s_lshl_b32 s91, s16, 1
    s_add_u32 s90, s90, s91
    s_lshl_b32 s90, s90, 12
    s_add_u32 s90, s90, s92
    s_add_u32 s35, s90, 0
    s_add_u32 s36, s90, 4096
    s_bfe_u32 s91, 873484918, s93
    s_lshr_b32 s91, s91, 1
    v_mov_b32 v0, s91
    v_and_b32 v24, 3, v1
    v_min_u32 v24, 2, v24
    v_and_b32 v25, 4, v1
    v_add3_u32 v24, v24, v25, 8
    v_cmp_gt_u32 vcc, 8, v1
    s_nop 1
    v_cndmask_b32 v0, v0, v24, vcc
    s_bfe_u32 s91, 4225674377, s93
    s_lshr_b32 s91, s91, 1
    v_writelane_b32 v0, s91, 8
    v_lshlrev_b32 v0, 3, v0
    s_xor_b32 s94, s70, 1
    s_add_u32 s67, s70, 3
    s_mov_b32 s17, -1
    s_mul_i32 s64, s70, 32768
    v_add_u32 v6, s64, v6
    v_add_u32 v7, s64, v7
    s_mov_b32 s12, s4
    s_mov_b32 s13, s5
    s_mov_b32 s14, 256
    s_mov_b32 s15, 0x20000
    s_lshl_b32 s90, s2, 2
    s_add_u32 s90, s90, s16
    s_cmp_lg_u32 s90, 0
    s_cbranch_scc1 m_tok10
    s_memrealtime s[92:93]
    s_waitcnt lgkmcnt(0)
    s_or_b32 s92, s92, 1
    v_mov_b32 v4, s92
    v_mov_b32 v5, s93
    s_mov_b64 exec, 1
    buffer_store_dwordx2 v[4:5], off, s[12:15], 0 sc1
    s_mov_b64 exec, -1
m_tok10:
    s_cmp_eq_u32 s70, 0
    s_cbranch_scc1 m_tok11
    buffer_load_dwordx2 v[4:5], off, s[12:15], 0 sc1
    s_waitcnt vmcnt(0)
    s_mov_b32 s3, 262144
m_spin12:
    v_readfirstlane_b32 s4, v4
    v_readfirstlane_b32 s5, v5
    s_nop 3
    s_cmp_lg_u32 s4, 0
    s_cbranch_scc1 m_ok13
    s_sub_u32 s3, s3, 1
    s_cbranch_scc1 m_ok13
    s_sleep 32
    buffer_load_dwordx2 v[4:5], off, s[12:15], 0 sc1
    s_waitcnt vmcnt(0)
    s_branch m_spin12
m_ok13:
m_tok11:
    s_add_u32 m0, s61, 0
    s_nop 0
    buffer_load_dwordx4 v16, s[40:43], s48 offen offset:0 sc1 lds
    buffer_load_dwordx4 v17, s[40:43], s48 offen offset:1024 sc1 lds
    s_add_u32 s48, s48, 128
    buffer_load_dwordx4 v16, s[40:43], s49 offen offset:2048 sc1 lds
    buffer_load_dwordx4 v17, s[40:43], s49 offen offset:3072 sc1 lds
    s_add_u32 s49, s49, 128
    s_add_u32 m0, s61, 4096
    s_nop 0
    buffer_load_dwordx4 v16, s[40:43], s50 offen offset:0 sc1 lds
    buffer_load_dwordx4 v17, s[40:43], s50 offen offset:1024 sc1 lds
    s_add_u32 s50, s50, 128
    buffer_load_dwordx4 v16, s[40:43], s51 offen offset:2048 sc1 lds
    buffer_load_dwordx4 v17, s[40:43], s51 offen offset:3072 sc1 lds
    s_add_u32 s51, s51, 128
    s_add_u32 s61, s61, 32768
    s_cmp_ge_u32 s61, 98304
    s_cselect_b32 s90, 98304, 0
    s_sub_u32 s61, s61, s90
    s_add_u32 m0, s62, 0
    s_nop 0
    buffer_load_dwordx4 v18, s[44:47], s52 offen offset:0 sc1 lds
    buffer_load_dwordx4 v19, s[44:47], s52 offen offset:1024 sc1 lds
    s_add_u32 s52, s52, s56
    buffer_load_dwordx4 v18, s[44:47], s53 offen offset:2048 sc1 lds
    buffer_load_dwordx4 v19, s[44:47], s53 offen offset:3072 sc1 lds
    s_add_u32 s53, s53, s56
    s_add_u32 m0, s62, 4096
    s_nop 0
    buffer_load_dwordx4 v20, s[44:47], s54 offen offset:0 sc1 lds
    buffer_load_dwordx4 v21, s[44:47], s54 offen offset:1024 sc1 lds
    s_add_u32 s54, s54, s56
    buffer_load_dwordx4 v20, s[44:47], s55 offen offset:2048 sc1 lds
    buffer_load_dwordx4 v21, s[44:47], s55 offen offset:3072 sc1 lds
    s_add_u32 s55, s55, s56
    s_xor_b32 s62, s62, 229376
    s_waitcnt vmcnt(16)
    s_barrier
    ds_read_b64_tr_b16 a[64:65], v8 offset:0
    ds_read_b64_tr_b16 a[66:67], v8 offset:2048
    ds_read_b64_tr_b16 a[68:69], v8 offset:16384
    ds_read_b64_tr_b16 a[70:71], v8 offset:18432
    ds_read_b64_tr_b16 a[72:73], v9 offset:0
    ds_read_b64_tr_b16 a[74:75], v9 offset:2048
    ds_read_b64_tr_b16 a[76:77], v9 offset:16384
    ds_read_b64_tr_b16 a[78:79], v9 offset:18432
    ds_read_b64_tr_b16 a[80:81], v10 offset:0
    ds_read_b64_tr_b16 a[82:83], v10 offset:2048
    ds_read_b64_tr_b16 a[84:85], v10 offset:16384
    ds_read_b64_tr_b16 a[86:87], v10 offset:18432
    ds_read_b64_tr_b16 a[88:89], v11 offset:0
    ds_read_b64_tr_b16 a[90:91], v11 offset:2048
    ds_read_b64_tr_b16 a[92:93], v11 offset:16384
    ds_read_b64_tr_b16 a[94:95], v11 offset:18432
    ds_read_b64_tr_b16 a[96:97], v12 offset:0
    ds_read_b128 a[0:3], v6 offset:0
    ds_read_b128 a[4:7], v7 offset:0
    ds_read_b64_tr_b16 a[98:99], v12 offset:2048
    ds_read_b128 a[8:11], v6 offset:2048
    ds_read_b128 a[12:15], v7 offset:2048
    ds_read_b64_tr_b16 a[100:101], v12 offset:16384
    ds_read_b128 a[16:19], v6 offset:4096
    ds_read_b128 a[20:23], v7 offset:4096
    ds_read_b64_tr_b16 a[102:103], v12 offset:18432
    ds_read_b128 a[24:27], v6 offset:6144
    ds_read_b128 a[28:31], v7 offset:6144
    ds_read_b64_tr_b16 a[104:105], v13 offset:0
    ds_read_b128 a[32:35], v6 offset:8192
    ds_read_b128 a[36:39], v7 offset:8192
    ds_read_b64_tr_b16 a[106:107], v13 offset:2048
    ds_read_b128 a[40:43], v6 offset:10240
    ds_read_b128 a[44:47], v7 offset:10240
    ds_read_b64_tr_b16 a[108:109], v13 offset:16384
    ds_read_b128 a[48:51], v6 offset:12288
    ds_read_b128 a[52:55], v7 offset:12288
    ds_read_b64_tr_b16 a[110:111], v13 offset:18432
    ds_read_b128 a[56:59], v6 offset:14336
    ds_read_b128 a[60:63], v7 offset:14336
    s_add_u32 m0, s61, 0
    s_nop 0
    buffer_load_dwordx4 v16, s[40:43], s48 offen offset:0 sc1 lds
    buffer_load_dwordx4 v17, s[40:43], s48 offen offset:1024 sc1 lds
    s_add_u32 s48, s48, 128
    buffer_load_dwordx4 v16, s[40:43], s49 offen offset:2048 sc1 lds
    buffer_load_dwordx4 v17, s[40:43], s49 offen offset:3072 sc1 lds
    s_add_u32 s49, s49, 128
    s_add_u32 m0, s61, 4096
    s_nop 0
    buffer_load_dwordx4 v16, s[40:43], s50 offen offset:0 sc1 lds
    buffer_load_dwordx4 v17, s[40:43], s50 offen offset:1024 sc1 lds
    s_add_u32 s50, s50, 128
    buffer_load_dwordx4 v16, s[40:43], s51 offen offset:2048 sc1 lds
    buffer_load_dwordx4 v17, s[40:43], s51 offen offset:3072 sc1 lds
    s_add_u32 s51, s51, 128
    s_add_u32 s61, s61, 32768
    s_cmp_ge_u32 s61, 98304
    s_cselect_b32 s90, 98304, 0
    s_sub_u32 s61, s61, s90
    s_mov_b32 s66, 1
    s_mov_b32 s24, s6
    s_mov_b32 s25, s7
    s_mov_b32 s26, 0
    s_mov_b32 s27, 0x20000
    s_mov_b32 s28, 0
    s_mov_b32 s29, 0
    s_mov_b32 s30, 0
    s_mov_b32 s31, 0
m_tile14:
    s_mov_b32 s65, s95
    s_cmp_eq_u32 s96, 1
    s_cbranch_scc1 m_swp16
    s_waitcnt lgkmcnt(15)
    v_mfma_f32_16x16x32_bf16 v[32:35], a[64:67], a[0:3], 0
    ds_read_b64_tr_b16 a[112:113], v14 offset:0
    v_mfma_f32_16x16x32_bf16 v[32:35], a[68:71], a[4:7], v[32:35]
    ds_read_b64_tr_b16 a[114:115], v14 offset:2048
    v_mfma_f32_16x16x32_bf16 v[36:39], a[76:79], a[4:7], 0
    ds_read_b64_tr_b16 a[116:117], v14 offset:16384
    v_mfma_f32_16x16x32_bf16 v[36:39], a[72:75], a[0:3], v[36:39]
    ds_read_b64_tr_b16 a[118:119], v14 offset:18432
    v_mfma_f32_16x16x32_bf16 v[44:47], a[72:75], a[8:11], 0
    ds_read_b64_tr_b16 a[120:121], v15 offset:0
    v_mfma_f32_16x16x32_bf16 v[44:47], a[76:79], a[12:15], v[44:47]
    ds_read_b64_tr_b16 a[122:123], v15 offset:2048
    v_mfma_f32_16x16x32_bf16 v[40:43], a[68:71], a[12:15], 0
    ds_read_b64_tr_b16 a[124:125], v15 offset:16384
    v_mfma_f32_16x16x32_bf16 v[40:43], a[64:67], a[8:11], v[40:43]
    ds_read_b64_tr_b16 a[126:127], v15 offset:18432
    v_mfma_f32_16x16x32_bf16 v[48:51], a[64:67], a[16:19], 0
    v_mfma_f32_16x16x32_bf16 v[48:51], a[68:71], a[20:23], v[48:51]
    v_mfma_f32_16x16x32_bf16 v[52:55], a[76:79], a[20:23], 0
    buffer_store_dwordx4 a[128:131], v2, s[24:27], s28 offen sc1
    v_mfma_f32_16x16x32_bf16 v[52:55], a[72:75], a[16:19], v[52:55]
    s_add_u32 s28, s28, s31
    s_waitcnt lgkmcnt(15)
    v_mfma_f32_16x16x32_bf16 v[60:63], a[72:75], a[24:27], 0
    v_xor_b32 v8, s60, v8
    v_xor_b32 v9, s60, v9
    v_mfma_f32_16x16x32_bf16 v[60:63], a[76:79], a[28:31], v[60:63]
    v_xor_b32 v10, s60, v10
    v_xor_b32 v11, s60, v11
    v_mfma_f32_16x16x32_bf16 v[56:59], a[68:71], a[28:31], 0
    v_xor_b32 v12, s60, v12
    v_xor_b32 v13, s60, v13
    v_mfma_f32_16x16x32_bf16 v[56:59], a[64:67], a[24:27], v[56:59]
    v_xor_b32 v14, s60, v14
    v_xor_b32 v15, s60, v15
    v_mfma_f32_16x16x32_bf16 v[64:67], a[64:67], a[32:35], 0
    buffer_store_dwordx4 a[132:135], v2, s[24:27], s28 offen sc1
    v_mfma_f32_16x16x32_bf16 v[64:67], a[68:71], a[36:39], v[64:67]
    s_add_u32 s28, s28, s31
    v_mfma_f32_16x16x32_bf16 v[68:71], a[76:79], a[36:39], 0
    v_mfma_f32_16x16x32_bf16 v[68:71], a[72:75], a[32:35], v[68:71]
    s_waitcnt lgkmcnt(14)
    v_mfma_f32_16x16x32_bf16 v[76:79], a[72:75], a[40:43], 0
    v_mfma_f32_16x16x32_bf16 v[76:79], a[76:79], a[44:47], v[76:79]
    v_mfma_f32_16x16x32_bf16 v[72:75], a[68:71], a[44:47], 0
    buffer_store_dwordx4 a[136:139], v2, s[24:27], s28 offen sc1
    v_mfma_f32_16x16x32_bf16 v[72:75], a[64:67], a[40:43], v[72:75]
    s_add_u32 s28, s28, s31
    s_waitcnt lgkmcnt(11)
    v_mfma_f32_16x16x32_bf16 v[80:83], a[64:67], a[48:51], 0
    v_mfma_f32_16x16x32_bf16 v[80:83], a[68:71], a[52:55], v[80:83]
    v_mfma_f32_16x16x32_bf16 v[84:87], a[76:79], a[52:55], 0
    v_mfma_f32_16x16x32_bf16 v[84:87], a[72:75], a[48:51], v[84:87]
    s_waitcnt lgkmcnt(8)
    v_mfma_f32_16x16x32_bf16 v[92:95], a[72:75], a[56:59], 0
    buffer_store_dwordx4 a[140:143], v2, s[24:27], s28 offen sc1
    v_mfma_f32_16x16x32_bf16 v[92:95], a[76:79], a[60:63], v[92:95]
    s_add_u32 s28, s28, s31
    v_mfma_f32_16x16x32_bf16 v[88:91], a[68:71], a[60:63], 0
    s_waitcnt vmcnt(44) lgkmcnt(0)
    s_cmp_eq_u32 s66, 2
    s_cbranch_scc1 m_w17
    s_waitcnt vmcnt(12)
m_w17:
    v_mfma_f32_16x16x32_bf16 v[88:91], a[64:67], a[56:59], v[88:91]
    s_barrier
    v_mfma_f32_16x16x32_bf16 v[96:99], a[80:83], a[0:3], 0
    ds_read_b64_tr_b16 a[64:65], v8 offset:0
    v_mfma_f32_16x16x32_bf16 v[96:99], a[84:87], a[4:7], v[96:99]
    s_add_u32 m0, s62, 0
    v_mfma_f32_16x16x32_bf16 v[100:103], a[92:95], a[4:7], 0
    buffer_load_dwordx4 v18, s[44:47], s52 offen offset:0 sc1 lds
    v_mfma_f32_16x16x32_bf16 v[100:103], a[88:91], a[0:3], v[100:103]
    ds_read_b64_tr_b16 a[66:67], v8 offset:2048
    v_mfma_f32_16x16x32_bf16 v[108:111], a[88:91], a[8:11], 0
    s_add_u32 s64, s64, 32768
    v_mfma_f32_16x16x32_bf16 v[108:111], a[92:95], a[12:15], v[108:111]
    s_cmp_ge_u32 s64, 98304
    s_cselect_b32 s63, 4294901760, s59
    s_cselect_b32 s64, 0, s64
    v_mfma_f32_16x16x32_bf16 v[104:107], a[84:87], a[12:15], 0
    buffer_load_dwordx4 v19, s[44:47], s52 offen offset:1024 sc1 lds
    v_mfma_f32_16x16x32_bf16 v[104:107], a[80:83], a[8:11], v[104:107]
    s_add_u32 s52, s52, s56
    ds_read_b64_tr_b16 a[68:69], v8 offset:16384
    v_mfma_f32_16x16x32_bf16 v[112:115], a[80:83], a[16:19], 0
    v_mfma_f32_16x16x32_bf16 v[112:115], a[84:87], a[20:23], v[112:115]
    v_mfma_f32_16x16x32_bf16 v[116:119], a[92:95], a[20:23], 0
    buffer_load_dwordx4 v18, s[44:47], s53 offen offset:2048 sc1 lds
    v_mfma_f32_16x16x32_bf16 v[116:119], a[88:91], a[16:19], v[116:119]
    ds_read_b64_tr_b16 a[70:71], v8 offset:18432
    v_mfma_f32_16x16x32_bf16 v[124:127], a[88:91], a[24:27], 0
    v_mfma_f32_16x16x32_bf16 v[124:127], a[92:95], a[28:31], v[124:127]
    v_mfma_f32_16x16x32_bf16 v[120:123], a[84:87], a[28:31], 0
    buffer_load_dwordx4 v19, s[44:47], s53 offen offset:3072 sc1 lds
    v_mfma_f32_16x16x32_bf16 v[120:123], a[80:83], a[24:27], v[120:123]
    s_add_u32 s53, s53, s56
    ds_read_b64_tr_b16 a[72:73], v9 offset:0
    v_mfma_f32_16x16x32_bf16 v[128:131], a[80:83], a[32:35], 0
    v_mfma_f32_16x16x32_bf16 v[128:131], a[84:87], a[36:39], v[128:131]
    s_add_u32 m0, s62, 4096
    v_mfma_f32_16x16x32_bf16 v[132:135], a[92:95], a[36:39], 0
    buffer_load_dwordx4 v20, s[44:47], s54 offen offset:0 sc1 lds
    v_mfma_f32_16x16x32_bf16 v[132:135], a[88:91], a[32:35], v[132:135]
    s_xor_b32 s62, s62, 229376
    ds_read_b64_tr_b16 a[74:75], v9 offset:2048
    v_mfma_f32_16x16x32_bf16 v[140:143], a[88:91], a[40:43], 0
    v_mfma_f32_16x16x32_bf16 v[140:143], a[92:95], a[44:47], v[140:143]
    v_mfma_f32_16x16x32_bf16 v[136:139], a[84:87], a[44:47], 0
    buffer_load_dwordx4 v21, s[44:47], s54 offen offset:1024 sc1 lds
    v_mfma_f32_16x16x32_bf16 v[136:139], a[80:83], a[40:43], v[136:139]
    s_add_u32 s54, s54, s56
    ds_read_b64_tr_b16 a[76:77], v9 offset:16384
    v_mfma_f32_16x16x32_bf16 v[144:147], a[80:83], a[48:51], 0
    v_mfma_f32_16x16x32_bf16 v[144:147], a[84:87], a[52:55], v[144:147]
    v_mfma_f32_16x16x32_bf16 v[148:151], a[92:95], a[52:55], 0
    buffer_load_dwordx4 v20, s[44:47], s55 offen offset:2048 sc1 lds
    v_mfma_f32_16x16x32_bf16 v[148:151], a[88:91], a[48:51], v[148:151]
    ds_read_b64_tr_b16 a[78:79], v9 offset:18432
    v_mfma_f32_16x16x32_bf16 v[156:159], a[88:91], a[56:59], 0
    v_add_u32 v6, s63, v6
    v_add_u32 v7, s63, v7
    v_mfma_f32_16x16x32_bf16 v[156:159], a[92:95], a[60:63], v[156:159]
    v_mfma_f32_16x16x32_bf16 v[152:155], a[84:87], a[60:63], 0
    buffer_load_dwordx4 v21, s[44:47], s55 offen offset:3072 sc1 lds
    v_mfma_f32_16x16x32_bf16 v[152:155], a[80:83], a[56:59], v[152:155]
    s_add_u32 s55, s55, s56
    v_mfma_f32_16x16x32_bf16 v[160:163], a[96:99], a[0:3], 0
    ds_read_b64_tr_b16 a[80:81], v10 offset:0
    v_mfma_f32_16x16x32_bf16 v[160:163], a[100:103], a[4:7], v[160:163]
    v_mfma_f32_16x16x32_bf16 v[164:167], a[108:111], a[4:7], 0
    v_mfma_f32_16x16x32_bf16 v[164:167], a[104:107], a[0:3], v[164:167]
    s_add_u32 m0, s61, 0
    ds_read_b64_tr_b16 a[82:83], v10 offset:2048
    v_mfma_f32_16x16x32_bf16 v[172:175], a[104:107], a[8:11], 0
    buffer_load_dwordx4 v16, s[40:43], s48 offen offset:0 sc1 lds
    v_mfma_f32_16x16x32_bf16 v[172:175], a[108:111], a[12:15], v[172:175]
    v_mfma_f32_16x16x32_bf16 v[168:171], a[100:103], a[12:15], 0
    ds_read_b64_tr_b16 a[84:85], v10 offset:16384
    v_mfma_f32_16x16x32_bf16 v[168:171], a[96:99], a[8:11], v[168:171]
    v_mfma_f32_16x16x32_bf16 v[176:179], a[96:99], a[16:19], 0
    buffer_store_dwordx4 a[144:147], v2, s[24:27], s28 offen sc1
    v_mfma_f32_16x16x32_bf16 v[176:179], a[100:103], a[20:23], v[176:179]
    s_add_u32 s28, s28, s31
    ds_read_b64_tr_b16 a[86:87], v10 offset:18432
    v_mfma_f32_16x16x32_bf16 v[180:183], a[108:111], a[20:23], 0
    v_mfma_f32_16x16x32_bf16 v[180:183], a[104:107], a[16:19], v[180:183]
    v_mfma_f32_16x16x32_bf16 v[188:191], a[104:107], a[24:27], 0
    buffer_load_dwordx4 v17, s[40:43], s48 offen offset:1024 sc1 lds
    v_mfma_f32_16x16x32_bf16 v[188:191], a[108:111], a[28:31], v[188:191]
    s_add_u32 s48, s48, 128
    ds_read_b64_tr_b16 a[88:89], v11 offset:0
    v_mfma_f32_16x16x32_bf16 v[184:187], a[100:103], a[28:31], 0
    v_mfma_f32_16x16x32_bf16 v[184:187], a[96:99], a[24:27], v[184:187]
    v_mfma_f32_16x16x32_bf16 v[192:195], a[96:99], a[32:35], 0
    buffer_store_dwordx4 a[148:151], v2, s[24:27], s28 offen sc1
    v_mfma_f32_16x16x32_bf16 v[192:195], a[100:103], a[36:39], v[192:195]
    s_add_u32 s28, s28, s31
    ds_read_b64_tr_b16 a[90:91], v11 offset:2048
    v_mfma_f32_16x16x32_bf16 v[196:199], a[108:111], a[36:39], 0
    v_mfma_f32_16x16x32_bf16 v[196:199], a[104:107], a[32:35], v[196:199]
    v_mfma_f32_16x16x32_bf16 v[204:207], a[104:107], a[40:43], 0
    buffer_load_dwordx4 v16, s[40:43], s49 offen offset:2048 sc1 lds
    v_mfma_f32_16x16x32_bf16 v[204:207], a[108:111], a[44:47], v[204:207]
    ds_read_b64_tr_b16 a[92:93], v11 offset:16384
    v_mfma_f32_16x16x32_bf16 v[200:203], a[100:103], a[44:47], 0
    v_mfma_f32_16x16x32_bf16 v[200:203], a[96:99], a[40:43], v[200:203]
    v_mfma_f32_16x16x32_bf16 v[208:211], a[96:99], a[48:51], 0
    buffer_store_dwordx4 a[152:155], v2, s[24:27], s28 offen sc1
    v_mfma_f32_16x16x32_bf16 v[208:211], a[100:103], a[52:55], v[208:211]
    s_add_u32 s28, s28, s31
    ds_read_b64_tr_b16 a[94:95], v11 offset:18432
    v_mfma_f32_16x16x32_bf16 v[212:215], a[108:111], a[52:55], 0
    v_mfma_f32_16x16x32_bf16 v[212:215], a[104:107], a[48:51], v[212:215]
    v_mfma_f32_16x16x32_bf16 v[220:223], a[104:107], a[56:59], 0
    buffer_load_dwordx4 v17, s[40:43], s49 offen offset:3072 sc1 lds
    v_mfma_f32_16x16x32_bf16 v[220:223], a[108:111], a[60:63], v[220:223]
    s_add_u32 s49, s49, 128
    v_mfma_f32_16x16x32_bf16 v[216:219], a[100:103], a[60:63], 0
    buffer_store_dwordx4 a[156:159], v2, s[24:27], s28 offen sc1
    v_mfma_f32_16x16x32_bf16 v[216:219], a[96:99], a[56:59], v[216:219]
    s_add_u32 s29, s29, s30
    s_mov_b32 s28, s29
    v_mfma_f32_16x16x32_bf16 v[224:227], a[112:115], a[0:3], 0
    v_mfma_f32_16x16x32_bf16 v[224:227], a[116:119], a[4:7], v[224:227]
    ds_read_b64_tr_b16 a[96:97], v12 offset:0
    v_mfma_f32_16x16x32_bf16 v[228:231], a[124:127], a[4:7], 0
    v_mfma_f32_16x16x32_bf16 v[228:231], a[120:123], a[0:3], v[228:231]
    s_add_u32 m0, s61, 4096
    ds_read_b128 a[0:3], v6 offset:0
    v_mfma_f32_16x16x32_bf16 v[236:239], a[120:123], a[8:11], 0
    buffer_load_dwordx4 v16, s[40:43], s50 offen offset:0 sc1 lds
    v_mfma_f32_16x16x32_bf16 v[236:239], a[124:127], a[12:15], v[236:239]
    s_add_u32 s61, s61, 32768
    ds_read_b128 a[4:7], v7 offset:0
    v_mfma_f32_16x16x32_bf16 v[232:235], a[116:119], a[12:15], 0
    s_cmp_ge_u32 s61, 98304
    s_cselect_b32 s90, 98304, 0
    ds_read_b64_tr_b16 a[98:99], v12 offset:2048
    v_mfma_f32_16x16x32_bf16 v[232:235], a[112:115], a[8:11], v[232:235]
    s_sub_u32 s61, s61, s90
    ds_read_b128 a[8:11], v6 offset:2048
    v_mfma_f32_16x16x32_bf16 v[240:243], a[112:115], a[16:19], 0
    ds_read_b128 a[12:15], v7 offset:2048
    v_mfma_f32_16x16x32_bf16 v[240:243], a[116:119], a[20:23], v[240:243]
    ds_read_b64_tr_b16 a[100:101], v12 offset:16384
    v_mfma_f32_16x16x32_bf16 v[244:247], a[124:127], a[20:23], 0
    v_mfma_f32_16x16x32_bf16 v[244:247], a[120:123], a[16:19], v[244:247]
    ds_read_b128 a[16:19], v6 offset:4096
    v_mfma_f32_16x16x32_bf16 v[252:255], a[120:123], a[24:27], 0
    buffer_load_dwordx4 v17, s[40:43], s50 offen offset:1024 sc1 lds
    v_mfma_f32_16x16x32_bf16 v[252:255], a[124:127], a[28:31], v[252:255]
    s_add_u32 s50, s50, 128
    ds_read_b128 a[20:23], v7 offset:4096
    v_mfma_f32_16x16x32_bf16 v[248:251], a[116:119], a[28:31], 0
    ds_read_b64_tr_b16 a[102:103], v12 offset:18432
    v_mfma_f32_16x16x32_bf16 v[248:251], a[112:115], a[24:27], v[248:251]
    ds_read_b128 a[24:27], v6 offset:6144
    v_mfma_f32_16x16x32_bf16 a[224:227], a[112:115], a[32:35], 0
    s_sub_u32 s65, s65, 1
    ds_read_b128 a[28:31], v7 offset:6144
    v_mfma_f32_16x16x32_bf16 a[224:227], a[116:119], a[36:39], a[224:227]
    ds_read_b64_tr_b16 a[104:105], v13 offset:0
    v_mfma_f32_16x16x32_bf16 a[228:231], a[124:127], a[36:39], 0
    v_mfma_f32_16x16x32_bf16 a[228:231], a[120:123], a[32:35], a[228:231]
    ds_read_b128 a[32:35], v6 offset:8192
    v_mfma_f32_16x16x32_bf16 a[236:239], a[120:123], a[40:43], 0
    buffer_load_dwordx4 v16, s[40:43], s51 offen offset:2048 sc1 lds
    v_mfma_f32_16x16x32_bf16 a[236:239], a[124:127], a[44:47], a[236:239]
    ds_read_b128 a[36:39], v7 offset:8192
    v_mfma_f32_16x16x32_bf16 a[232:235], a[116:119], a[44:47], 0
    ds_read_b64_tr_b16 a[106:107], v13 offset:2048
    v_mfma_f32_16x16x32_bf16 a[232:235], a[112:115], a[40:43], a[232:235]
    ds_read_b128 a[40:43], v6 offset:10240
    v_mfma_f32_16x16x32_bf16 a[240:243], a[112:115], a[48:51], 0
    ds_read_b128 a[44:47], v7 offset:10240
    v_mfma_f32_16x16x32_bf16 a[240:243], a[116:119], a[52:55], a[240:243]
    ds_read_b64_tr_b16 a[108:109], v13 offset:16384
    v_mfma_f32_16x16x32_bf16 a[244:247], a[124:127], a[52:55], 0
    v_mfma_f32_16x16x32_bf16 a[244:247], a[120:123], a[48:51], a[244:247]
    ds_read_b128 a[48:51], v6 offset:12288
    v_mfma_f32_16x16x32_bf16 a[252:255], a[120:123], a[56:59], 0
    buffer_load_dwordx4 v17, s[40:43], s51 offen offset:3072 sc1 lds
    v_mfma_f32_16x16x32_bf16 a[252:255], a[124:127], a[60:63], a[252:255]
    s_add_u32 s51, s51, 128
    ds_read_b128 a[52:55], v7 offset:12288
    v_mfma_f32_16x16x32_bf16 a[248:251], a[116:119], a[60:63], 0
    ds_read_b64_tr_b16 a[110:111], v13 offset:18432
    v_mfma_f32_16x16x32_bf16 a[248:251], a[112:115], a[56:59], a[248:251]
    ds_read_b128 a[56:59], v6 offset:14336
    ds_read_b128 a[60:63], v7 offset:14336
    s_waitcnt lgkmcnt(15)
    v_mfma_f32_16x16x32_bf16 v[32:35], a[64:67], a[0:3], v[32:35]
    ds_read_b64_tr_b16 a[112:113], v14 offset:0
    v_mfma_f32_16x16x32_bf16 v[32:35], a[68:71], a[4:7], v[32:35]
    ds_read_b64_tr_b16 a[114:115], v14 offset:2048
    v_mfma_f32_16x16x32_bf16 v[36:39], a[76:79], a[4:7], v[36:39]
    ds_read_b64_tr_b16 a[116:117], v14 offset:16384
    v_mfma_f32_16x16x32_bf16 v[36:39], a[72:75], a[0:3], v[36:39]
    ds_read_b64_tr_b16 a[118:119], v14 offset:18432
    v_mfma_f32_16x16x32_bf16 v[44:47], a[72:75], a[8:11], v[44:47]
    ds_read_b64_tr_b16 a[120:121], v15 offset:0
    v_mfma_f32_16x16x32_bf16 v[44:47], a[76:79], a[12:15], v[44:47]
    ds_read_b64_tr_b16 a[122:123], v15 offset:2048
    v_mfma_f32_16x16x32_bf16 v[40:43], a[68:71], a[12:15], v[40:43]
    ds_read_b64_tr_b16 a[124:125], v15 offset:16384
    v_mfma_f32_16x16x32_bf16 v[40:43], a[64:67], a[8:11], v[40:43]
    ds_read_b64_tr_b16 a[126:127], v15 offset:18432
    v_mfma_f32_16x16x32_bf16 v[48:51], a[64:67], a[16:19], v[48:51]
    v_mfma_f32_16x16x32_bf16 v[48:51], a[68:71], a[20:23], v[48:51]
    v_mfma_f32_16x16x32_bf16 v[52:55], a[76:79], a[20:23], v[52:55]
    buffer_store_dwordx4 a[160:163], v2, s[24:27], s28 offen sc1
    v_mfma_f32_16x16x32_bf16 v[52:55], a[72:75], a[16:19], v[52:55]
    s_add_u32 s28, s28, s31
    s_waitcnt lgkmcnt(15)
    v_mfma_f32_16x16x32_bf16 v[60:63], a[72:75], a[24:27], v[60:63]
    v_xor_b32 v8, s60, v8
    v_xor_b32 v9, s60, v9
    v_mfma_f32_16x16x32_bf16 v[60:63], a[76:79], a[28:31], v[60:63]
    v_xor_b32 v10, s60, v10
    v_xor_b32 v11, s60, v11
    v_mfma_f32_16x16x32_bf16 v[56:59], a[68:71], a[28:31], v[56:59]
    v_xor_b32 v12, s60, v12
    v_xor_b32 v13, s60, v13
    v_mfma_f32_16x16x32_bf16 v[56:59], a[64:67], a[24:27], v[56:59]
    v_xor_b32 v14, s60, v14
    v_xor_b32 v15, s60, v15
    v_mfma_f32_16x16x32_bf16 v[64:67], a[64:67], a[32:35], v[64:67]
    buffer_store_dwordx4 a[164:167], v2, s[24:27], s28 offen sc1
    v_mfma_f32_16x16x32_bf16 v[64:67], a[68:71], a[36:39], v[64:67]
    s_add_u32 s28, s28, s31
    v_mfma_f32_16x16x32_bf16 v[68:71], a[76:79], a[36:39], v[68:71]
    v_mfma_f32_16x16x32_bf16 v[68:71], a[72:75], a[32:35], v[68:71]
    s_waitcnt lgkmcnt(14)
    v_mfma_f32_16x16x32_bf16 v[76:79], a[72:75], a[40:43], v[76:79]
    v_mfma_f32_16x16x32_bf16 v[76:79], a[76:79], a[44:47], v[76:79]
    v_mfma_f32_16x16x32_bf16 v[72:75], a[68:71], a[44:47], v[72:75]
    buffer_store_dwordx4 a[168:171], v2, s[24:27], s28 offen sc1
    v_mfma_f32_16x16x32_bf16 v[72:75], a[64:67], a[40:43], v[72:75]
    s_add_u32 s28, s28, s31
    s_waitcnt lgkmcnt(11)
    v_mfma_f32_16x16x32_bf16 v[80:83], a[64:67], a[48:51], v[80:83]
    v_mfma_f32_16x16x32_bf16 v[80:83], a[68:71], a[52:55], v[80:83]
    v_mfma_f32_16x16x32_bf16 v[84:87], a[76:79], a[52:55], v[84:87]
    v_mfma_f32_16x16x32_bf16 v[84:87], a[72:75], a[48:51], v[84:87]
    s_waitcnt lgkmcnt(8)
    v_mfma_f32_16x16x32_bf16 v[92:95], a[72:75], a[56:59], v[92:95]
    buffer_store_dwordx4 a[172:175], v2, s[24:27], s28 offen sc1
    v_mfma_f32_16x16x32_bf16 v[92:95], a[76:79], a[60:63], v[92:95]
    s_add_u32 s28, s28, s31
    v_mfma_f32_16x16x32_bf16 v[88:91], a[68:71], a[60:63], v[88:91]
    s_waitcnt vmcnt(16) lgkmcnt(0)
    v_mfma_f32_16x16x32_bf16 v[88:91], a[64:67], a[56:59], v[88:91]
    s_barrier
    v_mfma_f32_16x16x32_bf16 v[96:99], a[80:83], a[0:3], v[96:99]
    ds_read_b64_tr_b16 a[64:65], v8 offset:0
    v_mfma_f32_16x16x32_bf16 v[96:99], a[84:87], a[4:7], v[96:99]
    s_add_u32 m0, s62, 0
    v_mfma_f32_16x16x32_bf16 v[100:103], a[92:95], a[4:7], v[100:103]
    buffer_load_dwordx4 v18, s[44:47], s52 offen offset:0 sc1 lds
    v_mfma_f32_16x16x32_bf16 v[100:103], a[88:91], a[0:3], v[100:103]
    ds_read_b64_tr_b16 a[66:67], v8 offset:2048
    v_mfma_f32_16x16x32_bf16 v[108:111], a[88:91], a[8:11], v[108:111]
    s_add_u32 s64, s64, 32768
    v_mfma_f32_16x16x32_bf16 v[108:111], a[92:95], a[12:15], v[108:111]
    s_cmp_ge_u32 s64, 98304
    s_cselect_b32 s63, 4294901760, s59
    s_cselect_b32 s64, 0, s64
    v_mfma_f32_16x16x32_bf16 v[104:107], a[84:87], a[12:15], v[104:107]
    buffer_load_dwordx4 v19, s[44:47], s52 offen offset:1024 sc1 lds
    v_mfma_f32_16x16x32_bf16 v[104:107], a[80:83], a[8:11], v[104:107]
    s_add_u32 s52, s52, s56
    ds_read_b64_tr_b16 a[68:69], v8 offset:16384
    v_mfma_f32_16x16x32_bf16 v[112:115], a[80:83], a[16:19], v[112:115]
    v_mfma_f32_16x16x32_bf16 v[112:115], a[84:87], a[20:23], v[112:115]
    v_mfma_f32_16x16x32_bf16 v[116:119], a[92:95], a[20:23], v[116:119]
    buffer_load_dwordx4 v18, s[44:47], s53 offen offset:2048 sc1 lds
    v_mfma_f32_16x16x32_bf16 v[116:119], a[88:91], a[16:19], v[116:119]
    ds_read_b64_tr_b16 a[70:71], v8 offset:18432
    v_mfma_f32_16x16x32_bf16 v[124:127], a[88:91], a[24:27], v[124:127]
    v_mfma_f32_16x16x32_bf16 v[124:127], a[92:95], a[28:31], v[124:127]
    v_mfma_f32_16x16x32_bf16 v[120:123], a[84:87], a[28:31], v[120:123]
    buffer_load_dwordx4 v19, s[44:47], s53 offen offset:3072 sc1 lds
    v_mfma_f32_16x16x32_bf16 v[120:123], a[80:83], a[24:27], v[120:123]
    s_add_u32 s53, s53, s56
    ds_read_b64_tr_b16 a[72:73], v9 offset:0
    v_mfma_f32_16x16x32_bf16 v[128:131], a[80:83], a[32:35], v[128:131]
    v_mfma_f32_16x16x32_bf16 v[128:131], a[84:87], a[36:39], v[128:131]
    s_add_u32 m0, s62, 4096
    v_mfma_f32_16x16x32_bf16 v[132:135], a[92:95], a[36:39], v[132:135]
    buffer_load_dwordx4 v20, s[44:47], s54 offen offset:0 sc1 lds
    v_mfma_f32_16x16x32_bf16 v[132:135], a[88:91], a[32:35], v[132:135]
    s_xor_b32 s62, s62, 229376
    ds_read_b64_tr_b16 a[74:75], v9 offset:2048
    v_mfma_f32_16x16x32_bf16 v[140:143], a[88:91], a[40:43], v[140:143]
    v_mfma_f32_16x16x32_bf16 v[140:143], a[92:95], a[44:47], v[140:143]
    v_mfma_f32_16x16x32_bf16 v[136:139], a[84:87], a[44:47], v[136:139]
    buffer_load_dwordx4 v21, s[44:47], s54 offen offset:1024 sc1 lds
    v_mfma_f32_16x16x32_bf16 v[136:139], a[80:83], a[40:43], v[136:139]
    s_add_u32 s54, s54, s56
    ds_read_b64_tr_b16 a[76:77], v9 offset:16384
    v_mfma_f32_16x16x32_bf16 v[144:147], a[80:83], a[48:51], v[144:147]
    v_mfma_f32_16x16x32_bf16 v[144:147], a[84:87], a[52:55], v[144:147]
    v_mfma_f32_16x16x32_bf16 v[148:151], a[92:95], a[52:55], v[148:151]
    buffer_load_dwordx4 v20, s[44:47], s55 offen offset:2048 sc1 lds
    v_mfma_f32_16x16x32_bf16 v[148:151], a[88:91], a[48:51], v[148:151]
    ds_read_b64_tr_b16 a[78:79], v9 offset:18432
    v_mfma_f32_16x16x32_bf16 v[156:159], a[88:91], a[56:59], v[156:159]
    v_add_u32 v6, s63, v6
    v_add_u32 v7, s63, v7
    v_mfma_f32_16x16x32_bf16 v[156:159], a[92:95], a[60:63], v[156:159]
    v_mfma_f32_16x16x32_bf16 v[152:155], a[84:87], a[60:63], v[152:155]
    buffer_load_dwordx4 v21, s[44:47], s55 offen offset:3072 sc1 lds
    v_mfma_f32_16x16x32_bf16 v[152:155], a[80:83], a[56:59], v[152:155]
    s_add_u32 s55, s55, s56
    v_mfma_f32_16x16x32_bf16 v[160:163], a[96:99], a[0:3], v[160:163]
    ds_read_b64_tr_b16 a[80:81], v10 offset:0
    v_mfma_f32_16x16x32_bf16 v[160:163], a[100:103], a[4:7], v[160:163]
    v_mfma_f32_16x16x32_bf16 v[164:167], a[108:111], a[4:7], v[164:167]
    v_mfma_f32_16x16x32_bf16 v[164:167], a[104:107], a[0:3], v[164:167]
    s_add_u32 m0, s61, 0
    ds_read_b64_tr_b16 a[82:83], v10 offset:2048
    v_mfma_f32_16x16x32_bf16 v[172:175], a[104:107], a[8:11], v[172:175]
    buffer_load_dwordx4 v16, s[40:43], s48 offen offset:0 sc1 lds
    v_mfma_f32_16x16x32_bf16 v[172:175], a[108:111], a[12:15], v[172:175]
    v_mfma_f32_16x16x32_bf16 v[168:171], a[100:103], a[12:15], v[168:171]
    ds_read_b64_tr_b16 a[84:85], v10 offset:16384
    v_mfma_f32_16x16x32_bf16 v[168:171], a[96:99], a[8:11], v[168:171]
    v_mfma_f32_16x16x32_bf16 v[176:179], a[96:99], a[16:19], v[176:179]
    buffer_store_dwordx4 a[176:179], v2, s[24:27], s28 offen sc1
    v_mfma_f32_16x16x32_bf16 v[176:179], a[100:103], a[20:23], v[176:179]
    s_add_u32 s28, s28, s31
    ds_read_b64_tr_b16 a[86:87], v10 offset:18432
    v_mfma_f32_16x16x32_bf16 v[180:183], a[108:111], a[20:23], v[180:183]
    v_mfma_f32_16x16x32_bf16 v[180:183], a[104:107], a[16:19], v[180:183]
    v_mfma_f32_16x16x32_bf16 v[188:191], a[104:107], a[24:27], v[188:191]
    buffer_load_dwordx4 v17, s[40:43], s48 offen offset:1024 sc1 lds
    v_mfma_f32_16x16x32_bf16 v[188:191], a[108:111], a[28:31], v[188:191]
    s_add_u32 s48, s48, 128
    ds_read_b64_tr_b16 a[88:89], v11 offset:0
    v_mfma_f32_16x16x32_bf16 v[184:187], a[100:103], a[28:31], v[184:187]
    v_mfma_f32_16x16x32_bf16 v[184:187], a[96:99], a[24:27], v[184:187]
    v_mfma_f32_16x16x32_bf16 v[192:195], a[96:99], a[32:35], v[192:195]
    buffer_store_dwordx4 a[180:183], v2, s[24:27], s28 offen sc1
    v_mfma_f32_16x16x32_bf16 v[192:195], a[100:103], a[36:39], v[192:195]
    s_add_u32 s28, s28, s31
    ds_read_b64_tr_b16 a[90:91], v11 offset:2048
    v_mfma_f32_16x16x32_bf16 v[196:199], a[108:111], a[36:39], v[196:199]
    v_mfma_f32_16x16x32_bf16 v[196:199], a[104:107], a[32:35], v[196:199]
    v_mfma_f32_16x16x32_bf16 v[204:207], a[104:107], a[40:43], v[204:207]
    buffer_load_dwordx4 v16, s[40:43], s49 offen offset:2048 sc1 lds
    v_mfma_f32_16x16x32_bf16 v[204:207], a[108:111], a[44:47], v[204:207]
    ds_read_b64_tr_b16 a[92:93], v11 offset:16384
    v_mfma_f32_16x16x32_bf16 v[200:203], a[100:103], a[44:47], v[200:203]
    v_mfma_f32_16x16x32_bf16 v[200:203], a[96:99], a[40:43], v[200:203]
    v_mfma_f32_16x16x32_bf16 v[208:211], a[96:99], a[48:51], v[208:211]
    buffer_store_dwordx4 a[184:187], v2, s[24:27], s28 offen sc1
    v_mfma_f32_16x16x32_bf16 v[208:211], a[100:103], a[52:55], v[208:211]
    s_add_u32 s28, s28, s31
    ds_read_b64_tr_b16 a[94:95], v11 offset:18432
    v_mfma_f32_16x16x32_bf16 v[212:215], a[108:111], a[52:55], v[212:215]
    v_mfma_f32_16x16x32_bf16 v[212:215], a[104:107], a[48:51], v[212:215]
    v_mfma_f32_16x16x32_bf16 v[220:223], a[104:107], a[56:59], v[220:223]
    buffer_load_dwordx4 v17, s[40:43], s49 offen offset:3072 sc1 lds
    v_mfma_f32_16x16x32_bf16 v[220:223], a[108:111], a[60:63], v[220:223]
    s_add_u32 s49, s49, 128
    v_mfma_f32_16x16x32_bf16 v[216:219], a[100:103], a[60:63], v[216:219]
    buffer_store_dwordx4 a[188:191], v2, s[24:27], s28 offen sc1
    v_mfma_f32_16x16x32_bf16 v[216:219], a[96:99], a[56:59], v[216:219]
    s_add_u32 s29, s29, s30
    s_mov_b32 s28, s29
    v_mfma_f32_16x16x32_bf16 v[224:227], a[112:115], a[0:3], v[224:227]
    v_mfma_f32_16x16x32_bf16 v[224:227], a[116:119], a[4:7], v[224:227]
    ds_read_b64_tr_b16 a[96:97], v12 offset:0
    v_mfma_f32_16x16x32_bf16 v[228:231], a[124:127], a[4:7], v[228:231]
    v_mfma_f32_16x16x32_bf16 v[228:231], a[120:123], a[0:3], v[228:231]
    s_add_u32 m0, s61, 4096
    ds_read_b128 a[0:3], v6 offset:0
    v_mfma_f32_16x16x32_bf16 v[236:239], a[120:123], a[8:11], v[236:239]
    buffer_load_dwordx4 v16, s[40:43], s50 offen offset:0 sc1 lds
    v_mfma_f32_16x16x32_bf16 v[236:239], a[124:127], a[12:15], v[236:239]
    s_add_u32 s61, s61, 32768
    ds_read_b128 a[4:7], v7 offset:0
    v_mfma_f32_16x16x32_bf16 v[232:235], a[116:119], a[12:15], v[232:235]
    s_cmp_ge_u32 s61, 98304
    s_cselect_b32 s90, 98304, 0
    ds_read_b64_tr_b16 a[98:99], v12 offset:2048
    v_mfma_f32_16x16x32_bf16 v[232:235], a[112:115], a[8:11], v[232:235]
    s_sub_u32 s61, s61, s90
    ds_read_b128 a[8:11], v6 offset:2048
    v_mfma_f32_16x16x32_bf16 v[240:243], a[112:115], a[16:19], v[240:243]
    ds_read_b128 a[12:15], v7 offset:2048
    v_mfma_f32_16x16x32_bf16 v[240:243], a[116:119], a[20:23], v[240:243]
    ds_read_b64_tr_b16 a[100:101], v12 offset:16384
    v_mfma_f32_16x16x32_bf16 v[244:247], a[124:127], a[20:23], v[244:247]
    v_mfma_f32_16x16x32_bf16 v[244:247], a[120:123], a[16:19], v[244:247]
    ds_read_b128 a[16:19], v6 offset:4096
    v_mfma_f32_16x16x32_bf16 v[252:255], a[120:123], a[24:27], v[252:255]
    buffer_load_dwordx4 v17, s[40:43], s50 offen offset:1024 sc1 lds
    v_mfma_f32_16x16x32_bf16 v[252:255], a[124:127], a[28:31], v[252:255]
    s_add_u32 s50, s50, 128
    ds_read_b128 a[20:23], v7 offset:4096
    v_mfma_f32_16x16x32_bf16 v[248:251], a[116:119], a[28:31], v[248:251]
    ds_read_b64_tr_b16 a[102:103], v12 offset:18432
    v_mfma_f32_16x16x32_bf16 v[248:251], a[112:115], a[24:27], v[248:251]
    ds_read_b128 a[24:27], v6 offset:6144
    v_mfma_f32_16x16x32_bf16 a[224:227], a[112:115], a[32:35], a[224:227]
    s_sub_u32 s65, s65, 1
    ds_read_b128 a[28:31], v7 offset:6144
    v_mfma_f32_16x16x32_bf16 a[224:227], a[116:119], a[36:39], a[224:227]
    ds_read_b64_tr_b16 a[104:105], v13 offset:0
    v_mfma_f32_16x16x32_bf16 a[228:231], a[124:127], a[36:39], a[228:231]
    v_mfma_f32_16x16x32_bf16 a[228:231], a[120:123], a[32:35], a[228:231]
    ds_read_b128 a[32:35], v6 offset:8192
    v_mfma_f32_16x16x32_bf16 a[236:239], a[120:123], a[40:43], a[236:239]
    buffer_load_dwordx4 v16, s[40:43], s51 offen offset:2048 sc1 lds
    v_mfma_f32_16x16x32_bf16 a[236:239], a[124:127], a[44:47], a[236:239]
    ds_read_b128 a[36:39], v7 offset:8192
    v_mfma_f32_16x16x32_bf16 a[232:235], a[116:119], a[44:47], a[232:235]
    ds_read_b64_tr_b16 a[106:107], v13 offset:2048
    v_mfma_f32_16x16x32_bf16 a[232:235], a[112:115], a[40:43], a[232:235]
    ds_read_b128 a[40:43], v6 offset:10240
    v_mfma_f32_16x16x32_bf16 a[240:243], a[112:115], a[48:51], a[240:243]
    ds_read_b128 a[44:47], v7 offset:10240
    v_mfma_f32_16x16x32_bf16 a[240:243], a[116:119], a[52:55], a[240:243]
    ds_read_b64_tr_b16 a[108:109], v13 offset:16384
    v_mfma_f32_16x16x32_bf16 a[244:247], a[124:127], a[52:55], a[244:247]
    v_mfma_f32_16x16x32_bf16 a[244:247], a[120:123], a[48:51], a[244:247]
    ds_read_b128 a[48:51], v6 offset:12288
    v_mfma_f32_16x16x32_bf16 a[252:255], a[120:123], a[56:59], a[252:255]
    buffer_load_dwordx4 v17, s[40:43], s51 offen offset:3072 sc1 lds
    v_mfma_f32_16x16x32_bf16 a[252:255], a[124:127], a[60:63], a[252:255]
    s_add_u32 s51, s51, 128
    ds_read_b128 a[52:55], v7 offset:12288
    v_mfma_f32_16x16x32_bf16 a[248:251], a[116:119], a[60:63], a[248:251]
    ds_read_b64_tr_b16 a[110:111], v13 offset:18432
    v_mfma_f32_16x16x32_bf16 a[248:251], a[112:115], a[56:59], a[248:251]
    ds_read_b128 a[56:59], v6 offset:14336
    ds_read_b128 a[60:63], v7 offset:14336
    s_cmp_eq_u32 s66, 2
    s_cbranch_scc1 m_hook18
m_hookr19:
    s_waitcnt lgkmcnt(15)
    v_mfma_f32_16x16x32_bf16 v[32:35], a[64:67], a[0:3], v[32:35]
    ds_read_b64_tr_b16 a[112:113], v14 offset:0
    v_mfma_f32_16x16x32_bf16 v[32:35], a[68:71], a[4:7], v[32:35]
    ds_read_b64_tr_b16 a[114:115], v14 offset:2048
    v_mfma_f32_16x16x32_bf16 v[36:39], a[76:79], a[4:7], v[36:39]
    ds_read_b64_tr_b16 a[116:117], v14 offset:16384
    v_mfma_f32_16x16x32_bf16 v[36:39], a[72:75], a[0:3], v[36:39]
    ds_read_b64_tr_b16 a[118:119], v14 offset:18432
    v_mfma_f32_16x16x32_bf16 v[44:47], a[72:75], a[8:11], v[44:47]
    ds_read_b64_tr_b16 a[120:121], v15 offset:0
    v_mfma_f32_16x16x32_bf16 v[44:47], a[76:79], a[12:15], v[44:47]
    ds_read_b64_tr_b16 a[122:123], v15 offset:2048
    v_mfma_f32_16x16x32_bf16 v[40:43], a[68:71], a[12:15], v[40:43]
    ds_read_b64_tr_b16 a[124:125], v15 offset:16384
    v_mfma_f32_16x16x32_bf16 v[40:43], a[64:67], a[8:11], v[40:43]
    ds_read_b64_tr_b16 a[126:127], v15 offset:18432
    v_mfma_f32_16x16x32_bf16 v[48:51], a[64:67], a[16:19], v[48:51]
    v_mfma_f32_16x16x32_bf16 v[48:51], a[68:71], a[20:23], v[48:51]
    v_mfma_f32_16x16x32_bf16 v[52:55], a[76:79], a[20:23], v[52:55]
    buffer_store_dwordx4 a[192:195], v2, s[24:27], s28 offen sc1
    v_mfma_f32_16x16x32_bf16 v[52:55], a[72:75], a[16:19], v[52:55]
    s_add_u32 s28, s28, s31
    s_waitcnt lgkmcnt(15)
    v_mfma_f32_16x16x32_bf16 v[60:63], a[72:75], a[24:27], v[60:63]
    v_xor_b32 v8, s60, v8
    v_xor_b32 v9, s60, v9
    v_mfma_f32_16x16x32_bf16 v[60:63], a[76:79], a[28:31], v[60:63]
    v_xor_b32 v10, s60, v10
    v_xor_b32 v11, s60, v11
    v_mfma_f32_16x16x32_bf16 v[56:59], a[68:71], a[28:31], v[56:59]
    v_xor_b32 v12, s60, v12
    v_xor_b32 v13, s60, v13
    v_mfma_f32_16x16x32_bf16 v[56:59], a[64:67], a[24:27], v[56:59]
    v_xor_b32 v14, s60, v14
    v_xor_b32 v15, s60, v15
    v_mfma_f32_16x16x32_bf16 v[64:67], a[64:67], a[32:35], v[64:67]
    buffer_store_dwordx4 a[196:199], v2, s[24:27], s28 offen sc1
    v_mfma_f32_16x16x32_bf16 v[64:67], a[68:71], a[36:39], v[64:67]
    s_add_u32 s28, s28, s31
    v_mfma_f32_16x16x32_bf16 v[68:71], a[76:79], a[36:39], v[68:71]
    v_mfma_f32_16x16x32_bf16 v[68:71], a[72:75], a[32:35], v[68:71]
    s_waitcnt lgkmcnt(14)
    v_mfma_f32_16x16x32_bf16 v[76:79], a[72:75], a[40:43], v[76:79]
    v_mfma_f32_16x16x32_bf16 v[76:79], a[76:79], a[44:47], v[76:79]
    v_mfma_f32_16x16x32_bf16 v[72:75], a[68:71], a[44:47], v[72:75]
    buffer_store_dwordx4 a[200:203], v2, s[24:27], s28 offen sc1
    v_mfma_f32_16x16x32_bf16 v[72:75], a[64:67], a[40:43], v[72:75]
    s_add_u32 s28, s28, s31
    s_waitcnt lgkmcnt(11)
    v_mfma_f32_16x16x32_bf16 v[80:83], a[64:67], a[48:51], v[80:83]
    v_mfma_f32_16x16x32_bf16 v[80:83], a[68:71], a[52:55], v[80:83]
    v_mfma_f32_16x16x32_bf16 v[84:87], a[76:79], a[52:55], v[84:87]
    v_mfma_f32_16x16x32_bf16 v[84:87], a[72:75], a[48:51], v[84:87]
    s_waitcnt lgkmcnt(8)
    v_mfma_f32_16x16x32_bf16 v[92:95], a[72:75], a[56:59], v[92:95]
    buffer_store_dwordx4 a[204:207], v2, s[24:27], s28 offen sc1
    v_mfma_f32_16x16x32_bf16 v[92:95], a[76:79], a[60:63], v[92:95]
    s_add_u32 s28, s28, s31
    v_mfma_f32_16x16x32_bf16 v[88:91], a[68:71], a[60:63], v[88:91]
    s_waitcnt vmcnt(16) lgkmcnt(0)
    v_mfma_f32_16x16x32_bf16 v[88:91], a[64:67], a[56:59], v[88:91]
    s_barrier
    v_mfma_f32_16x16x32_bf16 v[96:99], a[80:83], a[0:3], v[96:99]
    ds_read_b64_tr_b16 a[64:65], v8 offset:0
    v_mfma_f32_16x16x32_bf16 v[96:99], a[84:87], a[4:7], v[96:99]
    s_add_u32 m0, s62, 0
    v_mfma_f32_16x16x32_bf16 v[100:103], a[92:95], a[4:7], v[100:103]
    buffer_load_dwordx4 v18, s[44:47], s52 offen offset:0 sc1 lds
    v_mfma_f32_16x16x32_bf16 v[100:103], a[88:91], a[0:3], v[100:103]
    ds_read_b64_tr_b16 a[66:67], v8 offset:2048
    v_mfma_f32_16x16x32_bf16 v[108:111], a[88:91], a[8:11], v[108:111]
    s_add_u32 s64, s64, 32768
    v_mfma_f32_16x16x32_bf16 v[108:111], a[92:95], a[12:15], v[108:111]
    s_cmp_ge_u32 s64, 98304
    s_cselect_b32 s63, 4294901760, s59
    s_cselect_b32 s64, 0, s64
    v_mfma_f32_16x16x32_bf16 v[104:107], a[84:87], a[12:15], v[104:107]
    buffer_load_dwordx4 v19, s[44:47], s52 offen offset:1024 sc1 lds
    v_mfma_f32_16x16x32_bf16 v[104:107], a[80:83], a[8:11], v[104:107]
    s_add_u32 s52, s52, s56
    ds_read_b64_tr_b16 a[68:69], v8 offset:16384
    v_mfma_f32_16x16x32_bf16 v[112:115], a[80:83], a[16:19], v[112:115]
    v_mfma_f32_16x16x32_bf16 v[112:115], a[84:87], a[20:23], v[112:115]
    v_mfma_f32_16x16x32_bf16 v[116:119], a[92:95], a[20:23], v[116:119]
    buffer_load_dwordx4 v18, s[44:47], s53 offen offset:2048 sc1 lds
    v_mfma_f32_16x16x32_bf16 v[116:119], a[88:91], a[16:19], v[116:119]
    ds_read_b64_tr_b16 a[70:71], v8 offset:18432
    v_mfma_f32_16x16x32_bf16 v[124:127], a[88:91], a[24:27], v[124:127]
    v_mfma_f32_16x16x32_bf16 v[124:127], a[92:95], a[28:31], v[124:127]
    v_mfma_f32_16x16x32_bf16 v[120:123], a[84:87], a[28:31], v[120:123]
    buffer_load_dwordx4 v19, s[44:47], s53 offen offset:3072 sc1 lds
    v_mfma_f32_16x16x32_bf16 v[120:123], a[80:83], a[24:27], v[120:123]
    s_add_u32 s53, s53, s56
    ds_read_b64_tr_b16 a[72:73], v9 offset:0
    v_mfma_f32_16x16x32_bf16 v[128:131], a[80:83], a[32:35], v[128:131]
    v_mfma_f32_16x16x32_bf16 v[128:131], a[84:87], a[36:39], v[128:131]
    s_add_u32 m0, s62, 4096
    v_mfma_f32_16x16x32_bf16 v[132:135], a[92:95], a[36:39], v[132:135]
    buffer_load_dwordx4 v20, s[44:47], s54 offen offset:0 sc1 lds
    v_mfma_f32_16x16x32_bf16 v[132:135], a[88:91], a[32:35], v[132:135]
    s_xor_b32 s62, s62, 229376
    ds_read_b64_tr_b16 a[74:75], v9 offset:2048
    v_mfma_f32_16x16x32_bf16 v[140:143], a[88:91], a[40:43], v[140:143]
    v_mfma_f32_16x16x32_bf16 v[140:143], a[92:95], a[44:47], v[140:143]
    v_mfma_f32_16x16x32_bf16 v[136:139], a[84:87], a[44:47], v[136:139]
    buffer_load_dwordx4 v21, s[44:47], s54 offen offset:1024 sc1 lds
    v_mfma_f32_16x16x32_bf16 v[136:139], a[80:83], a[40:43], v[136:139]
    s_add_u32 s54, s54, s56
    ds_read_b64_tr_b16 a[76:77], v9 offset:16384
    v_mfma_f32_16x16x32_bf16 v[144:147], a[80:83], a[48:51], v[144:147]
    v_mfma_f32_16x16x32_bf16 v[144:147], a[84:87], a[52:55], v[144:147]
    v_mfma_f32_16x16x32_bf16 v[148:151], a[92:95], a[52:55], v[148:151]
    buffer_load_dwordx4 v20, s[44:47], s55 offen offset:2048 sc1 lds
    v_mfma_f32_16x16x32_bf16 v[148:151], a[88:91], a[48:51], v[148:151]
    ds_read_b64_tr_b16 a[78:79], v9 offset:18432
    v_mfma_f32_16x16x32_bf16 v[156:159], a[88:91], a[56:59], v[156:159]
    v_add_u32 v6, s63, v6
    v_add_u32 v7, s63, v7
    v_mfma_f32_16x16x32_bf16 v[156:159], a[92:95], a[60:63], v[156:159]
    v_mfma_f32_16x16x32_bf16 v[152:155], a[84:87], a[60:63], v[152:155]
    buffer_load_dwordx4 v21, s[44:47], s55 offen offset:3072 sc1 lds
    v_mfma_f32_16x16x32_bf16 v[152:155], a[80:83], a[56:59], v[152:155]
    s_add_u32 s55, s55, s56
    v_mfma_f32_16x16x32_bf16 v[160:163], a[96:99], a[0:3], v[160:163]
    ds_read_b64_tr_b16 a[80:81], v10 offset:0
    v_mfma_f32_16x16x32_bf16 v[160:163], a[100:103], a[4:7], v[160:163]
    v_mfma_f32_16x16x32_bf16 v[164:167], a[108:111], a[4:7], v[164:167]
    v_mfma_f32_16x16x32_bf16 v[164:167], a[104:107], a[0:3], v[164:167]
    s_add_u32 m0, s61, 0
    ds_read_b64_tr_b16 a[82:83], v10 offset:2048
    v_mfma_f32_16x16x32_bf16 v[172:175], a[104:107], a[8:11], v[172:175]
    buffer_load_dwordx4 v16, s[40:43], s48 offen offset:0 sc1 lds
    v_mfma_f32_16x16x32_bf16 v[172:175], a[108:111], a[12:15], v[172:175]
    v_mfma_f32_16x16x32_bf16 v[168:171], a[100:103], a[12:15], v[168:171]
    ds_read_b64_tr_b16 a[84:85], v10 offset:16384
    v_mfma_f32_16x16x32_bf16 v[168:171], a[96:99], a[8:11], v[168:171]
    v_mfma_f32_16x16x32_bf16 v[176:179], a[96:99], a[16:19], v[176:179]
    buffer_store_dwordx4 a[208:211], v2, s[24:27], s28 offen sc1
    v_mfma_f32_16x16x32_bf16 v[176:179], a[100:103], a[20:23], v[176:179]
    s_add_u32 s28, s28, s31
    ds_read_b64_tr_b16 a[86:87], v10 offset:18432
    v_mfma_f32_16x16x32_bf16 v[180:183], a[108:111], a[20:23], v[180:183]
    v_mfma_f32_16x16x32_bf16 v[180:183], a[104:107], a[16:19], v[180:183]
    v_mfma_f32_16x16x32_bf16 v[188:191], a[104:107], a[24:27], v[188:191]
    buffer_load_dwordx4 v17, s[40:43], s48 offen offset:1024 sc1 lds
    v_mfma_f32_16x16x32_bf16 v[188:191], a[108:111], a[28:31], v[188:191]
    s_add_u32 s48, s48, 128
    ds_read_b64_tr_b16 a[88:89], v11 offset:0
    v_mfma_f32_16x16x32_bf16 v[184:187], a[100:103], a[28:31], v[184:187]
    v_mfma_f32_16x16x32_bf16 v[184:187], a[96:99], a[24:27], v[184:187]
    v_mfma_f32_16x16x32_bf16 v[192:195], a[96:99], a[32:35], v[192:195]
    buffer_store_dwordx4 a[212:215], v2, s[24:27], s28 offen sc1
    v_mfma_f32_16x16x32_bf16 v[192:195], a[100:103], a[36:39], v[192:195]
    s_add_u32 s28, s28, s31
    ds_read_b64_tr_b16 a[90:91], v11 offset:2048
    v_mfma_f32_16x16x32_bf16 v[196:199], a[108:111], a[36:39], v[196:199]
    v_mfma_f32_16x16x32_bf16 v[196:199], a[104:107], a[32:35], v[196:199]
    v_mfma_f32_16x16x32_bf16 v[204:207], a[104:107], a[40:43], v[204:207]
    buffer_load_dwordx4 v16, s[40:43], s49 offen offset:2048 sc1 lds
    v_mfma_f32_16x16x32_bf16 v[204:207], a[108:111], a[44:47], v[204:207]
    ds_read_b64_tr_b16 a[92:93], v11 offset:16384
    v_mfma_f32_16x16x32_bf16 v[200:203], a[100:103], a[44:47], v[200:203]
    v_mfma_f32_16x16x32_bf16 v[200:203], a[96:99], a[40:43], v[200:203]
    v_mfma_f32_16x16x32_bf16 v[208:211], a[96:99], a[48:51], v[208:211]
    buffer_store_dwordx4 a[216:219], v2, s[24:27], s28 offen sc1
    v_mfma_f32_16x16x32_bf16 v[208:211], a[100:103], a[52:55], v[208:211]
    s_add_u32 s28, s28, s31
    ds_read_b64_tr_b16 a[94:95], v11 offset:18432
    v_mfma_f32_16x16x32_bf16 v[212:215], a[108:111], a[52:55], v[212:215]
    v_mfma_f32_16x16x32_bf16 v[212:215], a[104:107], a[48:51], v[212:215]
    v_mfma_f32_16x16x32_bf16 v[220:223], a[104:107], a[56:59], v[220:223]
    buffer_load_dwordx4 v17, s[40:43], s49 offen offset:3072 sc1 lds
    v_mfma_f32_16x16x32_bf16 v[220:223], a[108:111], a[60:63], v[220:223]
    s_add_u32 s49, s49, 128
    v_mfma_f32_16x16x32_bf16 v[216:219], a[100:103], a[60:63], v[216:219]
    buffer_store_dwordx4 a[220:223], v2, s[24:27], s28 offen sc1
    v_mfma_f32_16x16x32_bf16 v[216:219], a[96:99], a[56:59], v[216:219]
    s_add_u32 s29, s29, s30
    s_mov_b32 s28, s29
    v_mfma_f32_16x16x32_bf16 v[224:227], a[112:115], a[0:3], v[224:227]
    v_mfma_f32_16x16x32_bf16 v[224:227], a[116:119], a[4:7], v[224:227]
    ds_read_b64_tr_b16 a[96:97], v12 offset:0
    v_mfma_f32_16x16x32_bf16 v[228:231], a[124:127], a[4:7], v[228:231]
    v_mfma_f32_16x16x32_bf16 v[228:231], a[120:123], a[0:3], v[228:231]
    s_add_u32 m0, s61, 4096
    ds_read_b128 a[0:3], v6 offset:0
    v_mfma_f32_16x16x32_bf16 v[236:239], a[120:123], a[8:11], v[236:239]
    buffer_load_dwordx4 v16, s[40:43], s50 offen offset:0 sc1 lds
    v_mfma_f32_16x16x32_bf16 v[236:239], a[124:127], a[12:15], v[236:239]
    s_add_u32 s61, s61, 32768
    ds_read_b128 a[4:7], v7 offset:0
    v_mfma_f32_16x16x32_bf16 v[232:235], a[116:119], a[12:15], v[232:235]
    s_cmp_ge_u32 s61, 98304
    s_cselect_b32 s90, 98304, 0
    ds_read_b64_tr_b16 a[98:99], v12 offset:2048
    v_mfma_f32_16x16x32_bf16 v[232:235], a[112:115], a[8:11], v[232:235]
    s_sub_u32 s61, s61, s90
    ds_read_b128 a[8:11], v6 offset:2048
    v_mfma_f32_16x16x32_bf16 v[240:243], a[112:115], a[16:19], v[240:243]
    ds_read_b128 a[12:15], v7 offset:2048
    v_mfma_f32_16x16x32_bf16 v[240:243], a[116:119], a[20:23], v[240:243]
    ds_read_b64_tr_b16 a[100:101], v12 offset:16384
    v_mfma_f32_16x16x32_bf16 v[244:247], a[124:127], a[20:23], v[244:247]
    v_mfma_f32_16x16x32_bf16 v[244:247], a[120:123], a[16:19], v[244:247]
    ds_read_b128 a[16:19], v6 offset:4096
    v_mfma_f32_16x16x32_bf16 v[252:255], a[120:123], a[24:27], v[252:255]
    buffer_load_dwordx4 v17, s[40:43], s50 offen offset:1024 sc1 lds
    v_mfma_f32_16x16x32_bf16 v[252:255], a[124:127], a[28:31], v[252:255]
    s_add_u32 s50, s50, 128
    ds_read_b128 a[20:23], v7 offset:4096
    v_mfma_f32_16x16x32_bf16 v[248:251], a[116:119], a[28:31], v[248:251]
    ds_read_b64_tr_b16 a[102:103], v12 offset:18432
    v_mfma_f32_16x16x32_bf16 v[248:251], a[112:115], a[24:27], v[248:251]
    ds_read_b128 a[24:27], v6 offset:6144
    v_mfma_f32_16x16x32_bf16 a[224:227], a[112:115], a[32:35], a[224:227]
    s_sub_u32 s65, s65, 1
    ds_read_b128 a[28:31], v7 offset:6144
    v_mfma_f32_16x16x32_bf16 a[224:227], a[116:119], a[36:39], a[224:227]
    ds_read_b64_tr_b16 a[104:105], v13 offset:0
    v_mfma_f32_16x16x32_bf16 a[228:231], a[124:127], a[36:39], a[228:231]
    v_mfma_f32_16x16x32_bf16 a[228:231], a[120:123], a[32:35], a[228:231]
    ds_read_b128 a[32:35], v6 offset:8192
    v_mfma_f32_16x16x32_bf16 a[236:239], a[120:123], a[40:43], a[236:239]
    buffer_load_dwordx4 v16, s[40:43], s51 offen offset:2048 sc1 lds
    v_mfma_f32_16x16x32_bf16 a[236:239], a[124:127], a[44:47], a[236:239]
    ds_read_b128 a[36:39], v7 offset:8192
    v_mfma_f32_16x16x32_bf16 a[232:235], a[116:119], a[44:47], a[232:235]
    ds_read_b64_tr_b16 a[106:107], v13 offset:2048
    v_mfma_f32_16x16x32_bf16 a[232:235], a[112:115], a[40:43], a[232:235]
    ds_read_b128 a[40:43], v6 offset:10240
    v_mfma_f32_16x16x32_bf16 a[240:243], a[112:115], a[48:51], a[240:243]
    ds_read_b128 a[44:47], v7 offset:10240
    v_mfma_f32_16x16x32_bf16 a[240:243], a[116:119], a[52:55], a[240:243]
    ds_read_b64_tr_b16 a[108:109], v13 offset:16384
    v_mfma_f32_16x16x32_bf16 a[244:247], a[124:127], a[52:55], a[244:247]
    v_mfma_f32_16x16x32_bf16 a[244:247], a[120:123], a[48:51], a[244:247]
    ds_read_b128 a[48:51], v6 offset:12288
    v_mfma_f32_16x16x32_bf16 a[252:255], a[120:123], a[56:59], a[252:255]
    buffer_load_dwordx4 v17, s[40:43], s51 offen offset:3072 sc1 lds
    v_mfma_f32_16x16x32_bf16 a[252:255], a[124:127], a[60:63], a[252:255]
    s_add_u32 s51, s51, 128
    ds_read_b128 a[52:55], v7 offset:12288
    v_mfma_f32_16x16x32_bf16 a[248:251], a[116:119], a[60:63], a[248:251]
    ds_read_b64_tr_b16 a[110:111], v13 offset:18432
    v_mfma_f32_16x16x32_bf16 a[248:251], a[112:115], a[56:59], a[248:251]
    ds_read_b128 a[56:59], v6 offset:14336
    ds_read_b128 a[60:63], v7 offset:14336
.p2align 3
m_loop20:
    s_waitcnt lgkmcnt(15)
    v_mfma_f32_16x16x32_bf16 v[32:35], a[64:67], a[0:3], v[32:35]
    ds_read_b64_tr_b16 a[112:113], v14 offset:0
    v_mfma_f32_16x16x32_bf16 v[32:35], a[68:71], a[4:7], v[32:35]
    ds_read_b64_tr_b16 a[114:115], v14 offset:2048
    v_mfma_f32_16x16x32_bf16 v[36:39], a[76:79], a[4:7], v[36:39]
    ds_read_b64_tr_b16 a[116:117], v14 offset:16384
    v_mfma_f32_16x16x32_bf16 v[36:39], a[72:75], a[0:3], v[36:39]
    ds_read_b64_tr_b16 a[118:119], v14 offset:18432
    v_mfma_f32_16x16x32_bf16 v[44:47], a[72:75], a[8:11], v[44:47]
    ds_read_b64_tr_b16 a[120:121], v15 offset:0
    v_mfma_f32_16x16x32_bf16 v[44:47], a[76:79], a[12:15], v[44:47]
    ds_read_b64_tr_b16 a[122:123], v15 offset:2048
    v_mfma_f32_16x16x32_bf16 v[40:43], a[68:71], a[12:15], v[40:43]
    ds_read_b64_tr_b16 a[124:125], v15 offset:16384
    v_mfma_f32_16x16x32_bf16 v[40:43], a[64:67], a[8:11], v[40:43]
    ds_read_b64_tr_b16 a[126:127], v15 offset:18432
    v_mfma_f32_16x16x32_bf16 v[48:51], a[64:67], a[16:19], v[48:51]
    v_mfma_f32_16x16x32_bf16 v[48:51], a[68:71], a[20:23], v[48:51]
    v_mfma_f32_16x16x32_bf16 v[52:55], a[76:79], a[20:23], v[52:55]
    v_mfma_f32_16x16x32_bf16 v[52:55], a[72:75], a[16:19], v[52:55]
    s_waitcnt lgkmcnt(15)
    v_mfma_f32_16x16x32_bf16 v[60:63], a[72:75], a[24:27], v[60:63]
    v_xor_b32 v8, s60, v8
    v_xor_b32 v9, s60, v9
    v_mfma_f32_16x16x32_bf16 v[60:63], a[76:79], a[28:31], v[60:63]
    v_xor_b32 v10, s60, v10
    v_xor_b32 v11, s60, v11
    v_mfma_f32_16x16x32_bf16 v[56:59], a[68:71], a[28:31], v[56:59]
    v_xor_b32 v12, s60, v12
    v_xor_b32 v13, s60, v13
    v_mfma_f32_16x16x32_bf16 v[56:59], a[64:67], a[24:27], v[56:59]
    v_xor_b32 v14, s60, v14
    v_xor_b32 v15, s60, v15
    v_mfma_f32_16x16x32_bf16 v[64:67], a[64:67], a[32:35], v[64:67]
    v_mfma_f32_16x16x32_bf16 v[64:67], a[68:71], a[36:39], v[64:67]
    v_mfma_f32_16x16x32_bf16 v[68:71], a[76:79], a[36:39], v[68:71]
    v_mfma_f32_16x16x32_bf16 v[68:71], a[72:75], a[32:35], v[68:71]
    s_waitcnt lgkmcnt(14)
    v_mfma_f32_16x16x32_bf16 v[76:79], a[72:75], a[40:43], v[76:79]
    v_mfma_f32_16x16x32_bf16 v[76:79], a[76:79], a[44:47], v[76:79]
    v_mfma_f32_16x16x32_bf16 v[72:75], a[68:71], a[44:47], v[72:75]
    v_mfma_f32_16x16x32_bf16 v[72:75], a[64:67], a[40:43], v[72:75]
    s_waitcnt lgkmcnt(11)
    v_mfma_f32_16x16x32_bf16 v[80:83], a[64:67], a[48:51], v[80:83]
    v_mfma_f32_16x16x32_bf16 v[80:83], a[68:71], a[52:55], v[80:83]
    v_mfma_f32_16x16x32_bf16 v[84:87], a[76:79], a[52:55], v[84:87]
    v_mfma_f32_16x16x32_bf16 v[84:87], a[72:75], a[48:51], v[84:87]
    s_waitcnt lgkmcnt(8)
    v_mfma_f32_16x16x32_bf16 v[92:95], a[72:75], a[56:59], v[92:95]
    v_mfma_f32_16x16x32_bf16 v[92:95], a[76:79], a[60:63], v[92:95]
    v_mfma_f32_16x16x32_bf16 v[88:91], a[68:71], a[60:63], v[88:91]
    s_waitcnt vmcnt(8) lgkmcnt(0)
    v_mfma_f32_16x16x32_bf16 v[88:91], a[64:67], a[56:59], v[88:91]
    s_barrier
    v_mfma_f32_16x16x32_bf16 v[96:99], a[80:83], a[0:3], v[96:99]
    ds_read_b64_tr_b16 a[64:65], v8 offset:0
    v_mfma_f32_16x16x32_bf16 v[96:99], a[84:87], a[4:7], v[96:99]
    s_add_u32 m0, s62, 0
    v_mfma_f32_16x16x32_bf16 v[100:103], a[92:95], a[4:7], v[100:103]
    buffer_load_dwordx4 v18, s[44:47], s52 offen offset:0 sc1 lds
    v_mfma_f32_16x16x32_bf16 v[100:103], a[88:91], a[0:3], v[100:103]
    ds_read_b64_tr_b16 a[66:67], v8 offset:2048
    v_mfma_f32_16x16x32_bf16 v[108:111], a[88:91], a[8:11], v[108:111]
    s_add_u32 s64, s64, 32768
    v_mfma_f32_16x16x32_bf16 v[108:111], a[92:95], a[12:15], v[108:111]
    s_cmp_ge_u32 s64, 98304
    s_cselect_b32 s63, 4294901760, s59
    s_cselect_b32 s64, 0, s64
    v_mfma_f32_16x16x32_bf16 v[104:107], a[84:87], a[12:15], v[104:107]
    buffer_load_dwordx4 v19, s[44:47], s52 offen offset:1024 sc1 lds
    v_mfma_f32_16x16x32_bf16 v[104:107], a[80:83], a[8:11], v[104:107]
    s_add_u32 s52, s52, s56
    ds_read_b64_tr_b16 a[68:69], v8 offset:16384
    v_mfma_f32_16x16x32_bf16 v[112:115], a[80:83], a[16:19], v[112:115]
    v_mfma_f32_16x16x32_bf16 v[112:115], a[84:87], a[20:23], v[112:115]
    v_mfma_f32_16x16x32_bf16 v[116:119], a[92:95], a[20:23], v[116:119]
    buffer_load_dwordx4 v18, s[44:47], s53 offen offset:2048 sc1 lds
    v_mfma_f32_16x16x32_bf16 v[116:119], a[88:91], a[16:19], v[116:119]
    ds_read_b64_tr_b16 a[70:71], v8 offset:18432
    v_mfma_f32_16x16x32_bf16 v[124:127], a[88:91], a[24:27], v[124:127]
    v_mfma_f32_16x16x32_bf16 v[124:127], a[92:95], a[28:31], v[124:127]
    v_mfma_f32_16x16x32_bf16 v[120:123], a[84:87], a[28:31], v[120:123]
    buffer_load_dwordx4 v19, s[44:47], s53 offen offset:3072 sc1 lds
    v_mfma_f32_16x16x32_bf16 v[120:123], a[80:83], a[24:27], v[120:123]
    s_add_u32 s53, s53, s56
    ds_read_b64_tr_b16 a[72:73], v9 offset:0
    v_mfma_f32_16x16x32_bf16 v[128:131], a[80:83], a[32:35], v[128:131]
    v_mfma_f32_16x16x32_bf16 v[128:131], a[84:87], a[36:39], v[128:131]
    s_add_u32 m0, s62, 4096
    v_mfma_f32_16x16x32_bf16 v[132:135], a[92:95], a[36:39], v[132:135]
    buffer_load_dwordx4 v20, s[44:47], s54 offen offset:0 sc1 lds
    v_mfma_f32_16x16x32_bf16 v[132:135], a[88:91], a[32:35], v[132:135]
    s_xor_b32 s62, s62, 229376
    ds_read_b64_tr_b16 a[74:75], v9 offset:2048
    v_mfma_f32_16x16x32_bf16 v[140:143], a[88:91], a[40:43], v[140:143]
    v_mfma_f32_16x16x32_bf16 v[140:143], a[92:95], a[44:47], v[140:143]
    v_mfma_f32_16x16x32_bf16 v[136:139], a[84:87], a[44:47], v[136:139]
    buffer_load_dwordx4 v21, s[44:47], s54 offen offset:1024 sc1 lds
    v_mfma_f32_16x16x32_bf16 v[136:139], a[80:83], a[40:43], v[136:139]
    s_add_u32 s54, s54, s56
    ds_read_b64_tr_b16 a[76:77], v9 offset:16384
    v_mfma_f32_16x16x32_bf16 v[144:147], a[80:83], a[48:51], v[144:147]
    v_mfma_f32_16x16x32_bf16 v[144:147], a[84:87], a[52:55], v[144:147]
    v_mfma_f32_16x16x32_bf16 v[148:151], a[92:95], a[52:55], v[148:151]
    buffer_load_dwordx4 v20, s[44:47], s55 offen offset:2048 sc1 lds
    v_mfma_f32_16x16x32_bf16 v[148:151], a[88:91], a[48:51], v[148:151]
    ds_read_b64_tr_b16 a[78:79], v9 offset:18432
    v_mfma_f32_16x16x32_bf16 v[156:159], a[88:91], a[56:59], v[156:159]
    v_add_u32 v6, s63, v6
    v_add_u32 v7, s63, v7
    v_mfma_f32_16x16x32_bf16 v[156:159], a[92:95], a[60:63], v[156:159]
    v_mfma_f32_16x16x32_bf16 v[152:155], a[84:87], a[60:63], v[152:155]
    buffer_load_dwordx4 v21, s[44:47], s55 offen offset:3072 sc1 lds
    v_mfma_f32_16x16x32_bf16 v[152:155], a[80:83], a[56:59], v[152:155]
    s_add_u32 s55, s55, s56
    v_mfma_f32_16x16x32_bf16 v[160:163], a[96:99], a[0:3], v[160:163]
    ds_read_b64_tr_b16 a[80:81], v10 offset:0
    v_mfma_f32_16x16x32_bf16 v[160:163], a[100:103], a[4:7], v[160:163]
    v_mfma_f32_16x16x32_bf16 v[164:167], a[108:111], a[4:7], v[164:167]
    v_mfma_f32_16x16x32_bf16 v[164:167], a[104:107], a[0:3], v[164:167]
    s_add_u32 m0, s61, 0
    ds_read_b64_tr_b16 a[82:83], v10 offset:2048
    v_mfma_f32_16x16x32_bf16 v[172:175], a[104:107], a[8:11], v[172:175]
    buffer_load_dwordx4 v16, s[40:43], s48 offen offset:0 sc1 lds
    v_mfma_f32_16x16x32_bf16 v[172:175], a[108:111], a[12:15], v[172:175]
    v_mfma_f32_16x16x32_bf16 v[168:171], a[100:103], a[12:15], v[168:171]
    ds_read_b64_tr_b16 a[84:85], v10 offset:16384
    v_mfma_f32_16x16x32_bf16 v[168:171], a[96:99], a[8:11], v[168:171]
    v_mfma_f32_16x16x32_bf16 v[176:179], a[96:99], a[16:19], v[176:179]
    v_mfma_f32_16x16x32_bf16 v[176:179], a[100:103], a[20:23], v[176:179]
    ds_read_b64_tr_b16 a[86:87], v10 offset:18432
    v_mfma_f32_16x16x32_bf16 v[180:183], a[108:111], a[20:23], v[180:183]
    v_mfma_f32_16x16x32_bf16 v[180:183], a[104:107], a[16:19], v[180:183]
    v_mfma_f32_16x16x32_bf16 v[188:191], a[104:107], a[24:27], v[188:191]
    buffer_load_dwordx4 v17, s[40:43], s48 offen offset:1024 sc1 lds
    v_mfma_f32_16x16x32_bf16 v[188:191], a[108:111], a[28:31], v[188:191]
    s_add_u32 s48, s48, 128
    ds_read_b64_tr_b16 a[88:89], v11 offset:0
    v_mfma_f32_16x16x32_bf16 v[184:187], a[100:103], a[28:31], v[184:187]
    v_mfma_f32_16x16x32_bf16 v[184:187], a[96:99], a[24:27], v[184:187]
    v_mfma_f32_16x16x32_bf16 v[192:195], a[96:99], a[32:35], v[192:195]
    v_mfma_f32_16x16x32_bf16 v[192:195], a[100:103], a[36:39], v[192:195]
    ds_read_b64_tr_b16 a[90:91], v11 offset:2048
    v_mfma_f32_16x16x32_bf16 v[196:199], a[108:111], a[36:39], v[196:199]
    v_mfma_f32_16x16x32_bf16 v[196:199], a[104:107], a[32:35], v[196:199]
    v_mfma_f32_16x16x32_bf16 v[204:207], a[104:107], a[40:43], v[204:207]
    buffer_load_dwordx4 v16, s[40:43], s49 offen offset:2048 sc1 lds
    v_mfma_f32_16x16x32_bf16 v[204:207], a[108:111], a[44:47], v[204:207]
    ds_read_b64_tr_b16 a[92:93], v11 offset:16384
    v_mfma_f32_16x16x32_bf16 v[200:203], a[100:103], a[44:47], v[200:203]
    v_mfma_f32_16x16x32_bf16 v[200:203], a[96:99], a[40:43], v[200:203]
    v_mfma_f32_16x16x32_bf16 v[208:211], a[96:99], a[48:51], v[208:211]
    v_mfma_f32_16x16x32_bf16 v[208:211], a[100:103], a[52:55], v[208:211]
    ds_read_b64_tr_b16 a[94:95], v11 offset:18432
    v_mfma_f32_16x16x32_bf16 v[212:215], a[108:111], a[52:55], v[212:215]
    v_mfma_f32_16x16x32_bf16 v[212:215], a[104:107], a[48:51], v[212:215]
    v_mfma_f32_16x16x32_bf16 v[220:223], a[104:107], a[56:59], v[220:223]
    buffer_load_dwordx4 v17, s[40:43], s49 offen offset:3072 sc1 lds
    v_mfma_f32_16x16x32_bf16 v[220:223], a[108:111], a[60:63], v[220:223]
    s_add_u32 s49, s49, 128
    v_mfma_f32_16x16x32_bf16 v[216:219], a[100:103], a[60:63], v[216:219]
    v_mfma_f32_16x16x32_bf16 v[216:219], a[96:99], a[56:59], v[216:219]
    v_mfma_f32_16x16x32_bf16 v[224:227], a[112:115], a[0:3], v[224:227]
    v_mfma_f32_16x16x32_bf16 v[224:227], a[116:119], a[4:7], v[224:227]
    ds_read_b64_tr_b16 a[96:97], v12 offset:0
    v_mfma_f32_16x16x32_bf16 v[228:231], a[124:127], a[4:7], v[228:231]
    v_mfma_f32_16x16x32_bf16 v[228:231], a[120:123], a[0:3], v[228:231]
    s_add_u32 m0, s61, 4096
    ds_read_b128 a[0:3], v6 offset:0
    v_mfma_f32_16x16x32_bf16 v[236:239], a[120:123], a[8:11], v[236:239]
    buffer_load_dwordx4 v16, s[40:43], s50 offen offset:0 sc1 lds
    v_mfma_f32_16x16x32_bf16 v[236:239], a[124:127], a[12:15], v[236:239]
    s_add_u32 s61, s61, 32768
    ds_read_b128 a[4:7], v7 offset:0
    v_mfma_f32_16x16x32_bf16 v[232:235], a[116:119], a[12:15], v[232:235]
    s_cmp_ge_u32 s61, 98304
    s_cselect_b32 s90, 98304, 0
    ds_read_b64_tr_b16 a[98:99], v12 offset:2048
    v_mfma_f32_16x16x32_bf16 v[232:235], a[112:115], a[8:11], v[232:235]
    s_sub_u32 s61, s61, s90
    ds_read_b128 a[8:11], v6 offset:2048
    v_mfma_f32_16x16x32_bf16 v[240:243], a[112:115], a[16:19], v[240:243]
    ds_read_b128 a[12:15], v7 offset:2048
    v_mfma_f32_16x16x32_bf16 v[240:243], a[116:119], a[20:23], v[240:243]
    ds_read_b64_tr_b16 a[100:101], v12 offset:16384
    v_mfma_f32_16x16x32_bf16 v[244:247], a[124:127], a[20:23], v[244:247]
    v_mfma_f32_16x16x32_bf16 v[244:247], a[120:123], a[16:19], v[244:247]
    ds_read_b128 a[16:19], v6 offset:4096
    v_mfma_f32_16x16x32_bf16 v[252:255], a[120:123], a[24:27], v[252:255]
    buffer_load_dwordx4 v17, s[40:43], s50 offen offset:1024 sc1 lds
    v_mfma_f32_16x16x32_bf16 v[252:255], a[124:127], a[28:31], v[252:255]
    s_add_u32 s50, s50, 128
    ds_read_b128 a[20:23], v7 offset:4096
    v_mfma_f32_16x16x32_bf16 v[248:251], a[116:119], a[28:31], v[248:251]
    ds_read_b64_tr_b16 a[102:103], v12 offset:18432
    v_mfma_f32_16x16x32_bf16 v[248:251], a[112:115], a[24:27], v[248:251]
    ds_read_b128 a[24:27], v6 offset:6144
    v_mfma_f32_16x16x32_bf16 a[224:227], a[112:115], a[32:35], a[224:227]
    s_sub_u32 s65, s65, 1
    ds_read_b128 a[28:31], v7 offset:6144
    v_mfma_f32_16x16x32_bf16 a[224:227], a[116:119], a[36:39], a[224:227]
    ds_read_b64_tr_b16 a[104:105], v13 offset:0
    v_mfma_f32_16x16x32_bf16 a[228:231], a[124:127], a[36:39], a[228:231]
    v_mfma_f32_16x16x32_bf16 a[228:231], a[120:123], a[32:35], a[228:231]
    ds_read_b128 a[32:35], v6 offset:8192
    v_mfma_f32_16x16x32_bf16 a[236:239], a[120:123], a[40:43], a[236:239]
    buffer_load_dwordx4 v16, s[40:43], s51 offen offset:2048 sc1 lds
    v_mfma_f32_16x16x32_bf16 a[236:239], a[124:127], a[44:47], a[236:239]
    ds_read_b128 a[36:39], v7 offset:8192
    v_mfma_f32_16x16x32_bf16 a[232:235], a[116:119], a[44:47], a[232:235]
    ds_read_b64_tr_b16 a[106:107], v13 offset:2048
    v_mfma_f32_16x16x32_bf16 a[232:235], a[112:115], a[40:43], a[232:235]
    ds_read_b128 a[40:43], v6 offset:10240
    v_mfma_f32_16x16x32_bf16 a[240:243], a[112:115], a[48:51], a[240:243]
    ds_read_b128 a[44:47], v7 offset:10240
    v_mfma_f32_16x16x32_bf16 a[240:243], a[116:119], a[52:55], a[240:243]
    ds_read_b64_tr_b16 a[108:109], v13 offset:16384
    v_mfma_f32_16x16x32_bf16 a[244:247], a[124:127], a[52:55], a[244:247]
    v_mfma_f32_16x16x32_bf16 a[244:247], a[120:123], a[48:51], a[244:247]
    ds_read_b128 a[48:51], v6 offset:12288
    v_mfma_f32_16x16x32_bf16 a[252:255], a[120:123], a[56:59], a[252:255]
    buffer_load_dwordx4 v17, s[40:43], s51 offen offset:3072 sc1 lds
    v_mfma_f32_16x16x32_bf16 a[252:255], a[124:127], a[60:63], a[252:255]
    s_add_u32 s51, s51, 128
    ds_read_b128 a[52:55], v7 offset:12288
    v_mfma_f32_16x16x32_bf16 a[248:251], a[116:119], a[60:63], a[248:251]
    s_cmp_gt_u32 s65, s67
    ds_read_b64_tr_b16 a[110:111], v13 offset:18432
    v_mfma_f32_16x16x32_bf16 a[248:251], a[112:115], a[56:59], a[248:251]
    ds_read_b128 a[56:59], v6 offset:14336
    ds_read_b128 a[60:63], v7 offset:14336
    s_cbranch_scc1 m_loop20
    s_cmp_eq_u32 s65, 0
    s_cbranch_scc1 m_epi15
m_dosw21:
    s_cmp_eq_u32 s94, 0
    s_cbranch_scc1 m_x39
    s_cmp_lg_u32 s65, 3
    s_cbranch_scc1 m_x45
    s_mov_b32 s42, s73
    s_lshl_b32 s90, s77, 4
    s_lshl_b32 s90, s90, s81
    s_mov_b32 s48, s79
    s_mul_i32 s91, s90, 1
    s_add_u32 s49, s91, s79
    s_sub_u32 s49, s49, 2048
    s_mul_i32 s91, s90, 2
    s_add_u32 s50, s91, s79
    s_mul_i32 s91, s90, 3
    s_add_u32 s51, s91, s79
    s_sub_u32 s51, s51, 2048
    s_lshl_b32 s90, s58, 7
    s_add_u32 s90, s90, s57
    s_lshl_b32 s91, s16, 6
    s_cmp_eq_u32 s81, 1
    s_cselect_b32 s90, s90, s91
    v_lshrrev_b32 v24, 3, v1
    v_lshlrev_b32 v24, s81, v24
    v_add_u32 v24, s90, v24
    v_mul_lo_u32 v24, v24, s77
    v_lshrrev_b32 v25, 4, v1
    v_and_b32 v26, 7, v1
    v_xor_b32 v25, v25, v26
    v_lshl_add_u32 v16, v25, 4, v24
    v_xor_b32 v25, 4, v25
    v_lshl_add_u32 v17, v25, 4, v24
    s_lshl_b32 s90, s77, 3
    s_lshl_b32 s90, s90, s81
    s_sub_u32 s90, s90, 1024
    v_add_u32 v17, s90, v17
    s_mov_b32 s40, s71
    s_mov_b32 s41, s72
    buffer_load_dwordx2 v[4:5], off, s[12:15], 0 sc1
    s_branch m_loop20
m_x45:
    s_mov_b32 s46, s76
    s_mov_b32 s52, s80
    s_lshl_b32 s90, s78, 2
    s_mul_i32 s91, s90, 1
    s_add_u32 s53, s91, s80
    s_sub_u32 s53, s53, 2048
    s_mul_i32 s91, s90, 2
    s_add_u32 s54, s91, s80
    s_mul_i32 s91, s90, 3
    s_add_u32 s55, s91, s80
    s_sub_u32 s55, s55, 2048
    s_lshl_b32 s56, s78, 6
    v_lshrrev_b32 v24, 5, v1
    s_lshl_b32 s90, s16, 4
    v_add_u32 v25, s90, v24
    v_mul_lo_u32 v25, v25, s78
    v_lshlrev_b32 v24, 1, v24
    v_and_b32 v26, 31, v1
    v_xor_b32 v24, v24, v26
    s_lshl_b32 s90, s78, 1
    s_sub_u32 s90, s90, 1024
    v_add_u32 v27, s90, v25
    v_xor_b32 v26, 0, v24
    v_lshl_add_u32 v18, v26, 4, v25
    v_xor_b32 v26, 4, v24
    v_lshl_add_u32 v19, v26, 4, v27
    v_xor_b32 v26, 8, v24
    v_lshl_add_u32 v20, v26, 4, v25
    v_xor_b32 v26, 12, v24
    v_lshl_add_u32 v21, v26, 4, v27
    s_mov_b32 s44, s74
    s_mov_b32 s45, s75
    s_mov_b32 s67, 0
    s_branch m_loop20
m_x39:
    s_cmp_le_u32 s65, 4
    s_cbranch_scc1 m_x40
    s_cmp_lg_u32 s16, 0
    s_cbranch_scc1 m_np46
    v_mov_b32 v4, s4
    v_mov_b32 v5, s5
    s_add_u32 s90, s17, 117440512
    s_mov_b64 exec, 1
    buffer_store_dwordx2 v[4:5], off, s[8:11], s90 sc1
    s_mov_b64 exec, -1
m_np46:
    s_mov_b32 s17, -1
    s_mov_b32 s67, 4
    s_branch m_loop20
m_x40:
    s_cmp_lg_u32 s65, 4
    s_cbranch_scc1 m_x41
    s_cmp_eq_u32 s70, 1
    s_cbranch_scc1 m_ea47
    buffer_load_dwordx2 v[4:5], v0, s[8:11], s37 offen sc1
m_eb48:
    s_branch m_loop20
m_x41:
    s_waitcnt vmcnt(16)
    s_cmp_lg_u32 s65, 3
    s_cbranch_scc1 m_x42
    s_cmp_eq_u32 s70, 1
    s_cbranch_scc1 m_ea49
    s_mov_b32 s3, 262144
m_spin51:
    v_cmp_ne_u64 s[22:23], s[4:5], v[4:5]
    s_nop 3
    s_cmp_eq_u64 s[22:23], 0
    s_cbranch_scc1 m_ok52
    s_sub_u32 s3, s3, 1
    s_cbranch_scc1 m_ok52
    s_sleep 16
    buffer_load_dwordx2 v[4:5], v0, s[8:11], s37 offen sc1
    s_waitcnt vmcnt(0)
    s_branch m_spin51
m_ok52:
    buffer_load_dwordx4 a[128:131], v2, s[8:11], s33 offen offset:0 sc1
    buffer_load_dwordx4 a[132:135], v2, s[8:11], s33 offen offset:1024 sc1
    buffer_load_dwordx4 a[136:139], v2, s[8:11], s33 offen offset:2048 sc1
    buffer_load_dwordx4 a[140:143], v2, s[8:11], s33 offen offset:3072 sc1
    buffer_load_dwordx4 a[144:147], v2, s[8:11], s34 offen offset:0 sc1
    buffer_load_dwordx4 a[148:151], v2, s[8:11], s34 offen offset:1024 sc1
m_eb50:
    s_add_u32 s48, s32, 0
    s_mov_b32 s49, s48
    s_add_u32 s50, s48, 4096
    s_mov_b32 s51, s50
    s_cmp_eq_u32 s57, 0
    s_cselect_b32 s42, 268435456, 0
    s_mov_b32 s40, s6
    s_mov_b32 s41, s7
    v_mov_b32 v16, v2
    v_mov_b32 v17, v2
    s_branch m_loop20
m_x42:
    s_cmp_lg_u32 s65, 2
    s_cbranch_scc1 m_x43
    s_cmp_eq_u32 s70, 1
    s_cbranch_scc1 m_ea53
    buffer_load_dwordx4 a[152:155], v2, s[8:11], s34 offen offset:2048 sc1
    buffer_load_dwordx4 a[156:159], v2, s[8:11], s34 offen offset:3072 sc1
    buffer_load_dwordx4 a[160:163], v2, s[8:11], s35 offen offset:0 sc1
    buffer_load_dwordx4 a[164:167], v2, s[8:11], s35 offen offset:1024 sc1
    buffer_load_dwordx4 a[168:171], v2, s[8:11], s35 offen offset:2048 sc1
m_eb54:
    s_add_u32 s48, s32, 16384
    s_mov_b32 s49, s48
    s_add_u32 s50, s48, 4096
    s_mov_b32 s51, s50
    s_mov_b32 s42, 268435456
    s_add_u32 s52, s32, 49152
    s_mov_b32 s53, s52
    s_add_u32 s54, s52, 4096
    s_mov_b32 s55, s54
    s_mov_b32 s46, 268435456
    s_mov_b32 s44, s6
    s_mov_b32 s45, s7
    v_mov_b32 v18, v2
    v_mov_b32 v19, v2
    v_mov_b32 v20, v2
    v_mov_b32 v21, v2
    s_branch m_loop20
m_x43:
    s_cmp_eq_u32 s70, 1
    s_cbranch_scc1 m_ea55
    buffer_load_dwordx4 a[172:175], v2, s[8:11], s35 offen offset:3072 sc1
    buffer_load_dwordx4 a[176:179], v2, s[8:11], s36 offen offset:0 sc1
    buffer_load_dwordx4 a[180:183], v2, s[8:11], s36 offen offset:1024 sc1
    buffer_load_dwordx4 a[184:187], v2, s[8:11], s36 offen offset:2048 sc1
    buffer_load_dwordx4 a[188:191], v2, s[8:11], s36 offen offset:3072 sc1
m_eb56:
    s_add_u32 s48, s32, 32768
    s_mov_b32 s49, s48
    s_add_u32 s50, s48, 4096
    s_mov_b32 s51, s50
    s_add_u32 s52, s32, 65536
    s_mov_b32 s53, s52
    s_add_u32 s54, s52, 4096
    s_mov_b32 s55, s54
    s_branch m_loop20
m_ea47:
    s_and_b32 s92, s2, 7
    s_lshl_b32 s92, s92, 2
    s_bfe_u32 s93, s2, 0x20003
    s_add_u32 s92, s92, s93
    s_lshr_b32 s93, s2, 5
    s_lshl_b32 s93, s93, 2
    s_or_b32 s93, s93, 0x40000
    v_and_b32 v0, 3, v1
    v_min_u32 v0, 2, v0
    v_and_b32 v24, 4, v1
    v_add3_u32 v0, v0, v24, 8
    v_lshlrev_b32 v0, 3, v0
    buffer_load_dwordx2 v[4:5], v0, s[8:11], s37 offen sc1
    s_branch m_eb48
m_ea49:
    s_mov_b32 s3, 262144
m_spin57:
    v_cmp_ne_u64 s[22:23], s[4:5], v[4:5]
    s_nop 3
    s_cmp_eq_u64 s[22:23], 0
    s_cbranch_scc1 m_ok58
    s_sub_u32 s3, s3, 1
    s_cbranch_scc1 m_ok58
    s_sleep 16
    buffer_load_dwordx2 v[4:5], v0, s[8:11], s37 offen sc1
    s_waitcnt vmcnt(0)
    s_branch m_spin57
m_ok58:
    s_branch m_eb50
m_ea53:
    s_and_b32 s92, s2, 7
    s_lshl_b32 s92, s92, 2
    s_bfe_u32 s93, s2, 0x20003
    s_add_u32 s92, s92, s93
    s_lshr_b32 s93, s2, 5
    s_lshl_b32 s93, s93, 2
    s_or_b32 s93, s93, 0x40000
    s_bfe_u32 s91, 873484918, s93
    s_lshr_b32 s91, s91, 1
    v_mov_b32 v0, s91
    s_bfe_u32 s91, 4225674377, s93
    s_lshr_b32 s91, s91, 1
    v_writelane_b32 v0, s91, 8
    v_lshlrev_b32 v0, 3, v0
    buffer_load_dwordx2 v[4:5], v0, s[8:11], s37 offen sc1
    s_branch m_eb54
m_ea55:
    s_mov_b32 s3, 262144
m_spin59:
    v_cmp_ne_u64 s[22:23], s[4:5], v[4:5]
    s_nop 3
    s_cmp_eq_u64 s[22:23], 0
    s_cbranch_scc1 m_ok60
    s_sub_u32 s3, s3, 1
    s_cbranch_scc1 m_ok60
    s_sleep 16
    buffer_load_dwordx2 v[4:5], v0, s[8:11], s37 offen sc1
    s_waitcnt vmcnt(0)
    s_branch m_spin59
m_ok60:
    buffer_load_dwordx4 a[128:131], v2, s[8:11], s33 offen offset:0 sc1
    buffer_load_dwordx4 a[132:135], v2, s[8:11], s33 offen offset:1024 sc1
    buffer_load_dwordx4 a[136:139], v2, s[8:11], s33 offen offset:2048 sc1
    buffer_load_dwordx4 a[140:143], v2, s[8:11], s33 offen offset:3072 sc1
    buffer_load_dwordx4 a[144:147], v2, s[8:11], s34 offen offset:0 sc1
    buffer_load_dwordx4 a[148:151], v2, s[8:11], s34 offen offset:1024 sc1
    buffer_load_dwordx4 a[152:155], v2, s[8:11], s34 offen offset:2048 sc1
    buffer_load_dwordx4 a[156:159], v2, s[8:11], s34 offen offset:3072 sc1
    buffer_load_dwordx4 a[160:163], v2, s[8:11], s35 offen offset:0 sc1
    buffer_load_dwordx4 a[164:167], v2, s[8:11], s35 offen offset:1024 sc1
    buffer_load_dwordx4 a[168:171], v2, s[8:11], s35 offen offset:2048 sc1
    buffer_load_dwordx4 a[172:175], v2, s[8:11], s35 offen offset:3072 sc1
    buffer_load_dwordx4 a[176:179], v2, s[8:11], s36 offen offset:0 sc1
    buffer_load_dwordx4 a[180:183], v2, s[8:11], s36 offen offset:1024 sc1
    buffer_load_dwordx4 a[184:187], v2, s[8:11], s36 offen offset:2048 sc1
    buffer_load_dwordx4 a[188:191], v2, s[8:11], s36 offen offset:3072 sc1
    s_branch m_eb56
m_swp16:
    s_waitcnt lgkmcnt(15)
    v_mfma_f32_16x16x32_bf16 v[32:35], a[0:3], a[64:67], 0
    ds_read_b64_tr_b16 a[112:113], v14 offset:0
    v_mfma_f32_16x16x32_bf16 v[32:35], a[4:7], a[68:71], v[32:35]
    ds_read_b64_tr_b16 a[114:115], v14 offset:2048
    v_mfma_f32_16x16x32_bf16 v[40:43], a[4:7], a[76:79], 0
    ds_read_b64_tr_b16 a[116:117], v14 offset:16384
    v_mfma_f32_16x16x32_bf16 v[40:43], a[0:3], a[72:75], v[40:43]
    ds_read_b64_tr_b16 a[118:119], v14 offset:18432
    v_mfma_f32_16x16x32_bf16 v[44:47], a[8:11], a[72:75], 0
    ds_read_b64_tr_b16 a[120:121], v15 offset:0
    v_mfma_f32_16x16x32_bf16 v[44:47], a[12:15], a[76:79], v[44:47]
    ds_read_b64_tr_b16 a[122:123], v15 offset:2048
    v_mfma_f32_16x16x32_bf16 v[36:39], a[12:15], a[68:71], 0
    ds_read_b64_tr_b16 a[124:125], v15 offset:16384
    v_mfma_f32_16x16x32_bf16 v[36:39], a[8:11], a[64:67], v[36:39]
    ds_read_b64_tr_b16 a[126:127], v15 offset:18432
    v_mfma_f32_16x16x32_bf16 v[96:99], a[16:19], a[64:67], 0
    v_mfma_f32_16x16x32_bf16 v[96:99], a[20:23], a[68:71], v[96:99]
    v_mfma_f32_16x16x32_bf16 v[104:107], a[20:23], a[76:79], 0
    buffer_store_dwordx4 a[128:131], v2, s[24:27], s28 offen sc1
    v_mfma_f32_16x16x32_bf16 v[104:107], a[16:19], a[72:75], v[104:107]
    s_add_u32 s28, s28, s31
    s_waitcnt lgkmcnt(15)
    v_mfma_f32_16x16x32_bf16 v[108:111], a[24:27], a[72:75], 0
    v_xor_b32 v8, s60, v8
    v_xor_b32 v9, s60, v9
    v_mfma_f32_16x16x32_bf16 v[108:111], a[28:31], a[76:79], v[108:111]
    v_xor_b32 v10, s60, v10
    v_xor_b32 v11, s60, v11
    v_mfma_f32_16x16x32_bf16 v[100:103], a[28:31], a[68:71], 0
    v_xor_b32 v12, s60, v12
    v_xor_b32 v13, s60, v13
    v_mfma_f32_16x16x32_bf16 v[100:103], a[24:27], a[64:67], v[100:103]
    v_xor_b32 v14, s60, v14
    v_xor_b32 v15, s60, v15
    v_mfma_f32_16x16x32_bf16 v[160:163], a[32:35], a[64:67], 0
    buffer_store_dwordx4 a[132:135], v2, s[24:27], s28 offen sc1
    v_mfma_f32_16x16x32_bf16 v[160:163], a[36:39], a[68:71], v[160:163]
    s_add_u32 s28, s28, s31
    v_mfma_f32_16x16x32_bf16 v[168:171], a[36:39], a[76:79], 0
    v_mfma_f32_16x16x32_bf16 v[168:171], a[32:35], a[72:75], v[168:171]
    s_waitcnt lgkmcnt(14)
    v_mfma_f32_16x16x32_bf16 v[172:175], a[40:43], a[72:75], 0
    v_mfma_f32_16x16x32_bf16 v[172:175], a[44:47], a[76:79], v[172:175]
    v_mfma_f32_16x16x32_bf16 v[164:167], a[44:47], a[68:71], 0
    buffer_store_dwordx4 a[136:139], v2, s[24:27], s28 offen sc1
    v_mfma_f32_16x16x32_bf16 v[164:167], a[40:43], a[64:67], v[164:167]
    s_add_u32 s28, s28, s31
    s_waitcnt lgkmcnt(11)
    v_mfma_f32_16x16x32_bf16 v[224:227], a[48:51], a[64:67], 0
    v_mfma_f32_16x16x32_bf16 v[224:227], a[52:55], a[68:71], v[224:227]
    v_mfma_f32_16x16x32_bf16 v[232:235], a[52:55], a[76:79], 0
    v_mfma_f32_16x16x32_bf16 v[232:235], a[48:51], a[72:75], v[232:235]
    s_waitcnt lgkmcnt(8)
    v_mfma_f32_16x16x32_bf16 v[236:239], a[56:59], a[72:75], 0
    buffer_store_dwordx4 a[140:143], v2, s[24:27], s28 offen sc1
    v_mfma_f32_16x16x32_bf16 v[236:239], a[60:63], a[76:79], v[236:239]
    s_add_u32 s28, s28, s31
    v_mfma_f32_16x16x32_bf16 v[228:231], a[60:63], a[68:71], 0
    s_waitcnt vmcnt(44) lgkmcnt(0)
    s_cmp_eq_u32 s66, 2
    s_cbranch_scc1 m_w22
    s_waitcnt vmcnt(12)
m_w22:
    v_mfma_f32_16x16x32_bf16 v[228:231], a[56:59], a[64:67], v[228:231]
    s_barrier
    v_mfma_f32_16x16x32_bf16 v[48:51], a[0:3], a[80:83], 0
    ds_read_b64_tr_b16 a[64:65], v8 offset:0
    v_mfma_f32_16x16x32_bf16 v[48:51], a[4:7], a[84:87], v[48:51]
    s_add_u32 m0, s62, 0
    v_mfma_f32_16x16x32_bf16 v[56:59], a[4:7], a[92:95], 0
    buffer_load_dwordx4 v18, s[44:47], s52 offen offset:0 sc1 lds
    v_mfma_f32_16x16x32_bf16 v[56:59], a[0:3], a[88:91], v[56:59]
    ds_read_b64_tr_b16 a[66:67], v8 offset:2048
    v_mfma_f32_16x16x32_bf16 v[60:63], a[8:11], a[88:91], 0
    s_add_u32 s64, s64, 32768
    v_mfma_f32_16x16x32_bf16 v[60:63], a[12:15], a[92:95], v[60:63]
    s_cmp_ge_u32 s64, 98304
    s_cselect_b32 s63, 4294901760, s59
    s_cselect_b32 s64, 0, s64
    v_mfma_f32_16x16x32_bf16 v[52:55], a[12:15], a[84:87], 0
    buffer_load_dwordx4 v19, s[44:47], s52 offen offset:1024 sc1 lds
    v_mfma_f32_16x16x32_bf16 v[52:55], a[8:11], a[80:83], v[52:55]
    s_add_u32 s52, s52, s56
    ds_read_b64_tr_b16 a[68:69], v8 offset:16384
    v_mfma_f32_16x16x32_bf16 v[112:115], a[16:19], a[80:83], 0
    v_mfma_f32_16x16x32_bf16 v[112:115], a[20:23], a[84:87], v[112:115]
    v_mfma_f32_16x16x32_bf16 v[120:123], a[20:23], a[92:95], 0
    buffer_load_dwordx4 v18, s[44:47], s53 offen offset:2048 sc1 lds
    v_mfma_f32_16x16x32_bf16 v[120:123], a[16:19], a[88:91], v[120:123]
    ds_read_b64_tr_b16 a[70:71], v8 offset:18432
    v_mfma_f32_16x16x32_bf16 v[124:127], a[24:27], a[88:91], 0
    v_mfma_f32_16x16x32_bf16 v[124:127], a[28:31], a[92:95], v[124:127]
    v_mfma_f32_16x16x32_bf16 v[116:119], a[28:31], a[84:87], 0
    buffer_load_dwordx4 v19, s[44:47], s53 offen offset:3072 sc1 lds
    v_mfma_f32_16x16x32_bf16 v[116:119], a[24:27], a[80:83], v[116:119]
    s_add_u32 s53, s53, s56
    ds_read_b64_tr_b16 a[72:73], v9 offset:0
    v_mfma_f32_16x16x32_bf16 v[176:179], a[32:35], a[80:83], 0
    v_mfma_f32_16x16x32_bf16 v[176:179], a[36:39], a[84:87], v[176:179]
    s_add_u32 m0, s62, 4096
    v_mfma_f32_16x16x32_bf16 v[184:187], a[36:39], a[92:95], 0
    buffer_load_dwordx4 v20, s[44:47], s54 offen offset:0 sc1 lds
    v_mfma_f32_16x16x32_bf16 v[184:187], a[32:35], a[88:91], v[184:187]
    s_xor_b32 s62, s62, 229376
    ds_read_b64_tr_b16 a[74:75], v9 offset:2048
    v_mfma_f32_16x16x32_bf16 v[188:191], a[40:43], a[88:91], 0
    v_mfma_f32_16x16x32_bf16 v[188:191], a[44:47], a[92:95], v[188:191]
    v_mfma_f32_16x16x32_bf16 v[180:183], a[44:47], a[84:87], 0
    buffer_load_dwordx4 v21, s[44:47], s54 offen offset:1024 sc1 lds
    v_mfma_f32_16x16x32_bf16 v[180:183], a[40:43], a[80:83], v[180:183]
    s_add_u32 s54, s54, s56
    ds_read_b64_tr_b16 a[76:77], v9 offset:16384
    v_mfma_f32_16x16x32_bf16 v[240:243], a[48:51], a[80:83], 0
    v_mfma_f32_16x16x32_bf16 v[240:243], a[52:55], a[84:87], v[240:243]
    v_mfma_f32_16x16x32_bf16 v[248:251], a[52:55], a[92:95], 0
    buffer_load_dwordx4 v20, s[44:47], s55 offen offset:2048 sc1 lds
    v_mfma_f32_16x16x32_bf16 v[248:251], a[48:51], a[88:91], v[248:251]
    ds_read_b64_tr_b16 a[78:79], v9 offset:18432
    v_mfma_f32_16x16x32_bf16 v[252:255], a[56:59], a[88:91], 0
    v_add_u32 v6, s63, v6
    v_add_u32 v7, s63, v7
    v_mfma_f32_16x16x32_bf16 v[252:255], a[60:63], a[92:95], v[252:255]
    v_mfma_f32_16x16x32_bf16 v[244:247], a[60:63], a[84:87], 0
    buffer_load_dwordx4 v21, s[44:47], s55 offen offset:3072 sc1 lds
    v_mfma_f32_16x16x32_bf16 v[244:247], a[56:59], a[80:83], v[244:247]
    s_add_u32 s55, s55, s56
    v_mfma_f32_16x16x32_bf16 v[64:67], a[0:3], a[96:99], 0
    ds_read_b64_tr_b16 a[80:81], v10 offset:0
    v_mfma_f32_16x16x32_bf16 v[64:67], a[4:7], a[100:103], v[64:67]
    v_mfma_f32_16x16x32_bf16 v[72:75], a[4:7], a[108:111], 0
    v_mfma_f32_16x16x32_bf16 v[72:75], a[0:3], a[104:107], v[72:75]
    s_add_u32 m0, s61, 0
    ds_read_b64_tr_b16 a[82:83], v10 offset:2048
    v_mfma_f32_16x16x32_bf16 v[76:79], a[8:11], a[104:107], 0
    buffer_load_dwordx4 v16, s[40:43], s48 offen offset:0 sc1 lds
    v_mfma_f32_16x16x32_bf16 v[76:79], a[12:15], a[108:111], v[76:79]
    v_mfma_f32_16x16x32_bf16 v[68:71], a[12:15], a[100:103], 0
    ds_read_b64_tr_b16 a[84:85], v10 offset:16384
    v_mfma_f32_16x16x32_bf16 v[68:71], a[8:11], a[96:99], v[68:71]
    v_mfma_f32_16x16x32_bf16 v[128:131], a[16:19], a[96:99], 0
    buffer_store_dwordx4 a[144:147], v2, s[24:27], s28 offen sc1
    v_mfma_f32_16x16x32_bf16 v[128:131], a[20:23], a[100:103], v[128:131]
    s_add_u32 s28, s28, s31
    ds_read_b64_tr_b16 a[86:87], v10 offset:18432
    v_mfma_f32_16x16x32_bf16 v[136:139], a[20:23], a[108:111], 0
    v_mfma_f32_16x16x32_bf16 v[136:139], a[16:19], a[104:107], v[136:139]
    v_mfma_f32_16x16x32_bf16 v[140:143], a[24:27], a[104:107], 0
    buffer_load_dwordx4 v17, s[40:43], s48 offen offset:1024 sc1 lds
    v_mfma_f32_16x16x32_bf16 v[140:143], a[28:31], a[108:111], v[140:143]
    s_add_u32 s48, s48, 128
    ds_read_b64_tr_b16 a[88:89], v11 offset:0
    v_mfma_f32_16x16x32_bf16 v[132:135], a[28:31], a[100:103], 0
    v_mfma_f32_16x16x32_bf16 v[132:135], a[24:27], a[96:99], v[132:135]
    v_mfma_f32_16x16x32_bf16 v[192:195], a[32:35], a[96:99], 0
    buffer_store_dwordx4 a[148:151], v2, s[24:27], s28 offen sc1
    v_mfma_f32_16x16x32_bf16 v[192:195], a[36:39], a[100:103], v[192:195]
    s_add_u32 s28, s28, s31
    ds_read_b64_tr_b16 a[90:91], v11 offset:2048
    v_mfma_f32_16x16x32_bf16 v[200:203], a[36:39], a[108:111], 0
    v_mfma_f32_16x16x32_bf16 v[200:203], a[32:35], a[104:107], v[200:203]
    v_mfma_f32_16x16x32_bf16 v[204:207], a[40:43], a[104:107], 0
    buffer_load_dwordx4 v16, s[40:43], s49 offen offset:2048 sc1 lds
    v_mfma_f32_16x16x32_bf16 v[204:207], a[44:47], a[108:111], v[204:207]
    ds_read_b64_tr_b16 a[92:93], v11 offset:16384
    v_mfma_f32_16x16x32_bf16 v[196:199], a[44:47], a[100:103], 0
    v_mfma_f32_16x16x32_bf16 v[196:199], a[40:43], a[96:99], v[196:199]
    v_mfma_f32_16x16x32_bf16 a[224:227], a[48:51], a[96:99], 0
    buffer_store_dwordx4 a[152:155], v2, s[24:27], s28 offen sc1
    v_mfma_f32_16x16x32_bf16 a[224:227], a[52:55], a[100:103], a[224:227]
    s_add_u32 s28, s28, s31
    ds_read_b64_tr_b16 a[94:95], v11 offset:18432
    v_mfma_f32_16x16x32_bf16 a[232:235], a[52:55], a[108:111], 0
    v_mfma_f32_16x16x32_bf16 a[232:235], a[48:51], a[104:107], a[232:235]
    v_mfma_f32_16x16x32_bf16 a[236:239], a[56:59], a[104:107], 0
    buffer_load_dwordx4 v17, s[40:43], s49 offen offset:3072 sc1 lds
    v_mfma_f32_16x16x32_bf16 a[236:239], a[60:63], a[108:111], a[236:239]
    s_add_u32 s49, s49, 128
    v_mfma_f32_16x16x32_bf16 a[228:231], a[60:63], a[100:103], 0
    buffer_store_dwordx4 a[156:159], v2, s[24:27], s28 offen sc1
    v_mfma_f32_16x16x32_bf16 a[228:231], a[56:59], a[96:99], a[228:231]
    s_add_u32 s29, s29, s30
    s_mov_b32 s28, s29
    v_mfma_f32_16x16x32_bf16 v[80:83], a[0:3], a[112:115], 0
    v_mfma_f32_16x16x32_bf16 v[80:83], a[4:7], a[116:119], v[80:83]
    ds_read_b64_tr_b16 a[96:97], v12 offset:0
    v_mfma_f32_16x16x32_bf16 v[88:91], a[4:7], a[124:127], 0
    v_mfma_f32_16x16x32_bf16 v[88:91], a[0:3], a[120:123], v[88:91]
    s_add_u32 m0, s61, 4096
    ds_read_b128 a[0:3], v6 offset:0
    v_mfma_f32_16x16x32_bf16 v[92:95], a[8:11], a[120:123], 0
    buffer_load_dwordx4 v16, s[40:43], s50 offen offset:0 sc1 lds
    v_mfma_f32_16x16x32_bf16 v[92:95], a[12:15], a[124:127], v[92:95]
    s_add_u32 s61, s61, 32768
    ds_read_b128 a[4:7], v7 offset:0
    v_mfma_f32_16x16x32_bf16 v[84:87], a[12:15], a[116:119], 0
    s_cmp_ge_u32 s61, 98304
    s_cselect_b32 s90, 98304, 0
    ds_read_b64_tr_b16 a[98:99], v12 offset:2048
    v_mfma_f32_16x16x32_bf16 v[84:87], a[8:11], a[112:115], v[84:87]
    s_sub_u32 s61, s61, s90
    ds_read_b128 a[8:11], v6 offset:2048
    v_mfma_f32_16x16x32_bf16 v[144:147], a[16:19], a[112:115], 0
    ds_read_b128 a[12:15], v7 offset:2048
    v_mfma_f32_16x16x32_bf16 v[144:147], a[20:23], a[116:119], v[144:147]
    ds_read_b64_tr_b16 a[100:101], v12 offset:16384
    v_mfma_f32_16x16x32_bf16 v[152:155], a[20:23], a[124:127], 0
    v_mfma_f32_16x16x32_bf16 v[152:155], a[16:19], a[120:123], v[152:155]
    ds_read_b128 a[16:19], v6 offset:4096
    v_mfma_f32_16x16x32_bf16 v[156:159], a[24:27], a[120:123], 0
    buffer_load_dwordx4 v17, s[40:43], s50 offen offset:1024 sc1 lds
    v_mfma_f32_16x16x32_bf16 v[156:159], a[28:31], a[124:127], v[156:159]
    s_add_u32 s50, s50, 128
    ds_read_b128 a[20:23], v7 offset:4096
    v_mfma_f32_16x16x32_bf16 v[148:151], a[28:31], a[116:119], 0
    ds_read_b64_tr_b16 a[102:103], v12 offset:18432
    v_mfma_f32_16x16x32_bf16 v[148:151], a[24:27], a[112:115], v[148:151]
    ds_read_b128 a[24:27], v6 offset:6144
    v_mfma_f32_16x16x32_bf16 v[208:211], a[32:35], a[112:115], 0
    s_sub_u32 s65, s65, 1
    ds_read_b128 a[28:31], v7 offset:6144
    v_mfma_f32_16x16x32_bf16 v[208:211], a[36:39], a[116:119], v[208:211]
    ds_read_b64_tr_b16 a[104:105], v13 offset:0
    v_mfma_f32_16x16x32_bf16 v[216:219], a[36:39], a[124:127], 0
    v_mfma_f32_16x16x32_bf16 v[216:219], a[32:35], a[120:123], v[216:219]
    ds_read_b128 a[32:35], v6 offset:8192
    v_mfma_f32_16x16x32_bf16 v[220:223], a[40:43], a[120:123], 0
    buffer_load_dwordx4 v16, s[40:43], s51 offen offset:2048 sc1 lds
    v_mfma_f32_16x16x32_bf16 v[220:223], a[44:47], a[124:127], v[220:223]
    ds_read_b128 a[36:39], v7 offset:8192
    v_mfma_f32_16x16x32_bf16 v[212:215], a[44:47], a[116:119], 0
    ds_read_b64_tr_b16 a[106:107], v13 offset:2048
    v_mfma_f32_16x16x32_bf16 v[212:215], a[40:43], a[112:115], v[212:215]
    ds_read_b128 a[40:43], v6 offset:10240
    v_mfma_f32_16x16x32_bf16 a[240:243], a[48:51], a[112:115], 0
    ds_read_b128 a[44:47], v7 offset:10240
    v_mfma_f32_16x16x32_bf16 a[240:243], a[52:55], a[116:119], a[240:243]
    ds_read_b64_tr_b16 a[108:109], v13 offset:16384
    v_mfma_f32_16x16x32_bf16 a[248:251], a[52:55], a[124:127], 0
    v_mfma_f32_16x16x32_bf16 a[248:251], a[48:51], a[120:123], a[248:251]
    ds_read_b128 a[48:51], v6 offset:12288
    v_mfma_f32_16x16x32_bf16 a[252:255], a[56:59], a[120:123], 0
    buffer_load_dwordx4 v17, s[40:43], s51 offen offset:3072 sc1 lds
    v_mfma_f32_16x16x32_bf16 a[252:255], a[60:63], a[124:127], a[252:255]
    s_add_u32 s51, s51, 128
    ds_read_b128 a[52:55], v7 offset:12288
    v_mfma_f32_16x16x32_bf16 a[244:247], a[60:63], a[116:119], 0
    ds_read_b64_tr_b16 a[110:111], v13 offset:18432
    v_mfma_f32_16x16x32_bf16 a[244:247], a[56:59], a[112:115], a[244:247]
    ds_read_b128 a[56:59], v6 offset:14336
    ds_read_b128 a[60:63], v7 offset:14336
    s_waitcnt lgkmcnt(15)
    v_mfma_f32_16x16x32_bf16 v[32:35], a[0:3], a[64:67], v[32:35]
    ds_read_b64_tr_b16 a[112:113], v14 offset:0
    v_mfma_f32_16x16x32_bf16 v[32:35], a[4:7], a[68:71], v[32:35]
    ds_read_b64_tr_b16 a[114:115], v14 offset:2048
    v_mfma_f32_16x16x32_bf16 v[40:43], a[4:7], a[76:79], v[40:43]
    ds_read_b64_tr_b16 a[116:117], v14 offset:16384
    v_mfma_f32_16x16x32_bf16 v[40:43], a[0:3], a[72:75], v[40:43]
    ds_read_b64_tr_b16 a[118:119], v14 offset:18432
    v_mfma_f32_16x16x32_bf16 v[44:47], a[8:11], a[72:75], v[44:47]
    ds_read_b64_tr_b16 a[120:121], v15 offset:0
    v_mfma_f32_16x16x32_bf16 v[44:47], a[12:15], a[76:79], v[44:47]
    ds_read_b64_tr_b16 a[122:123], v15 offset:2048
    v_mfma_f32_16x16x32_bf16 v[36:39], a[12:15], a[68:71], v[36:39]
    ds_read_b64_tr_b16 a[124:125], v15 offset:16384
    v_mfma_f32_16x16x32_bf16 v[36:39], a[8:11], a[64:67], v[36:39]
    ds_read_b64_tr_b16 a[126:127], v15 offset:18432
    v_mfma_f32_16x16x32_bf16 v[96:99], a[16:19], a[64:67], v[96:99]
    v_mfma_f32_16x16x32_bf16 v[96:99], a[20:23], a[68:71], v[96:99]
    v_mfma_f32_16x16x32_bf16 v[104:107], a[20:23], a[76:79], v[104:107]
    buffer_store_dwordx4 a[160:163], v2, s[24:27], s28 offen sc1
    v_mfma_f32_16x16x32_bf16 v[104:107], a[16:19], a[72:75], v[104:107]
    s_add_u32 s28, s28, s31
    s_waitcnt lgkmcnt(15)
    v_mfma_f32_16x16x32_bf16 v[108:111], a[24:27], a[72:75], v[108:111]
    v_xor_b32 v8, s60, v8
    v_xor_b32 v9, s60, v9
    v_mfma_f32_16x16x32_bf16 v[108:111], a[28:31], a[76:79], v[108:111]
    v_xor_b32 v10, s60, v10
    v_xor_b32 v11, s60, v11
    v_mfma_f32_16x16x32_bf16 v[100:103], a[28:31], a[68:71], v[100:103]
    v_xor_b32 v12, s60, v12
    v_xor_b32 v13, s60, v13
    v_mfma_f32_16x16x32_bf16 v[100:103], a[24:27], a[64:67], v[100:103]
    v_xor_b32 v14, s60, v14
    v_xor_b32 v15, s60, v15
    v_mfma_f32_16x16x32_bf16 v[160:163], a[32:35], a[64:67], v[160:163]
    buffer_store_dwordx4 a[164:167], v2, s[24:27], s28 offen sc1
    v_mfma_f32_16x16x32_bf16 v[160:163], a[36:39], a[68:71], v[160:163]
    s_add_u32 s28, s28, s31
    v_mfma_f32_16x16x32_bf16 v[168:171], a[36:39], a[76:79], v[168:171]
    v_mfma_f32_16x16x32_bf16 v[168:171], a[32:35], a[72:75], v[168:171]
    s_waitcnt lgkmcnt(14)
    v_mfma_f32_16x16x32_bf16 v[172:175], a[40:43], a[72:75], v[172:175]
    v_mfma_f32_16x16x32_bf16 v[172:175], a[44:47], a[76:79], v[172:175]
    v_mfma_f32_16x16x32_bf16 v[164:167], a[44:47], a[68:71], v[164:167]
    buffer_store_dwordx4 a[168:171], v2, s[24:27], s28 offen sc1
    v_mfma_f32_16x16x32_bf16 v[164:167], a[40:43], a[64:67], v[164:167]
    s_add_u32 s28, s28, s31
    s_waitcnt lgkmcnt(11)
    v_mfma_f32_16x16x32_bf16 v[224:227], a[48:51], a[64:67], v[224:227]
    v_mfma_f32_16x16x32_bf16 v[224:227], a[52:55], a[68:71], v[224:227]
    v_mfma_f32_16x16x32_bf16 v[232:235], a[52:55], a[76:79], v[232:235]
    v_mfma_f32_16x16x32_bf16 v[232:235], a[48:51], a[72:75], v[232:235]
    s_waitcnt lgkmcnt(8)
    v_mfma_f32_16x16x32_bf16 v[236:239], a[56:59], a[72:75], v[236:239]
    buffer_store_dwordx4 a[172:175], v2, s[24:27], s28 offen sc1
    v_mfma_f32_16x16x32_bf16 v[236:239], a[60:63], a[76:79], v[236:239]
    s_add_u32 s28, s28, s31
    v_mfma_f32_16x16x32_bf16 v[228:231], a[60:63], a[68:71], v[228:231]
    s_waitcnt vmcnt(16) lgkmcnt(0)
    v_mfma_f32_16x16x32_bf16 v[228:231], a[56:59], a[64:67], v[228:231]
    s_barrier
    v_mfma_f32_16x16x32_bf16 v[48:51], a[0:3], a[80:83], v[48:51]
    ds_read_b64_tr_b16 a[64:65], v8 offset:0
    v_mfma_f32_16x16x32_bf16 v[48:51], a[4:7], a[84:87], v[48:51]
    s_add_u32 m0, s62, 0
    v_mfma_f32_16x16x32_bf16 v[56:59], a[4:7], a[92:95], v[56:59]
    buffer_load_dwordx4 v18, s[44:47], s52 offen offset:0 sc1 lds
    v_mfma_f32_16x16x32_bf16 v[56:59], a[0:3], a[88:91], v[56:59]
    ds_read_b64_tr_b16 a[66:67], v8 offset:2048
    v_mfma_f32_16x16x32_bf16 v[60:63], a[8:11], a[88:91], v[60:63]
    s_add_u32 s64, s64, 32768
    v_mfma_f32_16x16x32_bf16 v[60:63], a[12:15], a[92:95], v[60:63]
    s_cmp_ge_u32 s64, 98304
    s_cselect_b32 s63, 4294901760, s59
    s_cselect_b32 s64, 0, s64
    v_mfma_f32_16x16x32_bf16 v[52:55], a[12:15], a[84:87], v[52:55]
    buffer_load_dwordx4 v19, s[44:47], s52 offen offset:1024 sc1 lds
    v_mfma_f32_16x16x32_bf16 v[52:55], a[8:11], a[80:83], v[52:55]
    s_add_u32 s52, s52, s56
    ds_read_b64_tr_b16 a[68:69], v8 offset:16384
    v_mfma_f32_16x16x32_bf16 v[112:115], a[16:19], a[80:83], v[112:115]
    v_mfma_f32_16x16x32_bf16 v[112:115], a[20:23], a[84:87], v[112:115]
    v_mfma_f32_16x16x32_bf16 v[120:123], a[20:23], a[92:95], v[120:123]
    buffer_load_dwordx4 v18, s[44:47], s53 offen offset:2048 sc1 lds
    v_mfma_f32_16x16x32_bf16 v[120:123], a[16:19], a[88:91], v[120:123]
    ds_read_b64_tr_b16 a[70:71], v8 offset:18432
    v_mfma_f32_16x16x32_bf16 v[124:127], a[24:27], a[88:91], v[124:127]
    v_mfma_f32_16x16x32_bf16 v[124:127], a[28:31], a[92:95], v[124:127]
    v_mfma_f32_16x16x32_bf16 v[116:119], a[28:31], a[84:87], v[116:119]
    buffer_load_dwordx4 v19, s[44:47], s53 offen offset:3072 sc1 lds
    v_mfma_f32_16x16x32_bf16 v[116:119], a[24:27], a[80:83], v[116:119]
    s_add_u32 s53, s53, s56
    ds_read_b64_tr_b16 a[72:73], v9 offset:0
    v_mfma_f32_16x16x32_bf16 v[176:179], a[32:35], a[80:83], v[176:179]
    v_mfma_f32_16x16x32_bf16 v[176:179], a[36:39], a[84:87], v[176:179]
    s_add_u32 m0, s62, 4096
    v_mfma_f32_16x16x32_bf16 v[184:187], a[36:39], a[92:95], v[184:187]
    buffer_load_dwordx4 v20, s[44:47], s54 offen offset:0 sc1 lds
    v_mfma_f32_16x16x32_bf16 v[184:187], a[32:35], a[88:91], v[184:187]
    s_xor_b32 s62, s62, 229376
    ds_read_b64_tr_b16 a[74:75], v9 offset:2048
    v_mfma_f32_16x16x32_bf16 v[188:191], a[40:43], a[88:91], v[188:191]
    v_mfma_f32_16x16x32_bf16 v[188:191], a[44:47], a[92:95], v[188:191]
    v_mfma_f32_16x16x32_bf16 v[180:183], a[44:47], a[84:87], v[180:183]
    buffer_load_dwordx4 v21, s[44:47], s54 offen offset:1024 sc1 lds
    v_mfma_f32_16x16x32_bf16 v[180:183], a[40:43], a[80:83], v[180:183]
    s_add_u32 s54, s54, s56
    ds_read_b64_tr_b16 a[76:77], v9 offset:16384
    v_mfma_f32_16x16x32_bf16 v[240:243], a[48:51], a[80:83], v[240:243]
    v_mfma_f32_16x16x32_bf16 v[240:243], a[52:55], a[84:87], v[240:243]
    v_mfma_f32_16x16x32_bf16 v[248:251], a[52:55], a[92:95], v[248:251]
    buffer_load_dwordx4 v20, s[44:47], s55 offen offset:2048 sc1 lds
    v_mfma_f32_16x16x32_bf16 v[248:251], a[48:51], a[88:91], v[248:251]
    ds_read_b64_tr_b16 a[78:79], v9 offset:18432
    v_mfma_f32_16x16x32_bf16 v[252:255], a[56:59], a[88:91], v[252:255]
    v_add_u32 v6, s63, v6
    v_add_u32 v7, s63, v7
    v_mfma_f32_16x16x32_bf16 v[252:255], a[60:63], a[92:95], v[252:255]
    v_mfma_f32_16x16x32_bf16 v[244:247], a[60:63], a[84:87], v[244:247]
    buffer_load_dwordx4 v21, s[44:47], s55 offen offset:3072 sc1 lds
    v_mfma_f32_16x16x32_bf16 v[244:247], a[56:59], a[80:83], v[244:247]
    s_add_u32 s55, s55, s56
    v_mfma_f32_16x16x32_bf16 v[64:67], a[0:3], a[96:99], v[64:67]
    ds_read_b64_tr_b16 a[80:81], v10 offset:0
    v_mfma_f32_16x16x32_bf16 v[64:67], a[4:7], a[100:103], v[64:67]
    v_mfma_f32_16x16x32_bf16 v[72:75], a[4:7], a[108:111], v[72:75]
    v_mfma_f32_16x16x32_bf16 v[72:75], a[0:3], a[104:107], v[72:75]
    s_add_u32 m0, s61, 0
    ds_read_b64_tr_b16 a[82:83], v10 offset:2048
    v_mfma_f32_16x16x32_bf16 v[76:79], a[8:11], a[104:107], v[76:79]
    buffer_load_dwordx4 v16, s[40:43], s48 offen offset:0 sc1 lds
    v_mfma_f32_16x16x32_bf16 v[76:79], a[12:15], a[108:111], v[76:79]
    v_mfma_f32_16x16x32_bf16 v[68:71], a[12:15], a[100:103], v[68:71]
    ds_read_b64_tr_b16 a[84:85], v10 offset:16384
    v_mfma_f32_16x16x32_bf16 v[68:71], a[8:11], a[96:99], v[68:71]
    v_mfma_f32_16x16x32_bf16 v[128:131], a[16:19], a[96:99], v[128:131]
    buffer_store_dwordx4 a[176:179], v2, s[24:27], s28 offen sc1
    v_mfma_f32_16x16x32_bf16 v[128:131], a[20:23], a[100:103], v[128:131]
    s_add_u32 s28, s28, s31
    ds_read_b64_tr_b16 a[86:87], v10 offset:18432
    v_mfma_f32_16x16x32_bf16 v[136:139], a[20:23], a[108:111], v[136:139]
    v_mfma_f32_16x16x32_bf16 v[136:139], a[16:19], a[104:107], v[136:139]
    v_mfma_f32_16x16x32_bf16 v[140:143], a[24:27], a[104:107], v[140:143]
    buffer_load_dwordx4 v17, s[40:43], s48 offen offset:1024 sc1 lds
    v_mfma_f32_16x16x32_bf16 v[140:143], a[28:31], a[108:111], v[140:143]
    s_add_u32 s48, s48, 128
    ds_read_b64_tr_b16 a[88:89], v11 offset:0
    v_mfma_f32_16x16x32_bf16 v[132:135], a[28:31], a[100:103], v[132:135]
    v_mfma_f32_16x16x32_bf16 v[132:135], a[24:27], a[96:99], v[132:135]
    v_mfma_f32_16x16x32_bf16 v[192:195], a[32:35], a[96:99], v[192:195]
    buffer_store_dwordx4 a[180:183], v2, s[24:27], s28 offen sc1
    v_mfma_f32_16x16x32_bf16 v[192:195], a[36:39], a[100:103], v[192:195]
    s_add_u32 s28, s28, s31
    ds_read_b64_tr_b16 a[90:91], v11 offset:2048
    v_mfma_f32_16x16x32_bf16 v[200:203], a[36:39], a[108:111], v[200:203]
    v_mfma_f32_16x16x32_bf16 v[200:203], a[32:35], a[104:107], v[200:203]
    v_mfma_f32_16x16x32_bf16 v[204:207], a[40:43], a[104:107], v[204:207]
    buffer_load_dwordx4 v16, s[40:43], s49 offen offset:2048 sc1 lds
    v_mfma_f32_16x16x32_bf16 v[204:207], a[44:47], a[108:111], v[204:207]
    ds_read_b64_tr_b16 a[92:93], v11 offset:16384
    v_mfma_f32_16x16x32_bf16 v[196:199], a[44:47], a[100:103], v[196:199]
    v_mfma_f32_16x16x32_bf16 v[196:199], a[40:43], a[96:99], v[196:199]
    v_mfma_f32_16x16x32_bf16 a[224:227], a[48:51], a[96:99], a[224:227]
    buffer_store_dwordx4 a[184:187], v2, s[24:27], s28 offen sc1
    v_mfma_f32_16x16x32_bf16 a[224:227], a[52:55], a[100:103], a[224:227]
    s_add_u32 s28, s28, s31
    ds_read_b64_tr_b16 a[94:95], v11 offset:18432
    v_mfma_f32_16x16x32_bf16 a[232:235], a[52:55], a[108:111], a[232:235]
    v_mfma_f32_16x16x32_bf16 a[232:235], a[48:51], a[104:107], a[232:235]
    v_mfma_f32_16x16x32_bf16 a[236:239], a[56:59], a[104:107], a[236:239]
    buffer_load_dwordx4 v17, s[40:43], s49 offen offset:3072 sc1 lds
    v_mfma_f32_16x16x32_bf16 a[236:239], a[60:63], a[108:111], a[236:239]
    s_add_u32 s49, s49, 128
    v_mfma_f32_16x16x32_bf16 a[228:231], a[60:63], a[100:103], a[228:231]
    buffer_store_dwordx4 a[188:191], v2, s[24:27], s28 offen sc1
    v_mfma_f32_16x16x32_bf16 a[228:231], a[56:59], a[96:99], a[228:231]
    s_add_u32 s29, s29, s30
    s_mov_b32 s28, s29
    v_mfma_f32_16x16x32_bf16 v[80:83], a[0:3], a[112:115], v[80:83]
    v_mfma_f32_16x16x32_bf16 v[80:83], a[4:7], a[116:119], v[80:83]
    ds_read_b64_tr_b16 a[96:97], v12 offset:0
    v_mfma_f32_16x16x32_bf16 v[88:91], a[4:7], a[124:127], v[88:91]
    v_mfma_f32_16x16x32_bf16 v[88:91], a[0:3], a[120:123], v[88:91]
    s_add_u32 m0, s61, 4096
    ds_read_b128 a[0:3], v6 offset:0
    v_mfma_f32_16x16x32_bf16 v[92:95], a[8:11], a[120:123], v[92:95]
    buffer_load_dwordx4 v16, s[40:43], s50 offen offset:0 sc1 lds
    v_mfma_f32_16x16x32_bf16 v[92:95], a[12:15], a[124:127], v[92:95]
    s_add_u32 s61, s61, 32768
    ds_read_b128 a[4:7], v7 offset:0
    v_mfma_f32_16x16x32_bf16 v[84:87], a[12:15], a[116:119], v[84:87]
    s_cmp_ge_u32 s61, 98304
    s_cselect_b32 s90, 98304, 0
    ds_read_b64_tr_b16 a[98:99], v12 offset:2048
    v_mfma_f32_16x16x32_bf16 v[84:87], a[8:11], a[112:115], v[84:87]
    s_sub_u32 s61, s61, s90
    ds_read_b128 a[8:11], v6 offset:2048
    v_mfma_f32_16x16x32_bf16 v[144:147], a[16:19], a[112:115], v[144:147]
    ds_read_b128 a[12:15], v7 offset:2048
    v_mfma_f32_16x16x32_bf16 v[144:147], a[20:23], a[116:119], v[144:147]
    ds_read_b64_tr_b16 a[100:101], v12 offset:16384
    v_mfma_f32_16x16x32_bf16 v[152:155], a[20:23], a[124:127], v[152:155]
    v_mfma_f32_16x16x32_bf16 v[152:155], a[16:19], a[120:123], v[152:155]
    ds_read_b128 a[16:19], v6 offset:4096
    v_mfma_f32_16x16x32_bf16 v[156:159], a[24:27], a[120:123], v[156:159]
    buffer_load_dwordx4 v17, s[40:43], s50 offen offset:1024 sc1 lds
    v_mfma_f32_16x16x32_bf16 v[156:159], a[28:31], a[124:127], v[156:159]
    s_add_u32 s50, s50, 128
    ds_read_b128 a[20:23], v7 offset:4096
    v_mfma_f32_16x16x32_bf16 v[148:151], a[28:31], a[116:119], v[148:151]
    ds_read_b64_tr_b16 a[102:103], v12 offset:18432
    v_mfma_f32_16x16x32_bf16 v[148:151], a[24:27], a[112:115], v[148:151]
    ds_read_b128 a[24:27], v6 offset:6144
    v_mfma_f32_16x16x32_bf16 v[208:211], a[32:35], a[112:115], v[208:211]
    s_sub_u32 s65, s65, 1
    ds_read_b128 a[28:31], v7 offset:6144
    v_mfma_f32_16x16x32_bf16 v[208:211], a[36:39], a[116:119], v[208:211]
    ds_read_b64_tr_b16 a[104:105], v13 offset:0
    v_mfma_f32_16x16x32_bf16 v[216:219], a[36:39], a[124:127], v[216:219]
    v_mfma_f32_16x16x32_bf16 v[216:219], a[32:35], a[120:123], v[216:219]
    ds_read_b128 a[32:35], v6 offset:8192
    v_mfma_f32_16x16x32_bf16 v[220:223], a[40:43], a[120:123], v[220:223]
    buffer_load_dwordx4 v16, s[40:43], s51 offen offset:2048 sc1 lds
    v_mfma_f32_16x16x32_bf16 v[220:223], a[44:47], a[124:127], v[220:223]
    ds_read_b128 a[36:39], v7 offset:8192
    v_mfma_f32_16x16x32_bf16 v[212:215], a[44:47], a[116:119], v[212:215]
    ds_read_b64_tr_b16 a[106:107], v13 offset:2048
    v_mfma_f32_16x16x32_bf16 v[212:215], a[40:43], a[112:115], v[212:215]
    ds_read_b128 a[40:43], v6 offset:10240
    v_mfma_f32_16x16x32_bf16 a[240:243], a[48:51], a[112:115], a[240:243]
    ds_read_b128 a[44:47], v7 offset:10240
    v_mfma_f32_16x16x32_bf16 a[240:243], a[52:55], a[116:119], a[240:243]
    ds_read_b64_tr_b16 a[108:109], v13 offset:16384
    v_mfma_f32_16x16x32_bf16 a[248:251], a[52:55], a[124:127], a[248:251]
    v_mfma_f32_16x16x32_bf16 a[248:251], a[48:51], a[120:123], a[248:251]
    ds_read_b128 a[48:51], v6 offset:12288
    v_mfma_f32_16x16x32_bf16 a[252:255], a[56:59], a[120:123], a[252:255]
    buffer_load_dwordx4 v17, s[40:43], s51 offen offset:3072 sc1 lds
    v_mfma_f32_16x16x32_bf16 a[252:255], a[60:63], a[124:127], a[252:255]
    s_add_u32 s51, s51, 128
    ds_read_b128 a[52:55], v7 offset:12288
    v_mfma_f32_16x16x32_bf16 a[244:247], a[60:63], a[116:119], a[244:247]
    ds_read_b64_tr_b16 a[110:111], v13 offset:18432
    v_mfma_f32_16x16x32_bf16 a[244:247], a[56:59], a[112:115], a[244:247]
    ds_read_b128 a[56:59], v6 offset:14336
    ds_read_b128 a[60:63], v7 offset:14336
    s_cmp_eq_u32 s66, 2
    s_cbranch_scc1 m_hook23
m_hookr24:
    s_waitcnt lgkmcnt(15)
    v_mfma_f32_16x16x32_bf16 v[32:35], a[0:3], a[64:67], v[32:35]
    ds_read_b64_tr_b16 a[112:113], v14 offset:0
    v_mfma_f32_16x16x32_bf16 v[32:35], a[4:7], a[68:71], v[32:35]
    ds_read_b64_tr_b16 a[114:115], v14 offset:2048
    v_mfma_f32_16x16x32_bf16 v[40:43], a[4:7], a[76:79], v[40:43]
    ds_read_b64_tr_b16 a[116:117], v14 offset:16384
    v_mfma_f32_16x16x32_bf16 v[40:43], a[0:3], a[72:75], v[40:43]
    ds_read_b64_tr_b16 a[118:119], v14 offset:18432
    v_mfma_f32_16x16x32_bf16 v[44:47], a[8:11], a[72:75], v[44:47]
    ds_read_b64_tr_b16 a[120:121], v15 offset:0
    v_mfma_f32_16x16x32_bf16 v[44:47], a[12:15], a[76:79], v[44:47]
    ds_read_b64_tr_b16 a[122:123], v15 offset:2048
    v_mfma_f32_16x16x32_bf16 v[36:39], a[12:15], a[68:71], v[36:39]
    ds_read_b64_tr_b16 a[124:125], v15 offset:16384
    v_mfma_f32_16x16x32_bf16 v[36:39], a[8:11], a[64:67], v[36:39]
    ds_read_b64_tr_b16 a[126:127], v15 offset:18432
    v_mfma_f32_16x16x32_bf16 v[96:99], a[16:19], a[64:67], v[96:99]
    v_mfma_f32_16x16x32_bf16 v[96:99], a[20:23], a[68:71], v[96:99]
    v_mfma_f32_16x16x32_bf16 v[104:107], a[20:23], a[76:79], v[104:107]
    buffer_store_dwordx4 a[192:195], v2, s[24:27], s28 offen sc1
    v_mfma_f32_16x16x32_bf16 v[104:107], a[16:19], a[72:75], v[104:107]
    s_add_u32 s28, s28, s31
    s_waitcnt lgkmcnt(15)
    v_mfma_f32_16x16x32_bf16 v[108:111], a[24:27], a[72:75], v[108:111]
    v_xor_b32 v8, s60, v8
    v_xor_b32 v9, s60, v9
    v_mfma_f32_16x16x32_bf16 v[108:111], a[28:31], a[76:79], v[108:111]
    v_xor_b32 v10, s60, v10
    v_xor_b32 v11, s60, v11
    v_mfma_f32_16x16x32_bf16 v[100:103], a[28:31], a[68:71], v[100:103]
    v_xor_b32 v12, s60, v12
    v_xor_b32 v13, s60, v13
    v_mfma_f32_16x16x32_bf16 v[100:103], a[24:27], a[64:67], v[100:103]
    v_xor_b32 v14, s60, v14
    v_xor_b32 v15, s60, v15
    v_mfma_f32_16x16x32_bf16 v[160:163], a[32:35], a[64:67], v[160:163]
    buffer_store_dwordx4 a[196:199], v2, s[24:27], s28 offen sc1
    v_mfma_f32_16x16x32_bf16 v[160:163], a[36:39], a[68:71], v[160:163]
    s_add_u32 s28, s28, s31
    v_mfma_f32_16x16x32_bf16 v[168:171], a[36:39], a[76:79], v[168:171]
    v_mfma_f32_16x16x32_bf16 v[168:171], a[32:35], a[72:75], v[168:171]
    s_waitcnt lgkmcnt(14)
    v_mfma_f32_16x16x32_bf16 v[172:175], a[40:43], a[72:75], v[172:175]
    v_mfma_f32_16x16x32_bf16 v[172:175], a[44:47], a[76:79], v[172:175]
    v_mfma_f32_16x16x32_bf16 v[164:167], a[44:47], a[68:71], v[164:167]
    buffer_store_dwordx4 a[200:203], v2, s[24:27], s28 offen sc1
    v_mfma_f32_16x16x32_bf16 v[164:167], a[40:43], a[64:67], v[164:167]
    s_add_u32 s28, s28, s31
    s_waitcnt lgkmcnt(11)
    v_mfma_f32_16x16x32_bf16 v[224:227], a[48:51], a[64:67], v[224:227]
    v_mfma_f32_16x16x32_bf16 v[224:227], a[52:55], a[68:71], v[224:227]
    v_mfma_f32_16x16x32_bf16 v[232:235], a[52:55], a[76:79], v[232:235]
    v_mfma_f32_16x16x32_bf16 v[232:235], a[48:51], a[72:75], v[232:235]
    s_waitcnt lgkmcnt(8)
    v_mfma_f32_16x16x32_bf16 v[236:239], a[56:59], a[72:75], v[236:239]
    buffer_store_dwordx4 a[204:207], v2, s[24:27], s28 offen sc1
    v_mfma_f32_16x16x32_bf16 v[236:239], a[60:63], a[76:79], v[236:239]
    s_add_u32 s28, s28, s31
    v_mfma_f32_16x16x32_bf16 v[228:231], a[60:63], a[68:71], v[228:231]
    s_waitcnt vmcnt(16) lgkmcnt(0)
    v_mfma_f32_16x16x32_bf16 v[228:231], a[56:59], a[64:67], v[228:231]
    s_barrier
    v_mfma_f32_16x16x32_bf16 v[48:51], a[0:3], a[80:83], v[48:51]
    ds_read_b64_tr_b16 a[64:65], v8 offset:0
    v_mfma_f32_16x16x32_bf16 v[48:51], a[4:7], a[84:87], v[48:51]
    s_add_u32 m0, s62, 0
    v_mfma_f32_16x16x32_bf16 v[56:59], a[4:7], a[92:95], v[56:59]
    buffer_load_dwordx4 v18, s[44:47], s52 offen offset:0 sc1 lds
    v_mfma_f32_16x16x32_bf16 v[56:59], a[0:3], a[88:91], v[56:59]
    ds_read_b64_tr_b16 a[66:67], v8 offset:2048
    v_mfma_f32_16x16x32_bf16 v[60:63], a[8:11], a[88:91], v[60:63]
    s_add_u32 s64, s64, 32768
    v_mfma_f32_16x16x32_bf16 v[60:63], a[12:15], a[92:95], v[60:63]
    s_cmp_ge_u32 s64, 98304
    s_cselect_b32 s63, 4294901760, s59
    s_cselect_b32 s64, 0, s64
    v_mfma_f32_16x16x32_bf16 v[52:55], a[12:15], a[84:87], v[52:55]
    buffer_load_dwordx4 v19, s[44:47], s52 offen offset:1024 sc1 lds
    v_mfma_f32_16x16x32_bf16 v[52:55], a[8:11], a[80:83], v[52:55]
    s_add_u32 s52, s52, s56
    ds_read_b64_tr_b16 a[68:69], v8 offset:16384
    v_mfma_f32_16x16x32_bf16 v[112:115], a[16:19], a[80:83], v[112:115]
    v_mfma_f32_16x16x32_bf16 v[112:115], a[20:23], a[84:87], v[112:115]
    v_mfma_f32_16x16x32_bf16 v[120:123], a[20:23], a[92:95], v[120:123]
    buffer_load_dwordx4 v18, s[44:47], s53 offen offset:2048 sc1 lds
    v_mfma_f32_16x16x32_bf16 v[120:123], a[16:19], a[88:91], v[120:123]
    ds_read_b64_tr_b16 a[70:71], v8 offset:18432
    v_mfma_f32_16x16x32_bf16 v[124:127], a[24:27], a[88:91], v[124:127]
    v_mfma_f32_16x16x32_bf16 v[124:127], a[28:31], a[92:95], v[124:127]
    v_mfma_f32_16x16x32_bf16 v[116:119], a[28:31], a[84:87], v[116:119]
    buffer_load_dwordx4 v19, s[44:47], s53 offen offset:3072 sc1 lds
    v_mfma_f32_16x16x32_bf16 v[116:119], a[24:27], a[80:83], v[116:119]
    s_add_u32 s53, s53, s56
    ds_read_b64_tr_b16 a[72:73], v9 offset:0
    v_mfma_f32_16x16x32_bf16 v[176:179], a[32:35], a[80:83], v[176:179]
    v_mfma_f32_16x16x32_bf16 v[176:179], a[36:39], a[84:87], v[176:179]
    s_add_u32 m0, s62, 4096
    v_mfma_f32_16x16x32_bf16 v[184:187], a[36:39], a[92:95], v[184:187]
    buffer_load_dwordx4 v20, s[44:47], s54 offen offset:0 sc1 lds
    v_mfma_f32_16x16x32_bf16 v[184:187], a[32:35], a[88:91], v[184:187]
    s_xor_b32 s62, s62, 229376
    ds_read_b64_tr_b16 a[74:75], v9 offset:2048
    v_mfma_f32_16x16x32_bf16 v[188:191], a[40:43], a[88:91], v[188:191]
    v_mfma_f32_16x16x32_bf16 v[188:191], a[44:47], a[92:95], v[188:191]
    v_mfma_f32_16x16x32_bf16 v[180:183], a[44:47], a[84:87], v[180:183]
    buffer_load_dwordx4 v21, s[44:47], s54 offen offset:1024 sc1 lds
    v_mfma_f32_16x16x32_bf16 v[180:183], a[40:43], a[80:83], v[180:183]
    s_add_u32 s54, s54, s56
    ds_read_b64_tr_b16 a[76:77], v9 offset:16384
    v_mfma_f32_16x16x32_bf16 v[240:243], a[48:51], a[80:83], v[240:243]
    v_mfma_f32_16x16x32_bf16 v[240:243], a[52:55], a[84:87], v[240:243]
    v_mfma_f32_16x16x32_bf16 v[248:251], a[52:55], a[92:95], v[248:251]
    buffer_load_dwordx4 v20, s[44:47], s55 offen offset:2048 sc1 lds
    v_mfma_f32_16x16x32_bf16 v[248:251], a[48:51], a[88:91], v[248:251]
    ds_read_b64_tr_b16 a[78:79], v9 offset:18432
    v_mfma_f32_16x16x32_bf16 v[252:255], a[56:59], a[88:91], v[252:255]
    v_add_u32 v6, s63, v6
    v_add_u32 v7, s63, v7
    v_mfma_f32_16x16x32_bf16 v[252:255], a[60:63], a[92:95], v[252:255]
    v_mfma_f32_16x16x32_bf16 v[244:247], a[60:63], a[84:87], v[244:247]
    buffer_load_dwordx4 v21, s[44:47], s55 offen offset:3072 sc1 lds
    v_mfma_f32_16x16x32_bf16 v[244:247], a[56:59], a[80:83], v[244:247]
    s_add_u32 s55, s55, s56
    v_mfma_f32_16x16x32_bf16 v[64:67], a[0:3], a[96:99], v[64:67]
    ds_read_b64_tr_b16 a[80:81], v10 offset:0
    v_mfma_f32_16x16x32_bf16 v[64:67], a[4:7], a[100:103], v[64:67]
    v_mfma_f32_16x16x32_bf16 v[72:75], a[4:7], a[108:111], v[72:75]
    v_mfma_f32_16x16x32_bf16 v[72:75], a[0:3], a[104:107], v[72:75]
    s_add_u32 m0, s61, 0
    ds_read_b64_tr_b16 a[82:83], v10 offset:2048
    v_mfma_f32_16x16x32_bf16 v[76:79], a[8:11], a[104:107], v[76:79]
    buffer_load_dwordx4 v16, s[40:43], s48 offen offset:0 sc1 lds
    v_mfma_f32_16x16x32_bf16 v[76:79], a[12:15], a[108:111], v[76:79]
    v_mfma_f32_16x16x32_bf16 v[68:71], a[12:15], a[100:103], v[68:71]
    ds_read_b64_tr_b16 a[84:85], v10 offset:16384
    v_mfma_f32_16x16x32_bf16 v[68:71], a[8:11], a[96:99], v[68:71]
    v_mfma_f32_16x16x32_bf16 v[128:131], a[16:19], a[96:99], v[128:131]
    buffer_store_dwordx4 a[208:211], v2, s[24:27], s28 offen sc1
    v_mfma_f32_16x16x32_bf16 v[128:131], a[20:23], a[100:103], v[128:131]
    s_add_u32 s28, s28, s31
    ds_read_b64_tr_b16 a[86:87], v10 offset:18432
    v_mfma_f32_16x16x32_bf16 v[136:139], a[20:23], a[108:111], v[136:139]
    v_mfma_f32_16x16x32_bf16 v[136:139], a[16:19], a[104:107], v[136:139]
    v_mfma_f32_16x16x32_bf16 v[140:143], a[24:27], a[104:107], v[140:143]
    buffer_load_dwordx4 v17, s[40:43], s48 offen offset:1024 sc1 lds
    v_mfma_f32_16x16x32_bf16 v[140:143], a[28:31], a[108:111], v[140:143]
    s_add_u32 s48, s48, 128
    ds_read_b64_tr_b16 a[88:89], v11 offset:0
    v_mfma_f32_16x16x32_bf16 v[132:135], a[28:31], a[100:103], v[132:135]
    v_mfma_f32_16x16x32_bf16 v[132:135], a[24:27], a[96:99], v[132:135]
    v_mfma_f32_16x16x32_bf16 v[192:195], a[32:35], a[96:99], v[192:195]
    buffer_store_dwordx4 a[212:215], v2, s[24:27], s28 offen sc1
    v_mfma_f32_16x16x32_bf16 v[192:195], a[36:39], a[100:103], v[192:195]
    s_add_u32 s28, s28, s31
    ds_read_b64_tr_b16 a[90:91], v11 offset:2048
    v_mfma_f32_16x16x32_bf16 v[200:203], a[36:39], a[108:111], v[200:203]
    v_mfma_f32_16x16x32_bf16 v[200:203], a[32:35], a[104:107], v[200:203]
    v_mfma_f32_16x16x32_bf16 v[204:207], a[40:43], a[104:107], v[204:207]
    buffer_load_dwordx4 v16, s[40:43], s49 offen offset:2048 sc1 lds
    v_mfma_f32_16x16x32_bf16 v[204:207], a[44:47], a[108:111], v[204:207]
    ds_read_b64_tr_b16 a[92:93], v11 offset:16384
    v_mfma_f32_16x16x32_bf16 v[196:199], a[44:47], a[100:103], v[196:199]
    v_mfma_f32_16x16x32_bf16 v[196:199], a[40:43], a[96:99], v[196:199]
    v_mfma_f32_16x16x32_bf16 a[224:227], a[48:51], a[96:99], a[224:227]
    buffer_store_dwordx4 a[216:219], v2, s[24:27], s28 offen sc1
    v_mfma_f32_16x16x32_bf16 a[224:227], a[52:55], a[100:103], a[224:227]
    s_add_u32 s28, s28, s31
    ds_read_b64_tr_b16 a[94:95], v11 offset:18432
    v_mfma_f32_16x16x32_bf16 a[232:235], a[52:55], a[108:111], a[232:235]
    v_mfma_f32_16x16x32_bf16 a[232:235], a[48:51], a[104:107], a[232:235]
    v_mfma_f32_16x16x32_bf16 a[236:239], a[56:59], a[104:107], a[236:239]
    buffer_load_dwordx4 v17, s[40:43], s49 offen offset:3072 sc1 lds
    v_mfma_f32_16x16x32_bf16 a[236:239], a[60:63], a[108:111], a[236:239]
    s_add_u32 s49, s49, 128
    v_mfma_f32_16x16x32_bf16 a[228:231], a[60:63], a[100:103], a[228:231]
    buffer_store_dwordx4 a[220:223], v2, s[24:27], s28 offen sc1
    v_mfma_f32_16x16x32_bf16 a[228:231], a[56:59], a[96:99], a[228:231]
    s_add_u32 s29, s29, s30
    s_mov_b32 s28, s29
    v_mfma_f32_16x16x32_bf16 v[80:83], a[0:3], a[112:115], v[80:83]
    v_mfma_f32_16x16x32_bf16 v[80:83], a[4:7], a[116:119], v[80:83]
    ds_read_b64_tr_b16 a[96:97], v12 offset:0
    v_mfma_f32_16x16x32_bf16 v[88:91], a[4:7], a[124:127], v[88:91]
    v_mfma_f32_16x16x32_bf16 v[88:91], a[0:3], a[120:123], v[88:91]
    s_add_u32 m0, s61, 4096
    ds_read_b128 a[0:3], v6 offset:0
    v_mfma_f32_16x16x32_bf16 v[92:95], a[8:11], a[120:123], v[92:95]
    buffer_load_dwordx4 v16, s[40:43], s50 offen offset:0 sc1 lds
    v_mfma_f32_16x16x32_bf16 v[92:95], a[12:15], a[124:127], v[92:95]
    s_add_u32 s61, s61, 32768
    ds_read_b128 a[4:7], v7 offset:0
    v_mfma_f32_16x16x32_bf16 v[84:87], a[12:15], a[116:119], v[84:87]
    s_cmp_ge_u32 s61, 98304
    s_cselect_b32 s90, 98304, 0
    ds_read_b64_tr_b16 a[98:99], v12 offset:2048
    v_mfma_f32_16x16x32_bf16 v[84:87], a[8:11], a[112:115], v[84:87]
    s_sub_u32 s61, s61, s90
    ds_read_b128 a[8:11], v6 offset:2048
    v_mfma_f32_16x16x32_bf16 v[144:147], a[16:19], a[112:115], v[144:147]
    ds_read_b128 a[12:15], v7 offset:2048
    v_mfma_f32_16x16x32_bf16 v[144:147], a[20:23], a[116:119], v[144:147]
    ds_read_b64_tr_b16 a[100:101], v12 offset:16384
    v_mfma_f32_16x16x32_bf16 v[152:155], a[20:23], a[124:127], v[152:155]
    v_mfma_f32_16x16x32_bf16 v[152:155], a[16:19], a[120:123], v[152:155]
    ds_read_b128 a[16:19], v6 offset:4096
    v_mfma_f32_16x16x32_bf16 v[156:159], a[24:27], a[120:123], v[156:159]
    buffer_load_dwordx4 v17, s[40:43], s50 offen offset:1024 sc1 lds
    v_mfma_f32_16x16x32_bf16 v[156:159], a[28:31], a[124:127], v[156:159]
    s_add_u32 s50, s50, 128
    ds_read_b128 a[20:23], v7 offset:4096
    v_mfma_f32_16x16x32_bf16 v[148:151], a[28:31], a[116:119], v[148:151]
    ds_read_b64_tr_b16 a[102:103], v12 offset:18432
    v_mfma_f32_16x16x32_bf16 v[148:151], a[24:27], a[112:115], v[148:151]
    ds_read_b128 a[24:27], v6 offset:6144
    v_mfma_f32_16x16x32_bf16 v[208:211], a[32:35], a[112:115], v[208:211]
    s_sub_u32 s65, s65, 1
    ds_read_b128 a[28:31], v7 offset:6144
    v_mfma_f32_16x16x32_bf16 v[208:211], a[36:39], a[116:119], v[208:211]
    ds_read_b64_tr_b16 a[104:105], v13 offset:0
    v_mfma_f32_16x16x32_bf16 v[216:219], a[36:39], a[124:127], v[216:219]
    v_mfma_f32_16x16x32_bf16 v[216:219], a[32:35], a[120:123], v[216:219]
    ds_read_b128 a[32:35], v6 offset:8192
    v_mfma_f32_16x16x32_bf16 v[220:223], a[40:43], a[120:123], v[220:223]
    buffer_load_dwordx4 v16, s[40:43], s51 offen offset:2048 sc1 lds
    v_mfma_f32_16x16x32_bf16 v[220:223], a[44:47], a[124:127], v[220:223]
    ds_read_b128 a[36:39], v7 offset:8192
    v_mfma_f32_16x16x32_bf16 v[212:215], a[44:47], a[116:119], v[212:215]
    ds_read_b64_tr_b16 a[106:107], v13 offset:2048
    v_mfma_f32_16x16x32_bf16 v[212:215], a[40:43], a[112:115], v[212:215]
    ds_read_b128 a[40:43], v6 offset:10240
    v_mfma_f32_16x16x32_bf16 a[240:243], a[48:51], a[112:115], a[240:243]
    ds_read_b128 a[44:47], v7 offset:10240
    v_mfma_f32_16x16x32_bf16 a[240:243], a[52:55], a[116:119], a[240:243]
    ds_read_b64_tr_b16 a[108:109], v13 offset:16384
    v_mfma_f32_16x16x32_bf16 a[248:251], a[52:55], a[124:127], a[248:251]
    v_mfma_f32_16x16x32_bf16 a[248:251], a[48:51], a[120:123], a[248:251]
    ds_read_b128 a[48:51], v6 offset:12288
    v_mfma_f32_16x16x32_bf16 a[252:255], a[56:59], a[120:123], a[252:255]
    buffer_load_dwordx4 v17, s[40:43], s51 offen offset:3072 sc1 lds
    v_mfma_f32_16x16x32_bf16 a[252:255], a[60:63], a[124:127], a[252:255]
    s_add_u32 s51, s51, 128
    ds_read_b128 a[52:55], v7 offset:12288
    v_mfma_f32_16x16x32_bf16 a[244:247], a[60:63], a[116:119], a[244:247]
    ds_read_b64_tr_b16 a[110:111], v13 offset:18432
    v_mfma_f32_16x16x32_bf16 a[244:247], a[56:59], a[112:115], a[244:247]
    ds_read_b128 a[56:59], v6 offset:14336
    ds_read_b128 a[60:63], v7 offset:14336
.p2align 3
m_loop25:
    s_waitcnt lgkmcnt(15)
    v_mfma_f32_16x16x32_bf16 v[32:35], a[0:3], a[64:67], v[32:35]
    ds_read_b64_tr_b16 a[112:113], v14 offset:0
    v_mfma_f32_16x16x32_bf16 v[32:35], a[4:7], a[68:71], v[32:35]
    ds_read_b64_tr_b16 a[114:115], v14 offset:2048
    v_mfma_f32_16x16x32_bf16 v[40:43], a[4:7], a[76:79], v[40:43]
    ds_read_b64_tr_b16 a[116:117], v14 offset:16384
    v_mfma_f32_16x16x32_bf16 v[40:43], a[0:3], a[72:75], v[40:43]
    ds_read_b64_tr_b16 a[118:119], v14 offset:18432
    v_mfma_f32_16x16x32_bf16 v[44:47], a[8:11], a[72:75], v[44:47]
    ds_read_b64_tr_b16 a[120:121], v15 offset:0
    v_mfma_f32_16x16x32_bf16 v[44:47], a[12:15], a[76:79], v[44:47]
    ds_read_b64_tr_b16 a[122:123], v15 offset:2048
    v_mfma_f32_16x16x32_bf16 v[36:39], a[12:15], a[68:71], v[36:39]
    ds_read_b64_tr_b16 a[124:125], v15 offset:16384
    v_mfma_f32_16x16x32_bf16 v[36:39], a[8:11], a[64:67], v[36:39]
    ds_read_b64_tr_b16 a[126:127], v15 offset:18432
    v_mfma_f32_16x16x32_bf16 v[96:99], a[16:19], a[64:67], v[96:99]
    v_mfma_f32_16x16x32_bf16 v[96:99], a[20:23], a[68:71], v[96:99]
    v_mfma_f32_16x16x32_bf16 v[104:107], a[20:23], a[76:79], v[104:107]
    v_mfma_f32_16x16x32_bf16 v[104:107], a[16:19], a[72:75], v[104:107]
    s_waitcnt lgkmcnt(15)
    v_mfma_f32_16x16x32_bf16 v[108:111], a[24:27], a[72:75], v[108:111]
    v_xor_b32 v8, s60, v8
    v_xor_b32 v9, s60, v9
    v_mfma_f32_16x16x32_bf16 v[108:111], a[28:31], a[76:79], v[108:111]
    v_xor_b32 v10, s60, v10
    v_xor_b32 v11, s60, v11
    v_mfma_f32_16x16x32_bf16 v[100:103], a[28:31], a[68:71], v[100:103]
    v_xor_b32 v12, s60, v12
    v_xor_b32 v13, s60, v13
    v_mfma_f32_16x16x32_bf16 v[100:103], a[24:27], a[64:67], v[100:103]
    v_xor_b32 v14, s60, v14
    v_xor_b32 v15, s60, v15
    v_mfma_f32_16x16x32_bf16 v[160:163], a[32:35], a[64:67], v[160:163]
    v_mfma_f32_16x16x32_bf16 v[160:163], a[36:39], a[68:71], v[160:163]
    v_mfma_f32_16x16x32_bf16 v[168:171], a[36:39], a[76:79], v[168:171]
    v_mfma_f32_16x16x32_bf16 v[168:171], a[32:35], a[72:75], v[168:171]
    s_waitcnt lgkmcnt(14)
    v_mfma_f32_16x16x32_bf16 v[172:175], a[40:43], a[72:75], v[172:175]
    v_mfma_f32_16x16x32_bf16 v[172:175], a[44:47], a[76:79], v[172:175]
    v_mfma_f32_16x16x32_bf16 v[164:167], a[44:47], a[68:71], v[164:167]
    v_mfma_f32_16x16x32_bf16 v[164:167], a[40:43], a[64:67], v[164:167]
    s_waitcnt lgkmcnt(11)
    v_mfma_f32_16x16x32_bf16 v[224:227], a[48:51], a[64:67], v[224:227]
    v_mfma_f32_16x16x32_bf16 v[224:227], a[52:55], a[68:71], v[224:227]
    v_mfma_f32_16x16x32_bf16 v[232:235], a[52:55], a[76:79], v[232:235]
    v_mfma_f32_16x16x32_bf16 v[232:235], a[48:51], a[72:75], v[232:235]
    s_waitcnt lgkmcnt(8)
    v_mfma_f32_16x16x32_bf16 v[236:239], a[56:59], a[72:75], v[236:239]
    v_mfma_f32_16x16x32_bf16 v[236:239], a[60:63], a[76:79], v[236:239]
    v_mfma_f32_16x16x32_bf16 v[228:231], a[60:63], a[68:71], v[228:231]
    s_waitcnt vmcnt(8) lgkmcnt(0)
    v_mfma_f32_16x16x32_bf16 v[228:231], a[56:59], a[64:67], v[228:231]
    s_barrier
    v_mfma_f32_16x16x32_bf16 v[48:51], a[0:3], a[80:83], v[48:51]
    ds_read_b64_tr_b16 a[64:65], v8 offset:0
    v_mfma_f32_16x16x32_bf16 v[48:51], a[4:7], a[84:87], v[48:51]
    s_add_u32 m0, s62, 0
    v_mfma_f32_16x16x32_bf16 v[56:59], a[4:7], a[92:95], v[56:59]
    buffer_load_dwordx4 v18, s[44:47], s52 offen offset:0 sc1 lds
    v_mfma_f32_16x16x32_bf16 v[56:59], a[0:3], a[88:91], v[56:59]
    ds_read_b64_tr_b16 a[66:67], v8 offset:2048
    v_mfma_f32_16x16x32_bf16 v[60:63], a[8:11], a[88:91], v[60:63]
    s_add_u32 s64, s64, 32768
    v_mfma_f32_16x16x32_bf16 v[60:63], a[12:15], a[92:95], v[60:63]
    s_cmp_ge_u32 s64, 98304
    s_cselect_b32 s63, 4294901760, s59
    s_cselect_b32 s64, 0, s64
    v_mfma_f32_16x16x32_bf16 v[52:55], a[12:15], a[84:87], v[52:55]
    buffer_load_dwordx4 v19, s[44:47], s52 offen offset:1024 sc1 lds
    v_mfma_f32_16x16x32_bf16 v[52:55], a[8:11], a[80:83], v[52:55]
    s_add_u32 s52, s52, s56
    ds_read_b64_tr_b16 a[68:69], v8 offset:16384
    v_mfma_f32_16x16x32_bf16 v[112:115], a[16:19], a[80:83], v[112:115]
    v_mfma_f32_16x16x32_bf16 v[112:115], a[20:23], a[84:87], v[112:115]
    v_mfma_f32_16x16x32_bf16 v[120:123], a[20:23], a[92:95], v[120:123]
    buffer_load_dwordx4 v18, s[44:47], s53 offen offset:2048 sc1 lds
    v_mfma_f32_16x16x32_bf16 v[120:123], a[16:19], a[88:91], v[120:123]
    ds_read_b64_tr_b16 a[70:71], v8 offset:18432
    v_mfma_f32_16x16x32_bf16 v[124:127], a[24:27], a[88:91], v[124:127]
    v_mfma_f32_16x16x32_bf16 v[124:127], a[28:31], a[92:95], v[124:127]
    v_mfma_f32_16x16x32_bf16 v[116:119], a[28:31], a[84:87], v[116:119]
    buffer_load_dwordx4 v19, s[44:47], s53 offen offset:3072 sc1 lds
    v_mfma_f32_16x16x32_bf16 v[116:119], a[24:27], a[80:83], v[116:119]
    s_add_u32 s53, s53, s56
    ds_read_b64_tr_b16 a[72:73], v9 offset:0
    v_mfma_f32_16x16x32_bf16 v[176:179], a[32:35], a[80:83], v[176:179]
    v_mfma_f32_16x16x32_bf16 v[176:179], a[36:39], a[84:87], v[176:179]
    s_add_u32 m0, s62, 4096
    v_mfma_f32_16x16x32_bf16 v[184:187], a[36:39], a[92:95], v[184:187]
    buffer_load_dwordx4 v20, s[44:47], s54 offen offset:0 sc1 lds
    v_mfma_f32_16x16x32_bf16 v[184:187], a[32:35], a[88:91], v[184:187]
    s_xor_b32 s62, s62, 229376
    ds_read_b64_tr_b16 a[74:75], v9 offset:2048
    v_mfma_f32_16x16x32_bf16 v[188:191], a[40:43], a[88:91], v[188:191]
    v_mfma_f32_16x16x32_bf16 v[188:191], a[44:47], a[92:95], v[188:191]
    v_mfma_f32_16x16x32_bf16 v[180:183], a[44:47], a[84:87], v[180:183]
    buffer_load_dwordx4 v21, s[44:47], s54 offen offset:1024 sc1 lds
    v_mfma_f32_16x16x32_bf16 v[180:183], a[40:43], a[80:83], v[180:183]
    s_add_u32 s54, s54, s56
    ds_read_b64_tr_b16 a[76:77], v9 offset:16384
    v_mfma_f32_16x16x32_bf16 v[240:243], a[48:51], a[80:83], v[240:243]
    v_mfma_f32_16x16x32_bf16 v[240:243], a[52:55], a[84:87], v[240:243]
    v_mfma_f32_16x16x32_bf16 v[248:251], a[52:55], a[92:95], v[248:251]
    buffer_load_dwordx4 v20, s[44:47], s55 offen offset:2048 sc1 lds
    v_mfma_f32_16x16x32_bf16 v[248:251], a[48:51], a[88:91], v[248:251]
    ds_read_b64_tr_b16 a[78:79], v9 offset:18432
    v_mfma_f32_16x16x32_bf16 v[252:255], a[56:59], a[88:91], v[252:255]
    v_add_u32 v6, s63, v6
    v_add_u32 v7, s63, v7
    v_mfma_f32_16x16x32_bf16 v[252:255], a[60:63], a[92:95], v[252:255]
    v_mfma_f32_16x16x32_bf16 v[244:247], a[60:63], a[84:87], v[244:247]
    buffer_load_dwordx4 v21, s[44:47], s55 offen offset:3072 sc1 lds
    v_mfma_f32_16x16x32_bf16 v[244:247], a[56:59], a[80:83], v[244:247]
    s_add_u32 s55, s55, s56
    v_mfma_f32_16x16x32_bf16 v[64:67], a[0:3], a[96:99], v[64:67]
    ds_read_b64_tr_b16 a[80:81], v10 offset:0
    v_mfma_f32_16x16x32_bf16 v[64:67], a[4:7], a[100:103], v[64:67]
    v_mfma_f32_16x16x32_bf16 v[72:75], a[4:7], a[108:111], v[72:75]
    v_mfma_f32_16x16x32_bf16 v[72:75], a[0:3], a[104:107], v[72:75]
    s_add_u32 m0, s61, 0
    ds_read_b64_tr_b16 a[82:83], v10 offset:2048
    v_mfma_f32_16x16x32_bf16 v[76:79], a[8:11], a[104:107], v[76:79]
    buffer_load_dwordx4 v16, s[40:43], s48 offen offset:0 sc1 lds
    v_mfma_f32_16x16x32_bf16 v[76:79], a[12:15], a[108:111], v[76:79]
    v_mfma_f32_16x16x32_bf16 v[68:71], a[12:15], a[100:103], v[68:71]
    ds_read_b64_tr_b16 a[84:85], v10 offset:16384
    v_mfma_f32_16x16x32_bf16 v[68:71], a[8:11], a[96:99], v[68:71]
    v_mfma_f32_16x16x32_bf16 v[128:131], a[16:19], a[96:99], v[128:131]
    v_mfma_f32_16x16x32_bf16 v[128:131], a[20:23], a[100:103], v[128:131]
    ds_read_b64_tr_b16 a[86:87], v10 offset:18432
    v_mfma_f32_16x16x32_bf16 v[136:139], a[20:23], a[108:111], v[136:139]
    v_mfma_f32_16x16x32_bf16 v[136:139], a[16:19], a[104:107], v[136:139]
    v_mfma_f32_16x16x32_bf16 v[140:143], a[24:27], a[104:107], v[140:143]
    buffer_load_dwordx4 v17, s[40:43], s48 offen offset:1024 sc1 lds
    v_mfma_f32_16x16x32_bf16 v[140:143], a[28:31], a[108:111], v[140:143]
    s_add_u32 s48, s48, 128
    ds_read_b64_tr_b16 a[88:89], v11 offset:0
    v_mfma_f32_16x16x32_bf16 v[132:135], a[28:31], a[100:103], v[132:135]
    v_mfma_f32_16x16x32_bf16 v[132:135], a[24:27], a[96:99], v[132:135]
    v_mfma_f32_16x16x32_bf16 v[192:195], a[32:35], a[96:99], v[192:195]
    v_mfma_f32_16x16x32_bf16 v[192:195], a[36:39], a[100:103], v[192:195]
    ds_read_b64_tr_b16 a[90:91], v11 offset:2048
    v_mfma_f32_16x16x32_bf16 v[200:203], a[36:39], a[108:111], v[200:203]
    v_mfma_f32_16x16x32_bf16 v[200:203], a[32:35], a[104:107], v[200:203]
    v_mfma_f32_16x16x32_bf16 v[204:207], a[40:43], a[104:107], v[204:207]
    buffer_load_dwordx4 v16, s[40:43], s49 offen offset:2048 sc1 lds
    v_mfma_f32_16x16x32_bf16 v[204:207], a[44:47], a[108:111], v[204:207]
    ds_read_b64_tr_b16 a[92:93], v11 offset:16384
    v_mfma_f32_16x16x32_bf16 v[196:199], a[44:47], a[100:103], v[196:199]
    v_mfma_f32_16x16x32_bf16 v[196:199], a[40:43], a[96:99], v[196:199]
    v_mfma_f32_16x16x32_bf16 a[224:227], a[48:51], a[96:99], a[224:227]
    v_mfma_f32_16x16x32_bf16 a[224:227], a[52:55], a[100:103], a[224:227]
    ds_read_b64_tr_b16 a[94:95], v11 offset:18432
    v_mfma_f32_16x16x32_bf16 a[232:235], a[52:55], a[108:111], a[232:235]
    v_mfma_f32_16x16x32_bf16 a[232:235], a[48:51], a[104:107], a[232:235]
    v_mfma_f32_16x16x32_bf16 a[236:239], a[56:59], a[104:107], a[236:239]
    buffer_load_dwordx4 v17, s[40:43], s49 offen offset:3072 sc1 lds
    v_mfma_f32_16x16x32_bf16 a[236:239], a[60:63], a[108:111], a[236:239]
    s_add_u32 s49, s49, 128
    v_mfma_f32_16x16x32_bf16 a[228:231], a[60:63], a[100:103], a[228:231]
    v_mfma_f32_16x16x32_bf16 a[228:231], a[56:59], a[96:99], a[228:231]
    v_mfma_f32_16x16x32_bf16 v[80:83], a[0:3], a[112:115], v[80:83]
    v_mfma_f32_16x16x32_bf16 v[80:83], a[4:7], a[116:119], v[80:83]
    ds_read_b64_tr_b16 a[96:97], v12 offset:0
    v_mfma_f32_16x16x32_bf16 v[88:91], a[4:7], a[124:127], v[88:91]
    v_mfma_f32_16x16x32_bf16 v[88:91], a[0:3], a[120:123], v[88:91]
    s_add_u32 m0, s61, 4096
    ds_read_b128 a[0:3], v6 offset:0
    v_mfma_f32_16x16x32_bf16 v[92:95], a[8:11], a[120:123], v[92:95]
    buffer_load_dwordx4 v16, s[40:43], s50 offen offset:0 sc1 lds
    v_mfma_f32_16x16x32_bf16 v[92:95], a[12:15], a[124:127], v[92:95]
    s_add_u32 s61, s61, 32768
    ds_read_b128 a[4:7], v7 offset:0
    v_mfma_f32_16x16x32_bf16 v[84:87], a[12:15], a[116:119], v[84:87]
    s_cmp_ge_u32 s61, 98304
    s_cselect_b32 s90, 98304, 0
    ds_read_b64_tr_b16 a[98:99], v12 offset:2048
    v_mfma_f32_16x16x32_bf16 v[84:87], a[8:11], a[112:115], v[84:87]
    s_sub_u32 s61, s61, s90
    ds_read_b128 a[8:11], v6 offset:2048
    v_mfma_f32_16x16x32_bf16 v[144:147], a[16:19], a[112:115], v[144:147]
    ds_read_b128 a[12:15], v7 offset:2048
    v_mfma_f32_16x16x32_bf16 v[144:147], a[20:23], a[116:119], v[144:147]
    ds_read_b64_tr_b16 a[100:101], v12 offset:16384
    v_mfma_f32_16x16x32_bf16 v[152:155], a[20:23], a[124:127], v[152:155]
    v_mfma_f32_16x16x32_bf16 v[152:155], a[16:19], a[120:123], v[152:155]
    ds_read_b128 a[16:19], v6 offset:4096
    v_mfma_f32_16x16x32_bf16 v[156:159], a[24:27], a[120:123], v[156:159]
    buffer_load_dwordx4 v17, s[40:43], s50 offen offset:1024 sc1 lds
    v_mfma_f32_16x16x32_bf16 v[156:159], a[28:31], a[124:127], v[156:159]
    s_add_u32 s50, s50, 128
    ds_read_b128 a[20:23], v7 offset:4096
    v_mfma_f32_16x16x32_bf16 v[148:151], a[28:31], a[116:119], v[148:151]
    ds_read_b64_tr_b16 a[102:103], v12 offset:18432
    v_mfma_f32_16x16x32_bf16 v[148:151], a[24:27], a[112:115], v[148:151]
    ds_read_b128 a[24:27], v6 offset:6144
    v_mfma_f32_16x16x32_bf16 v[208:211], a[32:35], a[112:115], v[208:211]
    s_sub_u32 s65, s65, 1
    ds_read_b128 a[28:31], v7 offset:6144
    v_mfma_f32_16x16x32_bf16 v[208:211], a[36:39], a[116:119], v[208:211]
    ds_read_b64_tr_b16 a[104:105], v13 offset:0
    v_mfma_f32_16x16x32_bf16 v[216:219], a[36:39], a[124:127], v[216:219]
    v_mfma_f32_16x16x32_bf16 v[216:219], a[32:35], a[120:123], v[216:219]
    ds_read_b128 a[32:35], v6 offset:8192
    v_mfma_f32_16x16x32_bf16 v[220:223], a[40:43], a[120:123], v[220:223]
    buffer_load_dwordx4 v16, s[40:43], s51 offen offset:2048 sc1 lds
    v_mfma_f32_16x16x32_bf16 v[220:223], a[44:47], a[124:127], v[220:223]
    ds_read_b128 a[36:39], v7 offset:8192
    v_mfma_f32_16x16x32_bf16 v[212:215], a[44:47], a[116:119], v[212:215]
    ds_read_b64_tr_b16 a[106:107], v13 offset:2048
    v_mfma_f32_16x16x32_bf16 v[212:215], a[40:43], a[112:115], v[212:215]
    ds_read_b128 a[40:43], v6 offset:10240
    v_mfma_f32_16x16x32_bf16 a[240:243], a[48:51], a[112:115], a[240:243]
    ds_read_b128 a[44:47], v7 offset:10240
    v_mfma_f32_16x16x32_bf16 a[240:243], a[52:55], a[116:119], a[240:243]
    ds_read_b64_tr_b16 a[108:109], v13 offset:16384
    v_mfma_f32_16x16x32_bf16 a[248:251], a[52:55], a[124:127], a[248:251]
    v_mfma_f32_16x16x32_bf16 a[248:251], a[48:51], a[120:123], a[248:251]
    ds_read_b128 a[48:51], v6 offset:12288
    v_mfma_f32_16x16x32_bf16 a[252:255], a[56:59], a[120:123], a[252:255]
    buffer_load_dwordx4 v17, s[40:43], s51 offen offset:3072 sc1 lds
    v_mfma_f32_16x16x32_bf16 a[252:255], a[60:63], a[124:127], a[252:255]
    s_add_u32 s51, s51, 128
    ds_read_b128 a[52:55], v7 offset:12288
    v_mfma_f32_16x16x32_bf16 a[244:247], a[60:63], a[116:119], a[244:247]
    s_cmp_gt_u32 s65, s67
    ds_read_b64_tr_b16 a[110:111], v13 offset:18432
    v_mfma_f32_16x16x32_bf16 a[244:247], a[56:59], a[112:115], a[244:247]
    ds_read_b128 a[56:59], v6 offset:14336
    ds_read_b128 a[60:63], v7 offset:14336
    s_cbranch_scc1 m_loop25
    s_cmp_eq_u32 s65, 0
    s_cbranch_scc1 m_epi15
m_dosw26:
    s_cmp_eq_u32 s94, 0
    s_cbranch_scc1 m_x61
    s_cmp_lg_u32 s65, 3
    s_cbranch_scc1 m_x67
    s_mov_b32 s42, s73
    s_lshl_b32 s90, s77, 4
    s_lshl_b32 s90, s90, s81
    s_mov_b32 s48, s79
    s_mul_i32 s91, s90, 1
    s_add_u32 s49, s91, s79
    s_sub_u32 s49, s49, 2048
    s_mul_i32 s91, s90, 2
    s_add_u32 s50, s91, s79
    s_mul_i32 s91, s90, 3
    s_add_u32 s51, s91, s79
    s_sub_u32 s51, s51, 2048
    s_lshl_b32 s90, s58, 7
    s_add_u32 s90, s90, s57
    s_lshl_b32 s91, s16, 6
    s_cmp_eq_u32 s81, 1
    s_cselect_b32 s90, s90, s91
    v_lshrrev_b32 v24, 3, v1
    v_lshlrev_b32 v24, s81, v24
    v_add_u32 v24, s90, v24
    v_mul_lo_u32 v24, v24, s77
    v_lshrrev_b32 v25, 4, v1
    v_and_b32 v26, 7, v1
    v_xor_b32 v25, v25, v26
    v_lshl_add_u32 v16, v25, 4, v24
    v_xor_b32 v25, 4, v25
    v_lshl_add_u32 v17, v25, 4, v24
    s_lshl_b32 s90, s77, 3
    s_lshl_b32 s90, s90, s81
    s_sub_u32 s90, s90, 1024
    v_add_u32 v17, s90, v17
    s_mov_b32 s40, s71
    s_mov_b32 s41, s72
    buffer_load_dwordx2 v[4:5], off, s[12:15], 0 sc1
    s_branch m_loop25
m_x67:
    s_mov_b32 s46, s76
    s_mov_b32 s52, s80
    s_lshl_b32 s90, s78, 2
    s_mul_i32 s91, s90, 1
    s_add_u32 s53, s91, s80
    s_sub_u32 s53, s53, 2048
    s_mul_i32 s91, s90, 2
    s_add_u32 s54, s91, s80
    s_mul_i32 s91, s90, 3
    s_add_u32 s55, s91, s80
    s_sub_u32 s55, s55, 2048
    s_lshl_b32 s56, s78, 6
    v_lshrrev_b32 v24, 5, v1
    s_lshl_b32 s90, s16, 4
    v_add_u32 v25, s90, v24
    v_mul_lo_u32 v25, v25, s78
    v_lshlrev_b32 v24, 1, v24
    v_and_b32 v26, 31, v1
    v_xor_b32 v24, v24, v26
    s_lshl_b32 s90, s78, 1
    s_sub_u32 s90, s90, 1024
    v_add_u32 v27, s90, v25
    v_xor_b32 v26, 0, v24
    v_lshl_add_u32 v18, v26, 4, v25
    v_xor_b32 v26, 4, v24
    v_lshl_add_u32 v19, v26, 4, v27
    v_xor_b32 v26, 8, v24
    v_lshl_add_u32 v20, v26, 4, v25
    v_xor_b32 v26, 12, v24
    v_lshl_add_u32 v21, v26, 4, v27
    s_mov_b32 s44, s74
    s_mov_b32 s45, s75
    s_mov_b32 s67, 0
    s_branch m_loop25
m_x61:
    s_cmp_le_u32 s65, 4
    s_cbranch_scc1 m_x62
    s_cmp_lg_u32 s16, 0
    s_cbranch_scc1 m_np68
    v_mov_b32 v4, s4
    v_mov_b32 v5, s5
    s_add_u32 s90, s17, 117440512
    s_mov_b64 exec, 1
    buffer_store_dwordx2 v[4:5], off, s[8:11], s90 sc1
    s_mov_b64 exec, -1
m_np68:
    s_mov_b32 s17, -1
    s_mov_b32 s67, 4
    s_branch m_loop25
m_x62:
    s_cmp_lg_u32 s65, 4
    s_cbranch_scc1 m_x63
    s_cmp_eq_u32 s70, 1
    s_cbranch_scc1 m_ea69
    buffer_load_dwordx2 v[4:5], v0, s[8:11], s37 offen sc1
m_eb70:
    s_branch m_loop25
m_x63:
    s_waitcnt vmcnt(16)
    s_cmp_lg_u32 s65, 3
    s_cbranch_scc1 m_x64
    s_cmp_eq_u32 s70, 1
    s_cbranch_scc1 m_ea71
    s_mov_b32 s3, 262144
m_spin73:
    v_cmp_ne_u64 s[22:23], s[4:5], v[4:5]
    s_nop 3
    s_cmp_eq_u64 s[22:23], 0
    s_cbranch_scc1 m_ok74
    s_sub_u32 s3, s3, 1
    s_cbranch_scc1 m_ok74
    s_sleep 16
    buffer_load_dwordx2 v[4:5], v0, s[8:11], s37 offen sc1
    s_waitcnt vmcnt(0)
    s_branch m_spin73
m_ok74:
    buffer_load_dwordx4 a[128:131], v2, s[8:11], s33 offen offset:0 sc1
    buffer_load_dwordx4 a[132:135], v2, s[8:11], s33 offen offset:1024 sc1
    buffer_load_dwordx4 a[136:139], v2, s[8:11], s33 offen offset:2048 sc1
    buffer_load_dwordx4 a[140:143], v2, s[8:11], s33 offen offset:3072 sc1
    buffer_load_dwordx4 a[144:147], v2, s[8:11], s34 offen offset:0 sc1
    buffer_load_dwordx4 a[148:151], v2, s[8:11], s34 offen offset:1024 sc1
m_eb72:
    s_add_u32 s48, s32, 0
    s_mov_b32 s49, s48
    s_add_u32 s50, s48, 4096
    s_mov_b32 s51, s50
    s_cmp_eq_u32 s57, 0
    s_cselect_b32 s42, 268435456, 0
    s_mov_b32 s40, s6
    s_mov_b32 s41, s7
    v_mov_b32 v16, v2
    v_mov_b32 v17, v2
    s_branch m_loop25
m_x64:
    s_cmp_lg_u32 s65, 2
    s_cbranch_scc1 m_x65
    s_cmp_eq_u32 s70, 1
    s_cbranch_scc1 m_ea75
    buffer_load_dwordx4 a[152:155], v2, s[8:11], s34 offen offset:2048 sc1
    buffer_load_dwordx4 a[156:159], v2, s[8:11], s34 offen offset:3072 sc1
    buffer_load_dwordx4 a[160:163], v2, s[8:11], s35 offen offset:0 sc1
    buffer_load_dwordx4 a[164:167], v2, s[8:11], s35 offen offset:1024 sc1
    buffer_load_dwordx4 a[168:171], v2, s[8:11], s35 offen offset:2048 sc1
m_eb76:
    s_add_u32 s48, s32, 16384
    s_mov_b32 s49, s48
    s_add_u32 s50, s48, 4096
    s_mov_b32 s51, s50
    s_mov_b32 s42, 268435456
    s_add_u32 s52, s32, 49152
    s_mov_b32 s53, s52
    s_add_u32 s54, s52, 4096
    s_mov_b32 s55, s54
    s_mov_b32 s46, 268435456
    s_mov_b32 s44, s6
    s_mov_b32 s45, s7
    v_mov_b32 v18, v2
    v_mov_b32 v19, v2
    v_mov_b32 v20, v2
    v_mov_b32 v21, v2
    s_branch m_loop25
m_x65:
    s_cmp_eq_u32 s70, 1
    s_cbranch_scc1 m_ea77
    buffer_load_dwordx4 a[172:175], v2, s[8:11], s35 offen offset:3072 sc1
    buffer_load_dwordx4 a[176:179], v2, s[8:11], s36 offen offset:0 sc1
    buffer_load_dwordx4 a[180:183], v2, s[8:11], s36 offen offset:1024 sc1
    buffer_load_dwordx4 a[184:187], v2, s[8:11], s36 offen offset:2048 sc1
    buffer_load_dwordx4 a[188:191], v2, s[8:11], s36 offen offset:3072 sc1
m_eb78:
    s_add_u32 s48, s32, 32768
    s_mov_b32 s49, s48
    s_add_u32 s50, s48, 4096
    s_mov_b32 s51, s50
    s_add_u32 s52, s32, 65536
    s_mov_b32 s53, s52
    s_add_u32 s54, s52, 4096
    s_mov_b32 s55, s54
    s_branch m_loop25
m_ea69:
    s_and_b32 s92, s2, 7
    s_lshl_b32 s92, s92, 2
    s_bfe_u32 s93, s2, 0x20003
    s_add_u32 s92, s92, s93
    s_lshr_b32 s93, s2, 5
    s_lshl_b32 s93, s93, 2
    s_or_b32 s93, s93, 0x40000
    v_and_b32 v0, 3, v1
    v_min_u32 v0, 2, v0
    v_and_b32 v24, 4, v1
    v_add3_u32 v0, v0, v24, 8
    v_lshlrev_b32 v0, 3, v0
    buffer_load_dwordx2 v[4:5], v0, s[8:11], s37 offen sc1
    s_branch m_eb70
m_ea71:
    s_mov_b32 s3, 262144
m_spin79:
    v_cmp_ne_u64 s[22:23], s[4:5], v[4:5]
    s_nop 3
    s_cmp_eq_u64 s[22:23], 0
    s_cbranch_scc1 m_ok80
    s_sub_u32 s3, s3, 1
    s_cbranch_scc1 m_ok80
    s_sleep 16
    buffer_load_dwordx2 v[4:5], v0, s[8:11], s37 offen sc1
    s_waitcnt vmcnt(0)
    s_branch m_spin79
m_ok80:
    s_branch m_eb72
m_ea75:
    s_and_b32 s92, s2, 7
    s_lshl_b32 s92, s92, 2
    s_bfe_u32 s93, s2, 0x20003
    s_add_u32 s92, s92, s93
    s_lshr_b32 s93, s2, 5
    s_lshl_b32 s93, s93, 2
    s_or_b32 s93, s93, 0x40000
    s_bfe_u32 s91, 873484918, s93
    s_lshr_b32 s91, s91, 1
    v_mov_b32 v0, s91
    s_bfe_u32 s91, 4225674377, s93
    s_lshr_b32 s91, s91, 1
    v_writelane_b32 v0, s91, 8
    v_lshlrev_b32 v0, 3, v0
    buffer_load_dwordx2 v[4:5], v0, s[8:11], s37 offen sc1
    s_branch m_eb76
m_ea77:
    s_mov_b32 s3, 262144
m_spin81:
    v_cmp_ne_u64 s[22:23], s[4:5], v[4:5]
    s_nop 3
    s_cmp_eq_u64 s[22:23], 0
    s_cbranch_scc1 m_ok82
    s_sub_u32 s3, s3, 1
    s_cbranch_scc1 m_ok82
    s_sleep 16
    buffer_load_dwordx2 v[4:5], v0, s[8:11], s37 offen sc1
    s_waitcnt vmcnt(0)
    s_branch m_spin81
m_ok82:
    buffer_load_dwordx4 a[128:131], v2, s[8:11], s33 offen offset:0 sc1
    buffer_load_dwordx4 a[132:135], v2, s[8:11], s33 offen offset:1024 sc1
    buffer_load_dwordx4 a[136:139], v2, s[8:11], s33 offen offset:2048 sc1
    buffer_load_dwordx4 a[140:143], v2, s[8:11], s33 offen offset:3072 sc1
    buffer_load_dwordx4 a[144:147], v2, s[8:11], s34 offen offset:0 sc1
    buffer_load_dwordx4 a[148:151], v2, s[8:11], s34 offen offset:1024 sc1
    buffer_load_dwordx4 a[152:155], v2, s[8:11], s34 offen offset:2048 sc1
    buffer_load_dwordx4 a[156:159], v2, s[8:11], s34 offen offset:3072 sc1
    buffer_load_dwordx4 a[160:163], v2, s[8:11], s35 offen offset:0 sc1
    buffer_load_dwordx4 a[164:167], v2, s[8:11], s35 offen offset:1024 sc1
    buffer_load_dwordx4 a[168:171], v2, s[8:11], s35 offen offset:2048 sc1
    buffer_load_dwordx4 a[172:175], v2, s[8:11], s35 offen offset:3072 sc1
    buffer_load_dwordx4 a[176:179], v2, s[8:11], s36 offen offset:0 sc1
    buffer_load_dwordx4 a[180:183], v2, s[8:11], s36 offen offset:1024 sc1
    buffer_load_dwordx4 a[184:187], v2, s[8:11], s36 offen offset:2048 sc1
    buffer_load_dwordx4 a[188:191], v2, s[8:11], s36 offen offset:3072 sc1
    s_branch m_eb78
m_epi15:
    s_cmp_eq_u32 s94, 0
    s_cbranch_scc1 m_last29
    s_mov_b32 s3, 262144
m_spin33:
    v_readfirstlane_b32 s4, v4
    v_readfirstlane_b32 s5, v5
    s_nop 3
    s_cmp_lg_u32 s4, 0
    s_cbranch_scc1 m_ok34
    s_sub_u32 s3, s3, 1
    s_cbranch_scc1 m_ok34
    s_sleep 32
    buffer_load_dwordx2 v[4:5], off, s[12:15], 0 sc1
    s_waitcnt vmcnt(0)
    s_branch m_spin33
m_ok34:
    s_cmp_ge_u32 s68, 16
    s_cbranch_scc1 m_q036
m_epf27:
    s_nop 7
    s_mov_b32 s91, s98
    s_mov_b32 s92, s97
    s_mov_b32 s93, s97
    s_mov_b32 s90, s91
    v_pk_mul_f32 v[32:33], v[32:33], s[92:93]
    v_pk_mul_f32 v[34:35], v[34:35], s[92:93]
    v_pk_mul_f32 v[36:37], v[36:37], s[92:93]
    v_pk_mul_f32 v[38:39], v[38:39], s[92:93]
    v_cvt_pk_bf16_f32 v32, v32, v33
    v_cvt_pk_bf16_f32 v33, v34, v35
    v_cvt_pk_bf16_f32 v34, v36, v37
    v_cvt_pk_bf16_f32 v35, v38, v39
    buffer_store_dwordx4 v[32:35], v2, s[8:11], s90 offen sc1
    s_add_u32 s90, s90, s100
    v_pk_mul_f32 v[40:41], v[40:41], s[92:93]
    v_pk_mul_f32 v[42:43], v[42:43], s[92:93]
    v_pk_mul_f32 v[44:45], v[44:45], s[92:93]
    v_pk_mul_f32 v[46:47], v[46:47], s[92:93]
    v_cvt_pk_bf16_f32 v40, v40, v41
    v_cvt_pk_bf16_f32 v41, v42, v43
    v_cvt_pk_bf16_f32 v42, v44, v45
    v_cvt_pk_bf16_f32 v43, v46, v47
    buffer_store_dwordx4 v[40:43], v2, s[8:11], s90 offen sc1
    s_add_u32 s90, s90, s100
    v_pk_mul_f32 v[48:49], v[48:49], s[92:93]
    v_pk_mul_f32 v[50:51], v[50:51], s[92:93]
    v_pk_mul_f32 v[52:53], v[52:53], s[92:93]
    v_pk_mul_f32 v[54:55], v[54:55], s[92:93]
    v_cvt_pk_bf16_f32 v48, v48, v49
    v_cvt_pk_bf16_f32 v49, v50, v51
    v_cvt_pk_bf16_f32 v50, v52, v53
    v_cvt_pk_bf16_f32 v51, v54, v55
    buffer_store_dwordx4 v[48:51], v2, s[8:11], s90 offen sc1
    s_add_u32 s90, s90, s100
    v_pk_mul_f32 v[56:57], v[56:57], s[92:93]
    v_pk_mul_f32 v[58:59], v[58:59], s[92:93]
    v_pk_mul_f32 v[60:61], v[60:61], s[92:93]
    v_pk_mul_f32 v[62:63], v[62:63], s[92:93]
    v_cvt_pk_bf16_f32 v56, v56, v57
    v_cvt_pk_bf16_f32 v57, v58, v59
    v_cvt_pk_bf16_f32 v58, v60, v61
    v_cvt_pk_bf16_f32 v59, v62, v63
    buffer_store_dwordx4 v[56:59], v2, s[8:11], s90 offen sc1
    s_add_u32 s90, s90, s100
    v_pk_mul_f32 v[64:65], v[64:65], s[92:93]
    v_pk_mul_f32 v[66:67], v[66:67], s[92:93]
    v_pk_mul_f32 v[68:69], v[68:69], s[92:93]
    v_pk_mul_f32 v[70:71], v[70:71], s[92:93]
    v_cvt_pk_bf16_f32 v64, v64, v65
    v_cvt_pk_bf16_f32 v65, v66, v67
    v_cvt_pk_bf16_f32 v66, v68, v69
    v_cvt_pk_bf16_f32 v67, v70, v71
    buffer_store_dwordx4 v[64:67], v2, s[8:11], s90 offen sc1
    s_add_u32 s90, s90, s100
    v_pk_mul_f32 v[72:73], v[72:73], s[92:93]
    v_pk_mul_f32 v[74:75], v[74:75], s[92:93]
    v_pk_mul_f32 v[76:77], v[76:77], s[92:93]
    v_pk_mul_f32 v[78:79], v[78:79], s[92:93]
    v_cvt_pk_bf16_f32 v72, v72, v73
    v_cvt_pk_bf16_f32 v73, v74, v75
    v_cvt_pk_bf16_f32 v74, v76, v77
    v_cvt_pk_bf16_f32 v75, v78, v79
    buffer_store_dwordx4 v[72:75], v2, s[8:11], s90 offen sc1
    s_add_u32 s90, s90, s100
    v_pk_mul_f32 v[80:81], v[80:81], s[92:93]
    v_pk_mul_f32 v[82:83], v[82:83], s[92:93]
    v_pk_mul_f32 v[84:85], v[84:85], s[92:93]
    v_pk_mul_f32 v[86:87], v[86:87], s[92:93]
    v_cvt_pk_bf16_f32 v80, v80, v81
    v_cvt_pk_bf16_f32 v81, v82, v83
    v_cvt_pk_bf16_f32 v82, v84, v85
    v_cvt_pk_bf16_f32 v83, v86, v87
    buffer_store_dwordx4 v[80:83], v2, s[8:11], s90 offen sc1
    s_add_u32 s90, s90, s100
    v_pk_mul_f32 v[88:89], v[88:89], s[92:93]
    v_pk_mul_f32 v[90:91], v[90:91], s[92:93]
    v_pk_mul_f32 v[92:93], v[92:93], s[92:93]
    v_pk_mul_f32 v[94:95], v[94:95], s[92:93]
    v_cvt_pk_bf16_f32 v88, v88, v89
    v_cvt_pk_bf16_f32 v89, v90, v91
    v_cvt_pk_bf16_f32 v90, v92, v93
    v_cvt_pk_bf16_f32 v91, v94, v95
    buffer_store_dwordx4 v[88:91], v2, s[8:11], s90 offen sc1
    s_add_u32 s90, s90, s100
    s_add_u32 s91, s91, s99
    s_mov_b32 s90, s91
    v_pk_mul_f32 v[96:97], v[96:97], s[92:93]
    v_pk_mul_f32 v[98:99], v[98:99], s[92:93]
    v_pk_mul_f32 v[100:101], v[100:101], s[92:93]
    v_pk_mul_f32 v[102:103], v[102:103], s[92:93]
    v_cvt_pk_bf16_f32 v96, v96, v97
    v_cvt_pk_bf16_f32 v97, v98, v99
    v_cvt_pk_bf16_f32 v98, v100, v101
    v_cvt_pk_bf16_f32 v99, v102, v103
    buffer_store_dwordx4 v[96:99], v2, s[8:11], s90 offen sc1
    s_add_u32 s90, s90, s100
    v_pk_mul_f32 v[104:105], v[104:105], s[92:93]
    v_pk_mul_f32 v[106:107], v[106:107], s[92:93]
    v_pk_mul_f32 v[108:109], v[108:109], s[92:93]
    v_pk_mul_f32 v[110:111], v[110:111], s[92:93]
    v_cvt_pk_bf16_f32 v104, v104, v105
    v_cvt_pk_bf16_f32 v105, v106, v107
    v_cvt_pk_bf16_f32 v106, v108, v109
    v_cvt_pk_bf16_f32 v107, v110, v111
    buffer_store_dwordx4 v[104:107], v2, s[8:11], s90 offen sc1
    s_add_u32 s90, s90, s100
    v_pk_mul_f32 v[112:113], v[112:113], s[92:93]
    v_pk_mul_f32 v[114:115], v[114:115], s[92:93]
    v_pk_mul_f32 v[116:117], v[116:117], s[92:93]
    v_pk_mul_f32 v[118:119], v[118:119], s[92:93]
    v_cvt_pk_bf16_f32 v112, v112, v113
    v_cvt_pk_bf16_f32 v113, v114, v115
    v_cvt_pk_bf16_f32 v114, v116, v117
    v_cvt_pk_bf16_f32 v115, v118, v119
    buffer_store_dwordx4 v[112:115], v2, s[8:11], s90 offen sc1
    s_add_u32 s90, s90, s100
    v_pk_mul_f32 v[120:121], v[120:121], s[92:93]
    v_pk_mul_f32 v[122:123], v[122:123], s[92:93]
    v_pk_mul_f32 v[124:125], v[124:125], s[92:93]
    v_pk_mul_f32 v[126:127], v[126:127], s[92:93]
    v_cvt_pk_bf16_f32 v120, v120, v121
    v_cvt_pk_bf16_f32 v121, v122, v123
    v_cvt_pk_bf16_f32 v122, v124, v125
    v_cvt_pk_bf16_f32 v123, v126, v127
    buffer_store_dwordx4 v[120:123], v2, s[8:11], s90 offen sc1
    s_add_u32 s90, s90, s100
    v_pk_mul_f32 v[128:129], v[128:129], s[92:93]
    v_pk_mul_f32 v[130:131], v[130:131], s[92:93]
    v_pk_mul_f32 v[132:133], v[132:133], s[92:93]
    v_pk_mul_f32 v[134:135], v[134:135], s[92:93]
    v_cvt_pk_bf16_f32 v128, v128, v129
    v_cvt_pk_bf16_f32 v129, v130, v131
    v_cvt_pk_bf16_f32 v130, v132, v133
    v_cvt_pk_bf16_f32 v131, v134, v135
    buffer_store_dwordx4 v[128:131], v2, s[8:11], s90 offen sc1
    s_add_u32 s90, s90, s100
    v_pk_mul_f32 v[136:137], v[136:137], s[92:93]
    v_pk_mul_f32 v[138:139], v[138:139], s[92:93]
    v_pk_mul_f32 v[140:141], v[140:141], s[92:93]
    v_pk_mul_f32 v[142:143], v[142:143], s[92:93]
    v_cvt_pk_bf16_f32 v136, v136, v137
    v_cvt_pk_bf16_f32 v137, v138, v139
    v_cvt_pk_bf16_f32 v138, v140, v141
    v_cvt_pk_bf16_f32 v139, v142, v143
    buffer_store_dwordx4 v[136:139], v2, s[8:11], s90 offen sc1
    s_add_u32 s90, s90, s100
    v_pk_mul_f32 v[144:145], v[144:145], s[92:93]
    v_pk_mul_f32 v[146:147], v[146:147], s[92:93]
    v_pk_mul_f32 v[148:149], v[148:149], s[92:93]
    v_pk_mul_f32 v[150:151], v[150:151], s[92:93]
    v_cvt_pk_bf16_f32 v144, v144, v145
    v_cvt_pk_bf16_f32 v145, v146, v147
    v_cvt_pk_bf16_f32 v146, v148, v149
    v_cvt_pk_bf16_f32 v147, v150, v151
    buffer_store_dwordx4 v[144:147], v2, s[8:11], s90 offen sc1
    s_add_u32 s90, s90, s100
    v_pk_mul_f32 v[152:153], v[152:153], s[92:93]
    v_pk_mul_f32 v[154:155], v[154:155], s[92:93]
    v_pk_mul_f32 v[156:157], v[156:157], s[92:93]
    v_pk_mul_f32 v[158:159], v[158:159], s[92:93]
    v_cvt_pk_bf16_f32 v152, v152, v153
    v_cvt_pk_bf16_f32 v153, v154, v155
    v_cvt_pk_bf16_f32 v154, v156, v157
    v_cvt_pk_bf16_f32 v155, v158, v159
    buffer_store_dwordx4 v[152:155], v2, s[8:11], s90 offen sc1
    s_add_u32 s90, s90, s100
    s_add_u32 s91, s91, s99
    s_mov_b32 s90, s91
    v_pk_mul_f32 v[160:161], v[160:161], s[92:93]
    v_pk_mul_f32 v[162:163], v[162:163], s[92:93]
    v_pk_mul_f32 v[164:165], v[164:165], s[92:93]
    v_pk_mul_f32 v[166:167], v[166:167], s[92:93]
    v_cvt_pk_bf16_f32 v160, v160, v161
    v_cvt_pk_bf16_f32 v161, v162, v163
    v_cvt_pk_bf16_f32 v162, v164, v165
    v_cvt_pk_bf16_f32 v163, v166, v167
    buffer_store_dwordx4 v[160:163], v2, s[8:11], s90 offen sc1
    s_add_u32 s90, s90, s100
    v_pk_mul_f32 v[168:169], v[168:169], s[92:93]
    v_pk_mul_f32 v[170:171], v[170:171], s[92:93]
    v_pk_mul_f32 v[172:173], v[172:173], s[92:93]
    v_pk_mul_f32 v[174:175], v[174:175], s[92:93]
    v_cvt_pk_bf16_f32 v168, v168, v169
    v_cvt_pk_bf16_f32 v169, v170, v171
    v_cvt_pk_bf16_f32 v170, v172, v173
    v_cvt_pk_bf16_f32 v171, v174, v175
    buffer_store_dwordx4 v[168:171], v2, s[8:11], s90 offen sc1
    s_add_u32 s90, s90, s100
    v_pk_mul_f32 v[176:177], v[176:177], s[92:93]
    v_pk_mul_f32 v[178:179], v[178:179], s[92:93]
    v_pk_mul_f32 v[180:181], v[180:181], s[92:93]
    v_pk_mul_f32 v[182:183], v[182:183], s[92:93]
    v_cvt_pk_bf16_f32 v176, v176, v177
    v_cvt_pk_bf16_f32 v177, v178, v179
    v_cvt_pk_bf16_f32 v178, v180, v181
    v_cvt_pk_bf16_f32 v179, v182, v183
    buffer_store_dwordx4 v[176:179], v2, s[8:11], s90 offen sc1
    s_add_u32 s90, s90, s100
    v_pk_mul_f32 v[184:185], v[184:185], s[92:93]
    v_pk_mul_f32 v[186:187], v[186:187], s[92:93]
    v_pk_mul_f32 v[188:189], v[188:189], s[92:93]
    v_pk_mul_f32 v[190:191], v[190:191], s[92:93]
    v_cvt_pk_bf16_f32 v184, v184, v185
    v_cvt_pk_bf16_f32 v185, v186, v187
    v_cvt_pk_bf16_f32 v186, v188, v189
    v_cvt_pk_bf16_f32 v187, v190, v191
    buffer_store_dwordx4 v[184:187], v2, s[8:11], s90 offen sc1
    s_add_u32 s90, s90, s100
    v_pk_mul_f32 v[192:193], v[192:193], s[92:93]
    v_pk_mul_f32 v[194:195], v[194:195], s[92:93]
    v_pk_mul_f32 v[196:197], v[196:197], s[92:93]
    v_pk_mul_f32 v[198:199], v[198:199], s[92:93]
    v_cvt_pk_bf16_f32 v192, v192, v193
    v_cvt_pk_bf16_f32 v193, v194, v195
    v_cvt_pk_bf16_f32 v194, v196, v197
    v_cvt_pk_bf16_f32 v195, v198, v199
    buffer_store_dwordx4 v[192:195], v2, s[8:11], s90 offen sc1
    s_add_u32 s90, s90, s100
    v_pk_mul_f32 v[200:201], v[200:201], s[92:93]
    v_pk_mul_f32 v[202:203], v[202:203], s[92:93]
    v_pk_mul_f32 v[204:205], v[204:205], s[92:93]
    v_pk_mul_f32 v[206:207], v[206:207], s[92:93]
    v_cvt_pk_bf16_f32 v200, v200, v201
    v_cvt_pk_bf16_f32 v201, v202, v203
    v_cvt_pk_bf16_f32 v202, v204, v205
    v_cvt_pk_bf16_f32 v203, v206, v207
    buffer_store_dwordx4 v[200:203], v2, s[8:11], s90 offen sc1
    s_add_u32 s90, s90, s100
    v_pk_mul_f32 v[208:209], v[208:209], s[92:93]
    v_pk_mul_f32 v[210:211], v[210:211], s[92:93]
    v_pk_mul_f32 v[212:213], v[212:213], s[92:93]
    v_pk_mul_f32 v[214:215], v[214:215], s[92:93]
    v_cvt_pk_bf16_f32 v208, v208, v209
    v_cvt_pk_bf16_f32 v209, v210, v211
    v_cvt_pk_bf16_f32 v210, v212, v213
    v_cvt_pk_bf16_f32 v211, v214, v215
    buffer_store_dwordx4 v[208:211], v2, s[8:11], s90 offen sc1
    s_add_u32 s90, s90, s100
    v_pk_mul_f32 v[216:217], v[216:217], s[92:93]
    v_pk_mul_f32 v[218:219], v[218:219], s[92:93]
    v_pk_mul_f32 v[220:221], v[220:221], s[92:93]
    v_pk_mul_f32 v[222:223], v[222:223], s[92:93]
    v_cvt_pk_bf16_f32 v216, v216, v217
    v_cvt_pk_bf16_f32 v217, v218, v219
    v_cvt_pk_bf16_f32 v218, v220, v221
    v_cvt_pk_bf16_f32 v219, v222, v223
    buffer_store_dwordx4 v[216:219], v2, s[8:11], s90 offen sc1
    s_add_u32 s90, s90, s100
    s_add_u32 s91, s91, s99
    s_mov_b32 s90, s91
    v_pk_mul_f32 v[224:225], v[224:225], s[92:93]
    v_pk_mul_f32 v[226:227], v[226:227], s[92:93]
    v_pk_mul_f32 v[228:229], v[228:229], s[92:93]
    v_pk_mul_f32 v[230:231], v[230:231], s[92:93]
    v_cvt_pk_bf16_f32 v224, v224, v225
    v_cvt_pk_bf16_f32 v225, v226, v227
    v_cvt_pk_bf16_f32 v226, v228, v229
    v_cvt_pk_bf16_f32 v227, v230, v231
    buffer_store_dwordx4 v[224:227], v2, s[8:11], s90 offen sc1
    s_add_u32 s90, s90, s100
    v_pk_mul_f32 v[232:233], v[232:233], s[92:93]
    v_pk_mul_f32 v[234:235], v[234:235], s[92:93]
    v_pk_mul_f32 v[236:237], v[236:237], s[92:93]
    v_pk_mul_f32 v[238:239], v[238:239], s[92:93]
    v_cvt_pk_bf16_f32 v232, v232, v233
    v_cvt_pk_bf16_f32 v233, v234, v235
    v_cvt_pk_bf16_f32 v234, v236, v237
    v_cvt_pk_bf16_f32 v235, v238, v239
    buffer_store_dwordx4 v[232:235], v2, s[8:11], s90 offen sc1
    s_add_u32 s90, s90, s100
    v_pk_mul_f32 v[240:241], v[240:241], s[92:93]
    v_pk_mul_f32 v[242:243], v[242:243], s[92:93]
    v_pk_mul_f32 v[244:245], v[244:245], s[92:93]
    v_pk_mul_f32 v[246:247], v[246:247], s[92:93]
    v_cvt_pk_bf16_f32 v240, v240, v241
    v_cvt_pk_bf16_f32 v241, v242, v243
    v_cvt_pk_bf16_f32 v242, v244, v245
    v_cvt_pk_bf16_f32 v243, v246, v247
    buffer_store_dwordx4 v[240:243], v2, s[8:11], s90 offen sc1
    s_add_u32 s90, s90, s100
    v_pk_mul_f32 v[248:249], v[248:249], s[92:93]
    v_pk_mul_f32 v[250:251], v[250:251], s[92:93]
    v_pk_mul_f32 v[252:253], v[252:253], s[92:93]
    v_pk_mul_f32 v[254:255], v[254:255], s[92:93]
    v_cvt_pk_bf16_f32 v248, v248, v249
    v_cvt_pk_bf16_f32 v249, v250, v251
    v_cvt_pk_bf16_f32 v250, v252, v253
    v_cvt_pk_bf16_f32 v251, v254, v255
    buffer_store_dwordx4 v[248:251], v2, s[8:11], s90 offen sc1
    s_add_u32 s90, s90, s100
    v_accvgpr_read_b32 v24, a224
    v_accvgpr_read_b32 v25, a225
    v_accvgpr_read_b32 v26, a226
    v_accvgpr_read_b32 v27, a227
    v_accvgpr_read_b32 v28, a228
    v_accvgpr_read_b32 v29, a229
    v_accvgpr_read_b32 v30, a230
    v_accvgpr_read_b32 v31, a231
    v_pk_mul_f32 v[24:25], v[24:25], s[92:93]
    v_pk_mul_f32 v[26:27], v[26:27], s[92:93]
    v_pk_mul_f32 v[28:29], v[28:29], s[92:93]
    v_pk_mul_f32 v[30:31], v[30:31], s[92:93]
    v_cvt_pk_bf16_f32 v24, v24, v25
    v_cvt_pk_bf16_f32 v25, v26, v27
    v_cvt_pk_bf16_f32 v26, v28, v29
    v_cvt_pk_bf16_f32 v27, v30, v31
    buffer_store_dwordx4 v[24:27], v2, s[8:11], s90 offen sc1
    s_add_u32 s90, s90, s100
    s_nop 1
    v_accvgpr_read_b32 v24, a232
    v_accvgpr_read_b32 v25, a233
    v_accvgpr_read_b32 v26, a234
    v_accvgpr_read_b32 v27, a235
    v_accvgpr_read_b32 v28, a236
    v_accvgpr_read_b32 v29, a237
    v_accvgpr_read_b32 v30, a238
    v_accvgpr_read_b32 v31, a239
    v_pk_mul_f32 v[24:25], v[24:25], s[92:93]
    v_pk_mul_f32 v[26:27], v[26:27], s[92:93]
    v_pk_mul_f32 v[28:29], v[28:29], s[92:93]
    v_pk_mul_f32 v[30:31], v[30:31], s[92:93]
    v_cvt_pk_bf16_f32 v24, v24, v25
    v_cvt_pk_bf16_f32 v25, v26, v27
    v_cvt_pk_bf16_f32 v26, v28, v29
    v_cvt_pk_bf16_f32 v27, v30, v31
    buffer_store_dwordx4 v[24:27], v2, s[8:11], s90 offen sc1
    s_add_u32 s90, s90, s100
    s_nop 1
    v_accvgpr_read_b32 v24, a240
    v_accvgpr_read_b32 v25, a241
    v_accvgpr_read_b32 v26, a242
    v_accvgpr_read_b32 v27, a243
    v_accvgpr_read_b32 v28, a244
    v_accvgpr_read_b32 v29, a245
    v_accvgpr_read_b32 v30, a246
    v_accvgpr_read_b32 v31, a247
    v_pk_mul_f32 v[24:25], v[24:25], s[92:93]
    v_pk_mul_f32 v[26:27], v[26:27], s[92:93]
    v_pk_mul_f32 v[28:29], v[28:29], s[92:93]
    v_pk_mul_f32 v[30:31], v[30:31], s[92:93]
    v_cvt_pk_bf16_f32 v24, v24, v25
    v_cvt_pk_bf16_f32 v25, v26, v27
    v_cvt_pk_bf16_f32 v26, v28, v29
    v_cvt_pk_bf16_f32 v27, v30, v31
    buffer_store_dwordx4 v[24:27], v2, s[8:11], s90 offen sc1
    s_add_u32 s90, s90, s100
    s_nop 1
    v_accvgpr_read_b32 v24, a248
    v_accvgpr_read_b32 v25, a249
    v_accvgpr_read_b32 v26, a250
    v_accvgpr_read_b32 v27, a251
    v_accvgpr_read_b32 v28, a252
    v_accvgpr_read_b32 v29, a253
    v_accvgpr_read_b32 v30, a254
    v_accvgpr_read_b32 v31, a255
    v_pk_mul_f32 v[24:25], v[24:25], s[92:93]
    v_pk_mul_f32 v[26:27], v[26:27], s[92:93]
    v_pk_mul_f32 v[28:29], v[28:29], s[92:93]
    v_pk_mul_f32 v[30:31], v[30:31], s[92:93]
    v_cvt_pk_bf16_f32 v24, v24, v25
    v_cvt_pk_bf16_f32 v25, v26, v27
    v_cvt_pk_bf16_f32 v26, v28, v29
    v_cvt_pk_bf16_f32 v27, v30, v31
    buffer_store_dwordx4 v[24:27], v2, s[8:11], s90 offen sc1
    s_add_u32 s90, s90, s100
    s_nop 1
    s_add_u32 s91, s91, s99
m_epf27_r:
    s_mov_b32 s17, s101
    s_mov_b32 s66, 2
    s_branch m_q135
m_q036:
m_eps28:
    s_nop 3
    s_mov_b32 s90, s98
    v_cvt_pk_bf16_f32 v32, v32, v33
    v_cvt_pk_bf16_f32 v33, v34, v35
    v_cvt_pk_bf16_f32 v34, v36, v37
    v_cvt_pk_bf16_f32 v35, v38, v39
    buffer_store_dwordx4 v[32:35], v2, s[8:11], s90 offen sc1
    s_add_u32 s90, s90, s100
    v_cvt_pk_bf16_f32 v40, v40, v41
    v_cvt_pk_bf16_f32 v41, v42, v43
    v_cvt_pk_bf16_f32 v42, v44, v45
    v_cvt_pk_bf16_f32 v43, v46, v47
    buffer_store_dwordx4 v[40:43], v2, s[8:11], s90 offen sc1
    s_add_u32 s90, s90, s100
    v_cvt_pk_bf16_f32 v48, v48, v49
    v_cvt_pk_bf16_f32 v49, v50, v51
    v_cvt_pk_bf16_f32 v50, v52, v53
    v_cvt_pk_bf16_f32 v51, v54, v55
    buffer_store_dwordx4 v[48:51], v2, s[8:11], s90 offen sc1
    s_add_u32 s90, s90, s100
    v_cvt_pk_bf16_f32 v56, v56, v57
    v_cvt_pk_bf16_f32 v57, v58, v59
    v_cvt_pk_bf16_f32 v58, v60, v61
    v_cvt_pk_bf16_f32 v59, v62, v63
    buffer_store_dwordx4 v[56:59], v2, s[8:11], s90 offen sc1
    s_add_u32 s90, s90, s100
    v_cvt_pk_bf16_f32 v64, v64, v65
    v_cvt_pk_bf16_f32 v65, v66, v67
    v_cvt_pk_bf16_f32 v66, v68, v69
    v_cvt_pk_bf16_f32 v67, v70, v71
    buffer_store_dwordx4 v[64:67], v2, s[8:11], s90 offen sc1
    s_add_u32 s90, s90, s100
    v_cvt_pk_bf16_f32 v72, v72, v73
    v_cvt_pk_bf16_f32 v73, v74, v75
    v_cvt_pk_bf16_f32 v74, v76, v77
    v_cvt_pk_bf16_f32 v75, v78, v79
    buffer_store_dwordx4 v[72:75], v2, s[8:11], s90 offen sc1
    s_add_u32 s90, s90, s100
    v_cvt_pk_bf16_f32 v80, v80, v81
    v_cvt_pk_bf16_f32 v81, v82, v83
    v_cvt_pk_bf16_f32 v82, v84, v85
    v_cvt_pk_bf16_f32 v83, v86, v87
    buffer_store_dwordx4 v[80:83], v2, s[8:11], s90 offen sc1
    s_add_u32 s90, s90, s100
    v_cvt_pk_bf16_f32 v88, v88, v89
    v_cvt_pk_bf16_f32 v89, v90, v91
    v_cvt_pk_bf16_f32 v90, v92, v93
    v_cvt_pk_bf16_f32 v91, v94, v95
    buffer_store_dwordx4 v[88:91], v2, s[8:11], s90 offen sc1
    s_add_u32 s90, s90, s100
    v_cvt_pk_bf16_f32 v96, v96, v97
    v_cvt_pk_bf16_f32 v97, v98, v99
    v_cvt_pk_bf16_f32 v98, v100, v101
    v_cvt_pk_bf16_f32 v99, v102, v103
    v_accvgpr_write_b32 a128, v96
    v_accvgpr_write_b32 a129, v97
    v_accvgpr_write_b32 a130, v98
    v_accvgpr_write_b32 a131, v99
    v_cvt_pk_bf16_f32 v104, v104, v105
    v_cvt_pk_bf16_f32 v105, v106, v107
    v_cvt_pk_bf16_f32 v106, v108, v109
    v_cvt_pk_bf16_f32 v107, v110, v111
    v_accvgpr_write_b32 a132, v104
    v_accvgpr_write_b32 a133, v105
    v_accvgpr_write_b32 a134, v106
    v_accvgpr_write_b32 a135, v107
    v_cvt_pk_bf16_f32 v112, v112, v113
    v_cvt_pk_bf16_f32 v113, v114, v115
    v_cvt_pk_bf16_f32 v114, v116, v117
    v_cvt_pk_bf16_f32 v115, v118, v119
    v_accvgpr_write_b32 a136, v112
    v_accvgpr_write_b32 a137, v113
    v_accvgpr_write_b32 a138, v114
    v_accvgpr_write_b32 a139, v115
    v_cvt_pk_bf16_f32 v120, v120, v121
    v_cvt_pk_bf16_f32 v121, v122, v123
    v_cvt_pk_bf16_f32 v122, v124, v125
    v_cvt_pk_bf16_f32 v123, v126, v127
    v_accvgpr_write_b32 a140, v120
    v_accvgpr_write_b32 a141, v121
    v_accvgpr_write_b32 a142, v122
    v_accvgpr_write_b32 a143, v123
    v_cvt_pk_bf16_f32 v128, v128, v129
    v_cvt_pk_bf16_f32 v129, v130, v131
    v_cvt_pk_bf16_f32 v130, v132, v133
    v_cvt_pk_bf16_f32 v131, v134, v135
    v_accvgpr_write_b32 a144, v128
    v_accvgpr_write_b32 a145, v129
    v_accvgpr_write_b32 a146, v130
    v_accvgpr_write_b32 a147, v131
    v_cvt_pk_bf16_f32 v136, v136, v137
    v_cvt_pk_bf16_f32 v137, v138, v139
    v_cvt_pk_bf16_f32 v138, v140, v141
    v_cvt_pk_bf16_f32 v139, v142, v143
    v_accvgpr_write_b32 a148, v136
    v_accvgpr_write_b32 a149, v137
    v_accvgpr_write_b32 a150, v138
    v_accvgpr_write_b32 a151, v139
    v_cvt_pk_bf16_f32 v144, v144, v145
    v_cvt_pk_bf16_f32 v145, v146, v147
    v_cvt_pk_bf16_f32 v146, v148, v149
    v_cvt_pk_bf16_f32 v147, v150, v151
    v_accvgpr_write_b32 a152, v144
    v_accvgpr_write_b32 a153, v145
    v_accvgpr_write_b32 a154, v146
    v_accvgpr_write_b32 a155, v147
    v_cvt_pk_bf16_f32 v152, v152, v153
    v_cvt_pk_bf16_f32 v153, v154, v155
    v_cvt_pk_bf16_f32 v154, v156, v157
    v_cvt_pk_bf16_f32 v155, v158, v159
    v_accvgpr_write_b32 a156, v152
    v_accvgpr_write_b32 a157, v153
    v_accvgpr_write_b32 a158, v154
    v_accvgpr_write_b32 a159, v155
    v_cvt_pk_bf16_f32 v160, v160, v161
    v_cvt_pk_bf16_f32 v161, v162, v163
    v_cvt_pk_bf16_f32 v162, v164, v165
    v_cvt_pk_bf16_f32 v163, v166, v167
    v_accvgpr_write_b32 a160, v160
    v_accvgpr_write_b32 a161, v161
    v_accvgpr_write_b32 a162, v162
    v_accvgpr_write_b32 a163, v163
    v_cvt_pk_bf16_f32 v168, v168, v169
    v_cvt_pk_bf16_f32 v169, v170, v171
    v_cvt_pk_bf16_f32 v170, v172, v173
    v_cvt_pk_bf16_f32 v171, v174, v175
    v_accvgpr_write_b32 a164, v168
    v_accvgpr_write_b32 a165, v169
    v_accvgpr_write_b32 a166, v170
    v_accvgpr_write_b32 a167, v171
    v_cvt_pk_bf16_f32 v176, v176, v177
    v_cvt_pk_bf16_f32 v177, v178, v179
    v_cvt_pk_bf16_f32 v178, v180, v181
    v_cvt_pk_bf16_f32 v179, v182, v183
    v_accvgpr_write_b32 a168, v176
    v_accvgpr_write_b32 a169, v177
    v_accvgpr_write_b32 a170, v178
    v_accvgpr_write_b32 a171, v179
    v_cvt_pk_bf16_f32 v184, v184, v185
    v_cvt_pk_bf16_f32 v185, v186, v187
    v_cvt_pk_bf16_f32 v186, v188, v189
    v_cvt_pk_bf16_f32 v187, v190, v191
    v_accvgpr_write_b32 a172, v184
    v_accvgpr_write_b32 a173, v185
    v_accvgpr_write_b32 a174, v186
    v_accvgpr_write_b32 a175, v187
    v_cvt_pk_bf16_f32 v192, v192, v193
    v_cvt_pk_bf16_f32 v193, v194, v195
    v_cvt_pk_bf16_f32 v194, v196, v197
    v_cvt_pk_bf16_f32 v195, v198, v199
    v_accvgpr_write_b32 a176, v192
    v_accvgpr_write_b32 a177, v193
    v_accvgpr_write_b32 a178, v194
    v_accvgpr_write_b32 a179, v195
    v_cvt_pk_bf16_f32 v200, v200, v201
    v_cvt_pk_bf16_f32 v201, v202, v203
    v_cvt_pk_bf16_f32 v202, v204, v205
    v_cvt_pk_bf16_f32 v203, v206, v207
    v_accvgpr_write_b32 a180, v200
    v_accvgpr_write_b32 a181, v201
    v_accvgpr_write_b32 a182, v202
    v_accvgpr_write_b32 a183, v203
    v_cvt_pk_bf16_f32 v208, v208, v209
    v_cvt_pk_bf16_f32 v209, v210, v211
    v_cvt_pk_bf16_f32 v210, v212, v213
    v_cvt_pk_bf16_f32 v211, v214, v215
    v_accvgpr_write_b32 a184, v208
    v_accvgpr_write_b32 a185, v209
    v_accvgpr_write_b32 a186, v210
    v_accvgpr_write_b32 a187, v211
    v_cvt_pk_bf16_f32 v216, v216, v217
    v_cvt_pk_bf16_f32 v217, v218, v219
    v_cvt_pk_bf16_f32 v218, v220, v221
    v_cvt_pk_bf16_f32 v219, v222, v223
    v_accvgpr_write_b32 a188, v216
    v_accvgpr_write_b32 a189, v217
    v_accvgpr_write_b32 a190, v218
    v_accvgpr_write_b32 a191, v219
    v_cvt_pk_bf16_f32 v224, v224, v225
    v_cvt_pk_bf16_f32 v225, v226, v227
    v_cvt_pk_bf16_f32 v226, v228, v229
    v_cvt_pk_bf16_f32 v227, v230, v231
    v_accvgpr_write_b32 a192, v224
    v_accvgpr_write_b32 a193, v225
    v_accvgpr_write_b32 a194, v226
    v_accvgpr_write_b32 a195, v227
    v_cvt_pk_bf16_f32 v232, v232, v233
    v_cvt_pk_bf16_f32 v233, v234, v235
    v_cvt_pk_bf16_f32 v234, v236, v237
    v_cvt_pk_bf16_f32 v235, v238, v239
    v_accvgpr_write_b32 a196, v232
    v_accvgpr_write_b32 a197, v233
    v_accvgpr_write_b32 a198, v234
    v_accvgpr_write_b32 a199, v235
    v_cvt_pk_bf16_f32 v240, v240, v241
    v_cvt_pk_bf16_f32 v241, v242, v243
    v_cvt_pk_bf16_f32 v242, v244, v245
    v_cvt_pk_bf16_f32 v243, v246, v247
    v_accvgpr_write_b32 a200, v240
    v_accvgpr_write_b32 a201, v241
    v_accvgpr_write_b32 a202, v242
    v_accvgpr_write_b32 a203, v243
    v_cvt_pk_bf16_f32 v248, v248, v249
    v_cvt_pk_bf16_f32 v249, v250, v251
    v_cvt_pk_bf16_f32 v250, v252, v253
    v_cvt_pk_bf16_f32 v251, v254, v255
    v_accvgpr_write_b32 a204, v248
    v_accvgpr_write_b32 a205, v249
    v_accvgpr_write_b32 a206, v250
    v_accvgpr_write_b32 a207, v251
    v_accvgpr_read_b32 v24, a224
    v_accvgpr_read_b32 v25, a225
    v_accvgpr_read_b32 v26, a226
    v_accvgpr_read_b32 v27, a227
    v_accvgpr_read_b32 v28, a228
    v_accvgpr_read_b32 v29, a229
    v_accvgpr_read_b32 v30, a230
    v_accvgpr_read_b32 v31, a231
    v_cvt_pk_bf16_f32 v24, v24, v25
    v_cvt_pk_bf16_f32 v25, v26, v27
    v_cvt_pk_bf16_f32 v26, v28, v29
    v_cvt_pk_bf16_f32 v27, v30, v31
    v_accvgpr_write_b32 a208, v24
    v_accvgpr_write_b32 a209, v25
    v_accvgpr_write_b32 a210, v26
    v_accvgpr_write_b32 a211, v27
    v_accvgpr_read_b32 v24, a232
    v_accvgpr_read_b32 v25, a233
    v_accvgpr_read_b32 v26, a234
    v_accvgpr_read_b32 v27, a235
    v_accvgpr_read_b32 v28, a236
    v_accvgpr_read_b32 v29, a237
    v_accvgpr_read_b32 v30, a238
    v_accvgpr_read_b32 v31, a239
    v_cvt_pk_bf16_f32 v24, v24, v25
    v_cvt_pk_bf16_f32 v25, v26, v27
    v_cvt_pk_bf16_f32 v26, v28, v29
    v_cvt_pk_bf16_f32 v27, v30, v31
    v_accvgpr_write_b32 a212, v24
    v_accvgpr_write_b32 a213, v25
    v_accvgpr_write_b32 a214, v26
    v_accvgpr_write_b32 a215, v27
    v_accvgpr_read_b32 v24, a240
    v_accvgpr_read_b32 v25, a241
    v_accvgpr_read_b32 v26, a242
    v_accvgpr_read_b32 v27, a243
    v_accvgpr_read_b32 v28, a244
    v_accvgpr_read_b32 v29, a245
    v_accvgpr_read_b32 v30, a246
    v_accvgpr_read_b32 v31, a247
    v_cvt_pk_bf16_f32 v24, v24, v25
    v_cvt_pk_bf16_f32 v25, v26, v27
    v_cvt_pk_bf16_f32 v26, v28, v29
    v_cvt_pk_bf16_f32 v27, v30, v31
    v_accvgpr_write_b32 a216, v24
    v_accvgpr_write_b32 a217, v25
    v_accvgpr_write_b32 a218, v26
    v_accvgpr_write_b32 a219, v27
    v_accvgpr_read_b32 v24, a248
    v_accvgpr_read_b32 v25, a249
    v_accvgpr_read_b32 v26, a250
    v_accvgpr_read_b32 v27, a251
    v_accvgpr_read_b32 v28, a252
    v_accvgpr_read_b32 v29, a253
    v_accvgpr_read_b32 v30, a254
    v_accvgpr_read_b32 v31, a255
    v_cvt_pk_bf16_f32 v24, v24, v25
    v_cvt_pk_bf16_f32 v25, v26, v27
    v_cvt_pk_bf16_f32 v26, v28, v29
    v_cvt_pk_bf16_f32 v27, v30, v31
    v_accvgpr_write_b32 a220, v24
    v_accvgpr_write_b32 a221, v25
    v_accvgpr_write_b32 a222, v26
    v_accvgpr_write_b32 a223, v27
m_eps28_r:
    s_mov_b32 s17, s101
    s_add_u32 s28, s98, s99
    s_mov_b32 s29, s28
    s_mov_b32 s30, s99
    s_mov_b32 s31, s100
    s_mov_b32 s26, 268435456
m_q135:
    s_mov_b32 s95, s82
    s_mov_b32 s96, s83
    s_mov_b32 s97, s84
    s_mov_b32 s98, s85
    s_mov_b32 s99, s86
    s_mov_b32 s100, s87
    s_mov_b32 s101, s88
    s_sub_u32 s67, s95, 5
    s_max_u32 s67, s67, 4
    s_mov_b32 s94, 0
    s_branch m_tile14
m_last29:
m_kvl32:
    s_waitcnt lgkmcnt(0)
    v_mov_b32 v6, v2
    ds_read_b128 a[192:195], v6 offset:0
    ds_read_b128 a[196:199], v6 offset:1024
    ds_read_b128 a[200:203], v6 offset:2048
    ds_read_b128 a[204:207], v6 offset:3072
    ds_read_b128 a[208:211], v6 offset:4096
    ds_read_b128 a[212:215], v6 offset:5120
    ds_read_b128 a[216:219], v6 offset:6144
    ds_read_b128 a[220:223], v6 offset:7168
    s_load_dwordx2 s[48:49], s[0:1], 64
    s_load_dwordx2 s[50:51], s[0:1], 16
    s_load_dwordx2 s[54:55], s[0:1], 72
    s_mov_b32 s47, 0x20000
m_epl85:
    s_mov_b32 s92, s97
    s_mov_b32 s93, s97
    s_cmp_eq_u32 s97, 0
    s_cbranch_scc1 m_ns286
    s_mov_b32 s90, s98
    v_pk_mul_f32 v[32:33], v[32:33], s[92:93]
    v_pk_mul_f32 v[34:35], v[34:35], s[92:93]
    v_pk_mul_f32 v[36:37], v[36:37], s[92:93]
    v_pk_mul_f32 v[38:39], v[38:39], s[92:93]
    v_cvt_pk_bf16_f32 v32, v32, v33
    v_cvt_pk_bf16_f32 v33, v34, v35
    v_cvt_pk_bf16_f32 v34, v36, v37
    v_cvt_pk_bf16_f32 v35, v38, v39
    buffer_store_dwordx4 v[32:35], v2, s[8:11], s90 offen sc1
    s_add_u32 s90, s90, s100
    v_accvgpr_write_b32 a0, 0
    v_accvgpr_write_b32 a1, 0
    v_accvgpr_write_b32 a2, 0
    v_accvgpr_write_b32 a3, 0
    v_accvgpr_write_b32 a4, 0
    v_accvgpr_write_b32 a5, 0
    v_accvgpr_write_b32 a6, 0
    v_accvgpr_write_b32 a7, 0
    v_pk_mul_f32 v[192:193], v[192:193], s[92:93]
    v_pk_mul_f32 v[194:195], v[194:195], s[92:93]
    v_pk_mul_f32 v[196:197], v[196:197], s[92:93]
    v_pk_mul_f32 v[198:199], v[198:199], s[92:93]
    v_cvt_pk_bf16_f32 v192, v192, v193
    v_cvt_pk_bf16_f32 v193, v194, v195
    v_cvt_pk_bf16_f32 v194, v196, v197
    v_cvt_pk_bf16_f32 v195, v198, v199
    v_pk_mul_f32 v[40:41], v[40:41], s[92:93]
    v_pk_mul_f32 v[42:43], v[42:43], s[92:93]
    v_pk_mul_f32 v[44:45], v[44:45], s[92:93]
    v_pk_mul_f32 v[46:47], v[46:47], s[92:93]
    v_cvt_pk_bf16_f32 v40, v40, v41
    v_cvt_pk_bf16_f32 v41, v42, v43
    v_cvt_pk_bf16_f32 v42, v44, v45
    v_cvt_pk_bf16_f32 v43, v46, v47
    buffer_store_dwordx4 v[40:43], v2, s[8:11], s90 offen sc1
    s_add_u32 s90, s90, s100
    v_accvgpr_write_b32 a8, 0
    v_accvgpr_write_b32 a9, 0
    v_accvgpr_write_b32 a10, 0
    v_accvgpr_write_b32 a11, 0
    v_accvgpr_write_b32 a12, 0
    v_accvgpr_write_b32 a13, 0
    v_accvgpr_write_b32 a14, 0
    v_accvgpr_write_b32 a15, 0
    v_pk_mul_f32 v[200:201], v[200:201], s[92:93]
    v_pk_mul_f32 v[202:203], v[202:203], s[92:93]
    v_pk_mul_f32 v[204:205], v[204:205], s[92:93]
    v_pk_mul_f32 v[206:207], v[206:207], s[92:93]
    v_cvt_pk_bf16_f32 v196, v200, v201
    v_cvt_pk_bf16_f32 v197, v202, v203
    v_cvt_pk_bf16_f32 v198, v204, v205
    v_cvt_pk_bf16_f32 v199, v206, v207
    v_pk_mul_f32 v[48:49], v[48:49], s[92:93]
    v_pk_mul_f32 v[50:51], v[50:51], s[92:93]
    v_pk_mul_f32 v[52:53], v[52:53], s[92:93]
    v_pk_mul_f32 v[54:55], v[54:55], s[92:93]
    v_cvt_pk_bf16_f32 v48, v48, v49
    v_cvt_pk_bf16_f32 v49, v50, v51
    v_cvt_pk_bf16_f32 v50, v52, v53
    v_cvt_pk_bf16_f32 v51, v54, v55
    buffer_store_dwordx4 v[48:51], v2, s[8:11], s90 offen sc1
    s_add_u32 s90, s90, s100
    v_accvgpr_write_b32 a16, 0
    v_accvgpr_write_b32 a17, 0
    v_accvgpr_write_b32 a18, 0
    v_accvgpr_write_b32 a19, 0
    v_accvgpr_write_b32 a20, 0
    v_accvgpr_write_b32 a21, 0
    v_accvgpr_write_b32 a22, 0
    v_accvgpr_write_b32 a23, 0
    v_pk_mul_f32 v[208:209], v[208:209], s[92:93]
    v_pk_mul_f32 v[210:211], v[210:211], s[92:93]
    v_pk_mul_f32 v[212:213], v[212:213], s[92:93]
    v_pk_mul_f32 v[214:215], v[214:215], s[92:93]
    v_cvt_pk_bf16_f32 v200, v208, v209
    v_cvt_pk_bf16_f32 v201, v210, v211
    v_cvt_pk_bf16_f32 v202, v212, v213
    v_cvt_pk_bf16_f32 v203, v214, v215
    v_pk_mul_f32 v[56:57], v[56:57], s[92:93]
    v_pk_mul_f32 v[58:59], v[58:59], s[92:93]
    v_pk_mul_f32 v[60:61], v[60:61], s[92:93]
    v_pk_mul_f32 v[62:63], v[62:63], s[92:93]
    v_cvt_pk_bf16_f32 v56, v56, v57
    v_cvt_pk_bf16_f32 v57, v58, v59
    v_cvt_pk_bf16_f32 v58, v60, v61
    v_cvt_pk_bf16_f32 v59, v62, v63
    buffer_store_dwordx4 v[56:59], v2, s[8:11], s90 offen sc1
    s_add_u32 s90, s90, s100
    v_accvgpr_write_b32 a24, 0
    v_accvgpr_write_b32 a25, 0
    v_accvgpr_write_b32 a26, 0
    v_accvgpr_write_b32 a27, 0
    v_accvgpr_write_b32 a28, 0
    v_accvgpr_write_b32 a29, 0
    v_accvgpr_write_b32 a30, 0
    v_accvgpr_write_b32 a31, 0
    v_pk_mul_f32 v[216:217], v[216:217], s[92:93]
    v_pk_mul_f32 v[218:219], v[218:219], s[92:93]
    v_pk_mul_f32 v[220:221], v[220:221], s[92:93]
    v_pk_mul_f32 v[222:223], v[222:223], s[92:93]
    v_cvt_pk_bf16_f32 v204, v216, v217
    v_cvt_pk_bf16_f32 v205, v218, v219
    v_cvt_pk_bf16_f32 v206, v220, v221
    v_cvt_pk_bf16_f32 v207, v222, v223
    v_pk_mul_f32 v[64:65], v[64:65], s[92:93]
    v_pk_mul_f32 v[66:67], v[66:67], s[92:93]
    v_pk_mul_f32 v[68:69], v[68:69], s[92:93]
    v_pk_mul_f32 v[70:71], v[70:71], s[92:93]
    v_cvt_pk_bf16_f32 v64, v64, v65
    v_cvt_pk_bf16_f32 v65, v66, v67
    v_cvt_pk_bf16_f32 v66, v68, v69
    v_cvt_pk_bf16_f32 v67, v70, v71
    buffer_store_dwordx4 v[64:67], v2, s[8:11], s90 offen sc1
    s_add_u32 s90, s90, s100
    v_accvgpr_write_b32 a32, 0
    v_accvgpr_write_b32 a33, 0
    v_accvgpr_write_b32 a34, 0
    v_accvgpr_write_b32 a35, 0
    v_accvgpr_write_b32 a36, 0
    v_accvgpr_write_b32 a37, 0
    v_accvgpr_write_b32 a38, 0
    v_accvgpr_write_b32 a39, 0
    v_pk_mul_f32 v[224:225], v[224:225], s[92:93]
    v_pk_mul_f32 v[226:227], v[226:227], s[92:93]
    v_pk_mul_f32 v[228:229], v[228:229], s[92:93]
    v_pk_mul_f32 v[230:231], v[230:231], s[92:93]
    v_cvt_pk_bf16_f32 v208, v224, v225
    v_cvt_pk_bf16_f32 v209, v226, v227
    v_cvt_pk_bf16_f32 v210, v228, v229
    v_cvt_pk_bf16_f32 v211, v230, v231
    v_pk_mul_f32 v[72:73], v[72:73], s[92:93]
    v_pk_mul_f32 v[74:75], v[74:75], s[92:93]
    v_pk_mul_f32 v[76:77], v[76:77], s[92:93]
    v_pk_mul_f32 v[78:79], v[78:79], s[92:93]
    v_cvt_pk_bf16_f32 v72, v72, v73
    v_cvt_pk_bf16_f32 v73, v74, v75
    v_cvt_pk_bf16_f32 v74, v76, v77
    v_cvt_pk_bf16_f32 v75, v78, v79
    buffer_store_dwordx4 v[72:75], v2, s[8:11], s90 offen sc1
    s_add_u32 s90, s90, s100
    v_accvgpr_write_b32 a40, 0
    v_accvgpr_write_b32 a41, 0
    v_accvgpr_write_b32 a42, 0
    v_accvgpr_write_b32 a43, 0
    v_accvgpr_write_b32 a44, 0
    v_accvgpr_write_b32 a45, 0
    v_accvgpr_write_b32 a46, 0
    v_accvgpr_write_b32 a47, 0
    v_pk_mul_f32 v[232:233], v[232:233], s[92:93]
    v_pk_mul_f32 v[234:235], v[234:235], s[92:93]
    v_pk_mul_f32 v[236:237], v[236:237], s[92:93]
    v_pk_mul_f32 v[238:239], v[238:239], s[92:93]
    v_cvt_pk_bf16_f32 v212, v232, v233
    v_cvt_pk_bf16_f32 v213, v234, v235
    v_cvt_pk_bf16_f32 v214, v236, v237
    v_cvt_pk_bf16_f32 v215, v238, v239
    v_pk_mul_f32 v[80:81], v[80:81], s[92:93]
    v_pk_mul_f32 v[82:83], v[82:83], s[92:93]
    v_pk_mul_f32 v[84:85], v[84:85], s[92:93]
    v_pk_mul_f32 v[86:87], v[86:87], s[92:93]
    v_cvt_pk_bf16_f32 v80, v80, v81
    v_cvt_pk_bf16_f32 v81, v82, v83
    v_cvt_pk_bf16_f32 v82, v84, v85
    v_cvt_pk_bf16_f32 v83, v86, v87
    buffer_store_dwordx4 v[80:83], v2, s[8:11], s90 offen sc1
    s_add_u32 s90, s90, s100
    v_accvgpr_write_b32 a48, 0
    v_accvgpr_write_b32 a49, 0
    v_accvgpr_write_b32 a50, 0
    v_accvgpr_write_b32 a51, 0
    v_accvgpr_write_b32 a52, 0
    v_accvgpr_write_b32 a53, 0
    v_accvgpr_write_b32 a54, 0
    v_accvgpr_write_b32 a55, 0
    v_pk_mul_f32 v[240:241], v[240:241], s[92:93]
    v_pk_mul_f32 v[242:243], v[242:243], s[92:93]
    v_pk_mul_f32 v[244:245], v[244:245], s[92:93]
    v_pk_mul_f32 v[246:247], v[246:247], s[92:93]
    v_cvt_pk_bf16_f32 v216, v240, v241
    v_cvt_pk_bf16_f32 v217, v242, v243
    v_cvt_pk_bf16_f32 v218, v244, v245
    v_cvt_pk_bf16_f32 v219, v246, v247
    v_pk_mul_f32 v[88:89], v[88:89], s[92:93]
    v_pk_mul_f32 v[90:91], v[90:91], s[92:93]
    v_pk_mul_f32 v[92:93], v[92:93], s[92:93]
    v_pk_mul_f32 v[94:95], v[94:95], s[92:93]
    v_cvt_pk_bf16_f32 v88, v88, v89
    v_cvt_pk_bf16_f32 v89, v90, v91
    v_cvt_pk_bf16_f32 v90, v92, v93
    v_cvt_pk_bf16_f32 v91, v94, v95
    buffer_store_dwordx4 v[88:91], v2, s[8:11], s90 offen sc1
    s_add_u32 s90, s98, s99
    v_accvgpr_write_b32 a56, 0
    v_accvgpr_write_b32 a57, 0
    v_accvgpr_write_b32 a58, 0
    v_accvgpr_write_b32 a59, 0
    v_accvgpr_write_b32 a60, 0
    v_accvgpr_write_b32 a61, 0
    v_accvgpr_write_b32 a62, 0
    v_accvgpr_write_b32 a63, 0
    v_pk_mul_f32 v[248:249], v[248:249], s[92:93]
    v_pk_mul_f32 v[250:251], v[250:251], s[92:93]
    v_pk_mul_f32 v[252:253], v[252:253], s[92:93]
    v_pk_mul_f32 v[254:255], v[254:255], s[92:93]
    v_cvt_pk_bf16_f32 v220, v248, v249
    v_cvt_pk_bf16_f32 v221, v250, v251
    v_cvt_pk_bf16_f32 v222, v252, v253
    v_cvt_pk_bf16_f32 v223, v254, v255
    v_pk_mul_f32 v[96:97], v[96:97], s[92:93]
    v_pk_mul_f32 v[98:99], v[98:99], s[92:93]
    v_pk_mul_f32 v[100:101], v[100:101], s[92:93]
    v_pk_mul_f32 v[102:103], v[102:103], s[92:93]
    v_cvt_pk_bf16_f32 v96, v96, v97
    v_cvt_pk_bf16_f32 v97, v98, v99
    v_cvt_pk_bf16_f32 v98, v100, v101
    v_cvt_pk_bf16_f32 v99, v102, v103
    buffer_store_dwordx4 v[96:99], v2, s[8:11], s90 offen sc1
    s_add_u32 s90, s90, s100
    v_accvgpr_write_b32 a64, 0
    v_accvgpr_write_b32 a65, 0
    v_accvgpr_write_b32 a66, 0
    v_accvgpr_write_b32 a67, 0
    v_accvgpr_write_b32 a68, 0
    v_accvgpr_write_b32 a69, 0
    v_accvgpr_write_b32 a70, 0
    v_accvgpr_write_b32 a71, 0
    v_accvgpr_read_b32 v24, a224
    v_accvgpr_read_b32 v25, a225
    v_accvgpr_read_b32 v26, a226
    v_accvgpr_read_b32 v27, a227
    v_accvgpr_read_b32 v28, a228
    v_accvgpr_read_b32 v29, a229
    v_accvgpr_read_b32 v30, a230
    v_accvgpr_read_b32 v31, a231
    v_pk_mul_f32 v[24:25], v[24:25], s[92:93]
    v_pk_mul_f32 v[26:27], v[26:27], s[92:93]
    v_pk_mul_f32 v[28:29], v[28:29], s[92:93]
    v_pk_mul_f32 v[30:31], v[30:31], s[92:93]
    v_cvt_pk_bf16_f32 v224, v24, v25
    v_cvt_pk_bf16_f32 v225, v26, v27
    v_cvt_pk_bf16_f32 v226, v28, v29
    v_cvt_pk_bf16_f32 v227, v30, v31
    v_pk_mul_f32 v[104:105], v[104:105], s[92:93]
    v_pk_mul_f32 v[106:107], v[106:107], s[92:93]
    v_pk_mul_f32 v[108:109], v[108:109], s[92:93]
    v_pk_mul_f32 v[110:111], v[110:111], s[92:93]
    v_cvt_pk_bf16_f32 v104, v104, v105
    v_cvt_pk_bf16_f32 v105, v106, v107
    v_cvt_pk_bf16_f32 v106, v108, v109
    v_cvt_pk_bf16_f32 v107, v110, v111
    buffer_store_dwordx4 v[104:107], v2, s[8:11], s90 offen sc1
    s_add_u32 s90, s90, s100
    v_accvgpr_write_b32 a72, 0
    v_accvgpr_write_b32 a73, 0
    v_accvgpr_write_b32 a74, 0
    v_accvgpr_write_b32 a75, 0
    v_accvgpr_write_b32 a76, 0
    v_accvgpr_write_b32 a77, 0
    v_accvgpr_write_b32 a78, 0
    v_accvgpr_write_b32 a79, 0
    v_accvgpr_read_b32 v24, a232
    v_accvgpr_read_b32 v25, a233
    v_accvgpr_read_b32 v26, a234
    v_accvgpr_read_b32 v27, a235
    v_accvgpr_read_b32 v28, a236
    v_accvgpr_read_b32 v29, a237
    v_accvgpr_read_b32 v30, a238
    v_accvgpr_read_b32 v31, a239
    v_pk_mul_f32 v[24:25], v[24:25], s[92:93]
    v_pk_mul_f32 v[26:27], v[26:27], s[92:93]
    v_pk_mul_f32 v[28:29], v[28:29], s[92:93]
    v_pk_mul_f32 v[30:31], v[30:31], s[92:93]
    v_cvt_pk_bf16_f32 v228, v24, v25
    v_cvt_pk_bf16_f32 v229, v26, v27
    v_cvt_pk_bf16_f32 v230, v28, v29
    v_cvt_pk_bf16_f32 v231, v30, v31
    v_pk_mul_f32 v[112:113], v[112:113], s[92:93]
    v_pk_mul_f32 v[114:115], v[114:115], s[92:93]
    v_pk_mul_f32 v[116:117], v[116:117], s[92:93]
    v_pk_mul_f32 v[118:119], v[118:119], s[92:93]
    v_cvt_pk_bf16_f32 v112, v112, v113
    v_cvt_pk_bf16_f32 v113, v114, v115
    v_cvt_pk_bf16_f32 v114, v116, v117
    v_cvt_pk_bf16_f32 v115, v118, v119
    buffer_store_dwordx4 v[112:115], v2, s[8:11], s90 offen sc1
    s_add_u32 s90, s90, s100
    v_accvgpr_write_b32 a80, 0
    v_accvgpr_write_b32 a81, 0
    v_accvgpr_write_b32 a82, 0
    v_accvgpr_write_b32 a83, 0
    v_accvgpr_write_b32 a84, 0
    v_accvgpr_write_b32 a85, 0
    v_accvgpr_write_b32 a86, 0
    v_accvgpr_write_b32 a87, 0
    v_accvgpr_read_b32 v24, a240
    v_accvgpr_read_b32 v25, a241
    v_accvgpr_read_b32 v26, a242
    v_accvgpr_read_b32 v27, a243
    v_accvgpr_read_b32 v28, a244
    v_accvgpr_read_b32 v29, a245
    v_accvgpr_read_b32 v30, a246
    v_accvgpr_read_b32 v31, a247
    v_pk_mul_f32 v[24:25], v[24:25], s[92:93]
    v_pk_mul_f32 v[26:27], v[26:27], s[92:93]
    v_pk_mul_f32 v[28:29], v[28:29], s[92:93]
    v_pk_mul_f32 v[30:31], v[30:31], s[92:93]
    v_cvt_pk_bf16_f32 v232, v24, v25
    v_cvt_pk_bf16_f32 v233, v26, v27
    v_cvt_pk_bf16_f32 v234, v28, v29
    v_cvt_pk_bf16_f32 v235, v30, v31
    v_pk_mul_f32 v[120:121], v[120:121], s[92:93]
    v_pk_mul_f32 v[122:123], v[122:123], s[92:93]
    v_pk_mul_f32 v[124:125], v[124:125], s[92:93]
    v_pk_mul_f32 v[126:127], v[126:127], s[92:93]
    v_cvt_pk_bf16_f32 v120, v120, v121
    v_cvt_pk_bf16_f32 v121, v122, v123
    v_cvt_pk_bf16_f32 v122, v124, v125
    v_cvt_pk_bf16_f32 v123, v126, v127
    buffer_store_dwordx4 v[120:123], v2, s[8:11], s90 offen sc1
    s_add_u32 s90, s90, s100
    v_accvgpr_write_b32 a88, 0
    v_accvgpr_write_b32 a89, 0
    v_accvgpr_write_b32 a90, 0
    v_accvgpr_write_b32 a91, 0
    v_accvgpr_write_b32 a92, 0
    v_accvgpr_write_b32 a93, 0
    v_accvgpr_write_b32 a94, 0
    v_accvgpr_write_b32 a95, 0
    v_accvgpr_read_b32 v24, a248
    v_accvgpr_read_b32 v25, a249
    v_accvgpr_read_b32 v26, a250
    v_accvgpr_read_b32 v27, a251
    v_accvgpr_read_b32 v28, a252
    v_accvgpr_read_b32 v29, a253
    v_accvgpr_read_b32 v30, a254
    v_accvgpr_read_b32 v31, a255
    v_pk_mul_f32 v[24:25], v[24:25], s[92:93]
    v_pk_mul_f32 v[26:27], v[26:27], s[92:93]
    v_pk_mul_f32 v[28:29], v[28:29], s[92:93]
    v_pk_mul_f32 v[30:31], v[30:31], s[92:93]
    v_cvt_pk_bf16_f32 v236, v24, v25
    v_cvt_pk_bf16_f32 v237, v26, v27
    v_cvt_pk_bf16_f32 v238, v28, v29
    v_cvt_pk_bf16_f32 v239, v30, v31
    v_pk_mul_f32 v[128:129], v[128:129], s[92:93]
    v_pk_mul_f32 v[130:131], v[130:131], s[92:93]
    v_pk_mul_f32 v[132:133], v[132:133], s[92:93]
    v_pk_mul_f32 v[134:135], v[134:135], s[92:93]
    v_cvt_pk_bf16_f32 v128, v128, v129
    v_cvt_pk_bf16_f32 v129, v130, v131
    v_cvt_pk_bf16_f32 v130, v132, v133
    v_cvt_pk_bf16_f32 v131, v134, v135
    buffer_store_dwordx4 v[128:131], v2, s[8:11], s90 offen sc1
    s_add_u32 s90, s90, s100
    v_accvgpr_write_b32 a96, 0
    v_accvgpr_write_b32 a97, 0
    v_accvgpr_write_b32 a98, 0
    v_accvgpr_write_b32 a99, 0
    v_accvgpr_write_b32 a100, 0
    v_accvgpr_write_b32 a101, 0
    v_accvgpr_write_b32 a102, 0
    v_accvgpr_write_b32 a103, 0
    v_pk_mul_f32 v[160:161], v[160:161], s[92:93]
    v_pk_mul_f32 v[162:163], v[162:163], s[92:93]
    v_pk_mul_f32 v[164:165], v[164:165], s[92:93]
    v_pk_mul_f32 v[166:167], v[166:167], s[92:93]
    v_cvt_pk_bf16_f32 v240, v160, v161
    v_cvt_pk_bf16_f32 v241, v162, v163
    v_cvt_pk_bf16_f32 v242, v164, v165
    v_cvt_pk_bf16_f32 v243, v166, v167
    v_pk_mul_f32 v[136:137], v[136:137], s[92:93]
    v_pk_mul_f32 v[138:139], v[138:139], s[92:93]
    v_pk_mul_f32 v[140:141], v[140:141], s[92:93]
    v_pk_mul_f32 v[142:143], v[142:143], s[92:93]
    v_cvt_pk_bf16_f32 v136, v136, v137
    v_cvt_pk_bf16_f32 v137, v138, v139
    v_cvt_pk_bf16_f32 v138, v140, v141
    v_cvt_pk_bf16_f32 v139, v142, v143
    buffer_store_dwordx4 v[136:139], v2, s[8:11], s90 offen sc1
    s_add_u32 s90, s90, s100
    v_accvgpr_write_b32 a104, 0
    v_accvgpr_write_b32 a105, 0
    v_accvgpr_write_b32 a106, 0
    v_accvgpr_write_b32 a107, 0
    v_accvgpr_write_b32 a108, 0
    v_accvgpr_write_b32 a109, 0
    v_accvgpr_write_b32 a110, 0
    v_accvgpr_write_b32 a111, 0
    v_pk_mul_f32 v[168:169], v[168:169], s[92:93]
    v_pk_mul_f32 v[170:171], v[170:171], s[92:93]
    v_pk_mul_f32 v[172:173], v[172:173], s[92:93]
    v_pk_mul_f32 v[174:175], v[174:175], s[92:93]
    v_cvt_pk_bf16_f32 v244, v168, v169
    v_cvt_pk_bf16_f32 v245, v170, v171
    v_cvt_pk_bf16_f32 v246, v172, v173
    v_cvt_pk_bf16_f32 v247, v174, v175
    v_pk_mul_f32 v[144:145], v[144:145], s[92:93]
    v_pk_mul_f32 v[146:147], v[146:147], s[92:93]
    v_pk_mul_f32 v[148:149], v[148:149], s[92:93]
    v_pk_mul_f32 v[150:151], v[150:151], s[92:93]
    v_cvt_pk_bf16_f32 v144, v144, v145
    v_cvt_pk_bf16_f32 v145, v146, v147
    v_cvt_pk_bf16_f32 v146, v148, v149
    v_cvt_pk_bf16_f32 v147, v150, v151
    buffer_store_dwordx4 v[144:147], v2, s[8:11], s90 offen sc1
    s_add_u32 s90, s90, s100
    v_accvgpr_write_b32 a112, 0
    v_accvgpr_write_b32 a113, 0
    v_accvgpr_write_b32 a114, 0
    v_accvgpr_write_b32 a115, 0
    v_accvgpr_write_b32 a116, 0
    v_accvgpr_write_b32 a117, 0
    v_accvgpr_write_b32 a118, 0
    v_accvgpr_write_b32 a119, 0
    v_pk_mul_f32 v[176:177], v[176:177], s[92:93]
    v_pk_mul_f32 v[178:179], v[178:179], s[92:93]
    v_pk_mul_f32 v[180:181], v[180:181], s[92:93]
    v_pk_mul_f32 v[182:183], v[182:183], s[92:93]
    v_cvt_pk_bf16_f32 v248, v176, v177
    v_cvt_pk_bf16_f32 v249, v178, v179
    v_cvt_pk_bf16_f32 v250, v180, v181
    v_cvt_pk_bf16_f32 v251, v182, v183
    v_pk_mul_f32 v[152:153], v[152:153], s[92:93]
    v_pk_mul_f32 v[154:155], v[154:155], s[92:93]
    v_pk_mul_f32 v[156:157], v[156:157], s[92:93]
    v_pk_mul_f32 v[158:159], v[158:159], s[92:93]
    v_cvt_pk_bf16_f32 v152, v152, v153
    v_cvt_pk_bf16_f32 v153, v154, v155
    v_cvt_pk_bf16_f32 v154, v156, v157
    v_cvt_pk_bf16_f32 v155, v158, v159
    buffer_store_dwordx4 v[152:155], v2, s[8:11], s90 offen sc1
    s_add_u32 s90, s90, s100
    v_accvgpr_write_b32 a120, 0
    v_accvgpr_write_b32 a121, 0
    v_accvgpr_write_b32 a122, 0
    v_accvgpr_write_b32 a123, 0
    v_accvgpr_write_b32 a124, 0
    v_accvgpr_write_b32 a125, 0
    v_accvgpr_write_b32 a126, 0
    v_accvgpr_write_b32 a127, 0
    v_pk_mul_f32 v[184:185], v[184:185], s[92:93]
    v_pk_mul_f32 v[186:187], v[186:187], s[92:93]
    v_pk_mul_f32 v[188:189], v[188:189], s[92:93]
    v_pk_mul_f32 v[190:191], v[190:191], s[92:93]
    v_cvt_pk_bf16_f32 v252, v184, v185
    v_cvt_pk_bf16_f32 v253, v186, v187
    v_cvt_pk_bf16_f32 v254, v188, v189
    v_cvt_pk_bf16_f32 v255, v190, v191
    s_branch m_epl85_r
m_ns286:
    s_mov_b32 s90, s98
    v_cvt_pk_bf16_f32 v32, v32, v33
    v_cvt_pk_bf16_f32 v33, v34, v35
    v_cvt_pk_bf16_f32 v34, v36, v37
    v_cvt_pk_bf16_f32 v35, v38, v39
    buffer_store_dwordx4 v[32:35], v2, s[8:11], s90 offen sc1
    s_add_u32 s90, s90, s100
    v_accvgpr_write_b32 a0, 0
    v_accvgpr_write_b32 a1, 0
    v_accvgpr_write_b32 a2, 0
    v_accvgpr_write_b32 a3, 0
    v_accvgpr_write_b32 a4, 0
    v_accvgpr_write_b32 a5, 0
    v_accvgpr_write_b32 a6, 0
    v_accvgpr_write_b32 a7, 0
    v_cvt_pk_bf16_f32 v192, v192, v193
    v_cvt_pk_bf16_f32 v193, v194, v195
    v_cvt_pk_bf16_f32 v194, v196, v197
    v_cvt_pk_bf16_f32 v195, v198, v199
    v_cvt_pk_bf16_f32 v40, v40, v41
    v_cvt_pk_bf16_f32 v41, v42, v43
    v_cvt_pk_bf16_f32 v42, v44, v45
    v_cvt_pk_bf16_f32 v43, v46, v47
    buffer_store_dwordx4 v[40:43], v2, s[8:11], s90 offen sc1
    s_add_u32 s90, s90, s100
    v_accvgpr_write_b32 a8, 0
    v_accvgpr_write_b32 a9, 0
    v_accvgpr_write_b32 a10, 0
    v_accvgpr_write_b32 a11, 0
    v_accvgpr_write_b32 a12, 0
    v_accvgpr_write_b32 a13, 0
    v_accvgpr_write_b32 a14, 0
    v_accvgpr_write_b32 a15, 0
    v_cvt_pk_bf16_f32 v196, v200, v201
    v_cvt_pk_bf16_f32 v197, v202, v203
    v_cvt_pk_bf16_f32 v198, v204, v205
    v_cvt_pk_bf16_f32 v199, v206, v207
    v_cvt_pk_bf16_f32 v48, v48, v49
    v_cvt_pk_bf16_f32 v49, v50, v51
    v_cvt_pk_bf16_f32 v50, v52, v53
    v_cvt_pk_bf16_f32 v51, v54, v55
    buffer_store_dwordx4 v[48:51], v2, s[8:11], s90 offen sc1
    s_add_u32 s90, s90, s100
    v_accvgpr_write_b32 a16, 0
    v_accvgpr_write_b32 a17, 0
    v_accvgpr_write_b32 a18, 0
    v_accvgpr_write_b32 a19, 0
    v_accvgpr_write_b32 a20, 0
    v_accvgpr_write_b32 a21, 0
    v_accvgpr_write_b32 a22, 0
    v_accvgpr_write_b32 a23, 0
    v_cvt_pk_bf16_f32 v200, v208, v209
    v_cvt_pk_bf16_f32 v201, v210, v211
    v_cvt_pk_bf16_f32 v202, v212, v213
    v_cvt_pk_bf16_f32 v203, v214, v215
    v_cvt_pk_bf16_f32 v56, v56, v57
    v_cvt_pk_bf16_f32 v57, v58, v59
    v_cvt_pk_bf16_f32 v58, v60, v61
    v_cvt_pk_bf16_f32 v59, v62, v63
    buffer_store_dwordx4 v[56:59], v2, s[8:11], s90 offen sc1
    s_add_u32 s90, s90, s100
    v_accvgpr_write_b32 a24, 0
    v_accvgpr_write_b32 a25, 0
    v_accvgpr_write_b32 a26, 0
    v_accvgpr_write_b32 a27, 0
    v_accvgpr_write_b32 a28, 0
    v_accvgpr_write_b32 a29, 0
    v_accvgpr_write_b32 a30, 0
    v_accvgpr_write_b32 a31, 0
    v_cvt_pk_bf16_f32 v204, v216, v217
    v_cvt_pk_bf16_f32 v205, v218, v219
    v_cvt_pk_bf16_f32 v206, v220, v221
    v_cvt_pk_bf16_f32 v207, v222, v223
    v_cvt_pk_bf16_f32 v64, v64, v65
    v_cvt_pk_bf16_f32 v65, v66, v67
    v_cvt_pk_bf16_f32 v66, v68, v69
    v_cvt_pk_bf16_f32 v67, v70, v71
    buffer_store_dwordx4 v[64:67], v2, s[8:11], s90 offen sc1
    s_add_u32 s90, s90, s100
    v_accvgpr_write_b32 a32, 0
    v_accvgpr_write_b32 a33, 0
    v_accvgpr_write_b32 a34, 0
    v_accvgpr_write_b32 a35, 0
    v_accvgpr_write_b32 a36, 0
    v_accvgpr_write_b32 a37, 0
    v_accvgpr_write_b32 a38, 0
    v_accvgpr_write_b32 a39, 0
    v_cvt_pk_bf16_f32 v208, v224, v225
    v_cvt_pk_bf16_f32 v209, v226, v227
    v_cvt_pk_bf16_f32 v210, v228, v229
    v_cvt_pk_bf16_f32 v211, v230, v231
    v_cvt_pk_bf16_f32 v72, v72, v73
    v_cvt_pk_bf16_f32 v73, v74, v75
    v_cvt_pk_bf16_f32 v74, v76, v77
    v_cvt_pk_bf16_f32 v75, v78, v79
    buffer_store_dwordx4 v[72:75], v2, s[8:11], s90 offen sc1
    s_add_u32 s90, s90, s100
    v_accvgpr_write_b32 a40, 0
    v_accvgpr_write_b32 a41, 0
    v_accvgpr_write_b32 a42, 0
    v_accvgpr_write_b32 a43, 0
    v_accvgpr_write_b32 a44, 0
    v_accvgpr_write_b32 a45, 0
    v_accvgpr_write_b32 a46, 0
    v_accvgpr_write_b32 a47, 0
    v_cvt_pk_bf16_f32 v212, v232, v233
    v_cvt_pk_bf16_f32 v213, v234, v235
    v_cvt_pk_bf16_f32 v214, v236, v237
    v_cvt_pk_bf16_f32 v215, v238, v239
    v_cvt_pk_bf16_f32 v80, v80, v81
    v_cvt_pk_bf16_f32 v81, v82, v83
    v_cvt_pk_bf16_f32 v82, v84, v85
    v_cvt_pk_bf16_f32 v83, v86, v87
    buffer_store_dwordx4 v[80:83], v2, s[8:11], s90 offen sc1
    s_add_u32 s90, s90, s100
    v_accvgpr_write_b32 a48, 0
    v_accvgpr_write_b32 a49, 0
    v_accvgpr_write_b32 a50, 0
    v_accvgpr_write_b32 a51, 0
    v_accvgpr_write_b32 a52, 0
    v_accvgpr_write_b32 a53, 0
    v_accvgpr_write_b32 a54, 0
    v_accvgpr_write_b32 a55, 0
    v_cvt_pk_bf16_f32 v216, v240, v241
    v_cvt_pk_bf16_f32 v217, v242, v243
    v_cvt_pk_bf16_f32 v218, v244, v245
    v_cvt_pk_bf16_f32 v219, v246, v247
    v_cvt_pk_bf16_f32 v88, v88, v89
    v_cvt_pk_bf16_f32 v89, v90, v91
    v_cvt_pk_bf16_f32 v90, v92, v93
    v_cvt_pk_bf16_f32 v91, v94, v95
    buffer_store_dwordx4 v[88:91], v2, s[8:11], s90 offen sc1
    s_add_u32 s90, s98, s99
    v_accvgpr_write_b32 a56, 0
    v_accvgpr_write_b32 a57, 0
    v_accvgpr_write_b32 a58, 0
    v_accvgpr_write_b32 a59, 0
    v_accvgpr_write_b32 a60, 0
    v_accvgpr_write_b32 a61, 0
    v_accvgpr_write_b32 a62, 0
    v_accvgpr_write_b32 a63, 0
    v_cvt_pk_bf16_f32 v220, v248, v249
    v_cvt_pk_bf16_f32 v221, v250, v251
    v_cvt_pk_bf16_f32 v222, v252, v253
    v_cvt_pk_bf16_f32 v223, v254, v255
    v_cvt_pk_bf16_f32 v96, v96, v97
    v_cvt_pk_bf16_f32 v97, v98, v99
    v_cvt_pk_bf16_f32 v98, v100, v101
    v_cvt_pk_bf16_f32 v99, v102, v103
    buffer_store_dwordx4 v[96:99], v2, s[8:11], s90 offen sc1
    s_add_u32 s90, s90, s100
    v_accvgpr_write_b32 a64, 0
    v_accvgpr_write_b32 a65, 0
    v_accvgpr_write_b32 a66, 0
    v_accvgpr_write_b32 a67, 0
    v_accvgpr_write_b32 a68, 0
    v_accvgpr_write_b32 a69, 0
    v_accvgpr_write_b32 a70, 0
    v_accvgpr_write_b32 a71, 0
    v_accvgpr_read_b32 v24, a224
    v_accvgpr_read_b32 v25, a225
    v_accvgpr_read_b32 v26, a226
    v_accvgpr_read_b32 v27, a227
    v_accvgpr_read_b32 v28, a228
    v_accvgpr_read_b32 v29, a229
    v_accvgpr_read_b32 v30, a230
    v_accvgpr_read_b32 v31, a231
    v_cvt_pk_bf16_f32 v224, v24, v25
    v_cvt_pk_bf16_f32 v225, v26, v27
    v_cvt_pk_bf16_f32 v226, v28, v29
    v_cvt_pk_bf16_f32 v227, v30, v31
    v_cvt_pk_bf16_f32 v104, v104, v105
    v_cvt_pk_bf16_f32 v105, v106, v107
    v_cvt_pk_bf16_f32 v106, v108, v109
    v_cvt_pk_bf16_f32 v107, v110, v111
    buffer_store_dwordx4 v[104:107], v2, s[8:11], s90 offen sc1
    s_add_u32 s90, s90, s100
    v_accvgpr_write_b32 a72, 0
    v_accvgpr_write_b32 a73, 0
    v_accvgpr_write_b32 a74, 0
    v_accvgpr_write_b32 a75, 0
    v_accvgpr_write_b32 a76, 0
    v_accvgpr_write_b32 a77, 0
    v_accvgpr_write_b32 a78, 0
    v_accvgpr_write_b32 a79, 0
    v_accvgpr_read_b32 v24, a232
    v_accvgpr_read_b32 v25, a233
    v_accvgpr_read_b32 v26, a234
    v_accvgpr_read_b32 v27, a235
    v_accvgpr_read_b32 v28, a236
    v_accvgpr_read_b32 v29, a237
    v_accvgpr_read_b32 v30, a238
    v_accvgpr_read_b32 v31, a239
    v_cvt_pk_bf16_f32 v228, v24, v25
    v_cvt_pk_bf16_f32 v229, v26, v27
    v_cvt_pk_bf16_f32 v230, v28, v29
    v_cvt_pk_bf16_f32 v231, v30, v31
    v_cvt_pk_bf16_f32 v112, v112, v113
    v_cvt_pk_bf16_f32 v113, v114, v115
    v_cvt_pk_bf16_f32 v114, v116, v117
    v_cvt_pk_bf16_f32 v115, v118, v119
    buffer_store_dwordx4 v[112:115], v2, s[8:11], s90 offen sc1
    s_add_u32 s90, s90, s100
    v_accvgpr_write_b32 a80, 0
    v_accvgpr_write_b32 a81, 0
    v_accvgpr_write_b32 a82, 0
    v_accvgpr_write_b32 a83, 0
    v_accvgpr_write_b32 a84, 0
    v_accvgpr_write_b32 a85, 0
    v_accvgpr_write_b32 a86, 0
    v_accvgpr_write_b32 a87, 0
    v_accvgpr_read_b32 v24, a240
    v_accvgpr_read_b32 v25, a241
    v_accvgpr_read_b32 v26, a242
    v_accvgpr_read_b32 v27, a243
    v_accvgpr_read_b32 v28, a244
    v_accvgpr_read_b32 v29, a245
    v_accvgpr_read_b32 v30, a246
    v_accvgpr_read_b32 v31, a247
    v_cvt_pk_bf16_f32 v232, v24, v25
    v_cvt_pk_bf16_f32 v233, v26, v27
    v_cvt_pk_bf16_f32 v234, v28, v29
    v_cvt_pk_bf16_f32 v235, v30, v31
    v_cvt_pk_bf16_f32 v120, v120, v121
    v_cvt_pk_bf16_f32 v121, v122, v123
    v_cvt_pk_bf16_f32 v122, v124, v125
    v_cvt_pk_bf16_f32 v123, v126, v127
    buffer_store_dwordx4 v[120:123], v2, s[8:11], s90 offen sc1
    s_add_u32 s90, s90, s100
    v_accvgpr_write_b32 a88, 0
    v_accvgpr_write_b32 a89, 0
    v_accvgpr_write_b32 a90, 0
    v_accvgpr_write_b32 a91, 0
    v_accvgpr_write_b32 a92, 0
    v_accvgpr_write_b32 a93, 0
    v_accvgpr_write_b32 a94, 0
    v_accvgpr_write_b32 a95, 0
    v_accvgpr_read_b32 v24, a248
    v_accvgpr_read_b32 v25, a249
    v_accvgpr_read_b32 v26, a250
    v_accvgpr_read_b32 v27, a251
    v_accvgpr_read_b32 v28, a252
    v_accvgpr_read_b32 v29, a253
    v_accvgpr_read_b32 v30, a254
    v_accvgpr_read_b32 v31, a255
    v_cvt_pk_bf16_f32 v236, v24, v25
    v_cvt_pk_bf16_f32 v237, v26, v27
    v_cvt_pk_bf16_f32 v238, v28, v29
    v_cvt_pk_bf16_f32 v239, v30, v31
    v_cvt_pk_bf16_f32 v128, v128, v129
    v_cvt_pk_bf16_f32 v129, v130, v131
    v_cvt_pk_bf16_f32 v130, v132, v133
    v_cvt_pk_bf16_f32 v131, v134, v135
    buffer_store_dwordx4 v[128:131], v2, s[8:11], s90 offen sc1
    s_add_u32 s90, s90, s100
    v_accvgpr_write_b32 a96, 0
    v_accvgpr_write_b32 a97, 0
    v_accvgpr_write_b32 a98, 0
    v_accvgpr_write_b32 a99, 0
    v_accvgpr_write_b32 a100, 0
    v_accvgpr_write_b32 a101, 0
    v_accvgpr_write_b32 a102, 0
    v_accvgpr_write_b32 a103, 0
    v_cvt_pk_bf16_f32 v240, v160, v161
    v_cvt_pk_bf16_f32 v241, v162, v163
    v_cvt_pk_bf16_f32 v242, v164, v165
    v_cvt_pk_bf16_f32 v243, v166, v167
    v_cvt_pk_bf16_f32 v136, v136, v137
    v_cvt_pk_bf16_f32 v137, v138, v139
    v_cvt_pk_bf16_f32 v138, v140, v141
    v_cvt_pk_bf16_f32 v139, v142, v143
    buffer_store_dwordx4 v[136:139], v2, s[8:11], s90 offen sc1
    s_add_u32 s90, s90, s100
    v_accvgpr_write_b32 a104, 0
    v_accvgpr_write_b32 a105, 0
    v_accvgpr_write_b32 a106, 0
    v_accvgpr_write_b32 a107, 0
    v_accvgpr_write_b32 a108, 0
    v_accvgpr_write_b32 a109, 0
    v_accvgpr_write_b32 a110, 0
    v_accvgpr_write_b32 a111, 0
    v_cvt_pk_bf16_f32 v244, v168, v169
    v_cvt_pk_bf16_f32 v245, v170, v171
    v_cvt_pk_bf16_f32 v246, v172, v173
    v_cvt_pk_bf16_f32 v247, v174, v175
    v_cvt_pk_bf16_f32 v144, v144, v145
    v_cvt_pk_bf16_f32 v145, v146, v147
    v_cvt_pk_bf16_f32 v146, v148, v149
    v_cvt_pk_bf16_f32 v147, v150, v151
    buffer_store_dwordx4 v[144:147], v2, s[8:11], s90 offen sc1
    s_add_u32 s90, s90, s100
    v_accvgpr_write_b32 a112, 0
    v_accvgpr_write_b32 a113, 0
    v_accvgpr_write_b32 a114, 0
    v_accvgpr_write_b32 a115, 0
    v_accvgpr_write_b32 a116, 0
    v_accvgpr_write_b32 a117, 0
    v_accvgpr_write_b32 a118, 0
    v_accvgpr_write_b32 a119, 0
    v_cvt_pk_bf16_f32 v248, v176, v177
    v_cvt_pk_bf16_f32 v249, v178, v179
    v_cvt_pk_bf16_f32 v250, v180, v181
    v_cvt_pk_bf16_f32 v251, v182, v183
    v_cvt_pk_bf16_f32 v152, v152, v153
    v_cvt_pk_bf16_f32 v153, v154, v155
    v_cvt_pk_bf16_f32 v154, v156, v157
    v_cvt_pk_bf16_f32 v155, v158, v159
    buffer_store_dwordx4 v[152:155], v2, s[8:11], s90 offen sc1
    s_add_u32 s90, s90, s100
    v_accvgpr_write_b32 a120, 0
    v_accvgpr_write_b32 a121, 0
    v_accvgpr_write_b32 a122, 0
    v_accvgpr_write_b32 a123, 0
    v_accvgpr_write_b32 a124, 0
    v_accvgpr_write_b32 a125, 0
    v_accvgpr_write_b32 a126, 0
    v_accvgpr_write_b32 a127, 0
    v_cvt_pk_bf16_f32 v252, v184, v185
    v_cvt_pk_bf16_f32 v253, v186, v187
    v_cvt_pk_bf16_f32 v254, v188, v189
    v_cvt_pk_bf16_f32 v255, v190, v191
m_epl85_r:
    s_mov_b32 s17, s101
    s_mov_b32 s38, 268435456
m_init31:
    s_mov_b32 s36, s6
    s_mov_b32 s37, s7
    s_mov_b32 s39, 0x20000
    s_lshl_b32 s90, s99, 1
    s_add_u32 s98, s98, s90
    s_lshl_b32 s90, s100, 2
    s_add_u32 s40, s98, s90
    s_waitcnt vmcnt(32)
    s_waitcnt lgkmcnt(0)
    v_mfma_f32_16x16x32_bf16 v[64:67], a[192:195], a[128:131], 0
    s_and_b32 s92, s2, 7
    s_lshl_b32 s92, s92, 2
    s_bfe_u32 s93, s2, 0x20003
    s_add_u32 s92, s92, s93
    v_mfma_f32_16x16x32_bf16 v[64:67], a[196:199], a[132:135], v[64:67]
    buffer_store_dwordx4 v[192:195], v2, s[36:39], s40 offen sc1
    s_add_u32 s40, s40, s100
    s_lshr_b32 s93, s2, 5
    v_mfma_f32_16x16x32_bf16 v[64:67], a[200:203], a[136:139], v[64:67]
    s_lshl_b32 s93, s93, 2
    s_or_b32 s93, s93, 0x40000
    s_mov_b32 s32, s92
    s_bfe_u32 s33, 4225674377, s93
    v_mfma_f32_16x16x32_bf16 v[64:67], a[204:207], a[140:143], v[64:67]
    s_add_u32 s33, s33, 1
    s_bfe_u32 s34, 873484918, s93
    s_add_u32 s34, s34, 1
    s_lshl_b32 s60, s16, 12
    v_mfma_f32_16x16x32_bf16 v[72:75], a[204:207], a[156:159], 0
    v_add_u32 v7, s60, v2
    s_lshl_b32 s90, s34, 2
    s_lshl_b32 s91, s33, 2
    s_lshl_b32 s26, s91, 13
    v_mfma_f32_16x16x32_bf16 v[72:75], a[200:203], a[152:155], v[72:75]
    buffer_store_dwordx4 v[196:199], v2, s[36:39], s40 offen sc1
    s_add_u32 s40, s40, s100
    s_mov_b32 s30, s26
    v_mfma_f32_16x16x32_bf16 v[72:75], a[196:199], a[148:151], v[72:75]
    s_sub_u32 s67, s90, 4
    s_add_u32 s67, s67, s16
    s_add_u32 s68, s67, 1
    s_mov_b32 s69, s90
    v_mfma_f32_16x16x32_bf16 v[72:75], a[192:195], a[144:147], v[72:75]
    s_sub_u32 s70, s91, 4
    s_add_u32 s70, s70, s16
    s_add_u32 s71, s70, 1
    s_mov_b32 s72, s91
    v_mfma_f32_16x16x32_bf16 v[80:83], a[192:195], a[160:163], 0
    s_cmp_lt_u32 s16, 2
    s_cselect_b32 s90, 2, 0
    s_sub_u32 s72, s72, s90
    s_mov_b32 s27, 0x20000
    v_mfma_f32_16x16x32_bf16 v[80:83], a[196:199], a[164:167], v[80:83]
    buffer_store_dwordx4 v[200:203], v2, s[36:39], s40 offen sc1
    s_add_u32 s40, s40, s100
    s_mov_b32 s31, 0x20000
    v_mfma_f32_16x16x32_bf16 v[80:83], a[200:203], a[168:171], v[80:83]
    s_lshl_b32 s82, s32, 19
    s_add_u32 s90, s82, 16777216
    s_add_u32 s24, s6, s90
    s_addc_u32 s25, s7, 0
    v_mfma_f32_16x16x32_bf16 v[80:83], a[204:207], a[172:175], v[80:83]
    s_add_u32 s90, s82, 33554432
    s_add_u32 s28, s6, s90
    s_addc_u32 s29, s7, 0
    s_mov_b32 s56, 81920
    v_mfma_f32_16x16x32_bf16 v[88:91], a[204:207], a[188:191], 0
    s_mov_b32 s57, 65536
    v_mov_b32 v9, 0xff800000
    s_mov_b32 s65, 1233125376
    s_lshl_b32 s91, s16, 1
    v_mfma_f32_16x16x32_bf16 v[88:91], a[200:203], a[184:187], v[88:91]
    buffer_store_dwordx4 v[204:207], v2, s[36:39], s40 offen sc1
    s_add_u32 s40, s98, s99
    s_sub_u32 s91, s91, 8
    v_mfma_f32_16x16x32_bf16 v[88:91], a[196:199], a[180:183], v[88:91]
    s_lshl_b32 s78, s33, 3
    s_add_u32 s78, s78, s91
    s_lshl_b32 s79, s34, 3
    s_add_u32 s79, s79, s91
    v_mfma_f32_16x16x32_bf16 v[88:91], a[192:195], a[176:179], v[88:91]
    s_lshr_b32 s90, s32, 1
    s_lshl_b32 s90, s90, 7
    s_add_u32 s90, s90, 117444608
    s_lshr_b32 s91, s2, 6
    v_mfma_f32_16x16x32_bf16 v[92:95], a[208:211], a[176:179], 0
    ds_read_b128 a[192:195], v6 offset:8192
    s_lshl_b32 s91, s91, 8
    s_add_u32 s91, s91, 117446592
    v_min_u32 v10, 31, v1
    v_mfma_f32_16x16x32_bf16 v[92:95], a[212:215], a[180:183], v[92:95]
    buffer_store_dwordx4 v[208:211], v2, s[36:39], s40 offen sc1
    s_add_u32 s40, s40, s100
    ds_read_b128 a[196:199], v6 offset:9216
    v_mfma_f32_16x16x32_bf16 v[92:95], a[216:219], a[184:187], v[92:95]
    ds_read_b128 a[200:203], v6 offset:10240
    v_lshlrev_b32 v10, 3, v10
    v_mov_b32 v11, s90
    v_mov_b32 v8, s91
    v_mfma_f32_16x16x32_bf16 v[92:95], a[220:223], a[188:191], v[92:95]
    ds_read_b128 a[204:207], v6 offset:11264
    v_cmp_gt_u32 vcc, 8, v1
    s_nop 1
    v_cndmask_b32 v11, v8, v11, vcc
    v_mfma_f32_16x16x32_bf16 v[84:87], a[220:223], a[172:175], 0
    v_add_u32 v10, v10, v11
    s_mov_b32 s58, 0
    v_mov_b32 v12, 0
    v_mov_b32 v28, 0
    v_mfma_f32_16x16x32_bf16 v[84:87], a[216:219], a[168:171], v[84:87]
    buffer_store_dwordx4 v[212:215], v2, s[36:39], s40 offen sc1
    s_add_u32 s40, s40, s100
    v_mov_b32 v44, 0x3f803f80
    v_mfma_f32_16x16x32_bf16 v[84:87], a[212:215], a[164:167], v[84:87]
    v_mov_b32 v13, 0
    v_mov_b32 v32, 0
    v_mov_b32 v45, 0x3f803f80
    v_mov_b32 v14, 0
    v_mfma_f32_16x16x32_bf16 v[84:87], a[208:211], a[160:163], v[84:87]
    v_mov_b32 v36, 0
    v_mov_b32 v46, 0x3f803f80
    v_mov_b32 v15, 0
    v_mov_b32 v40, 0
    v_mfma_f32_16x16x32_bf16 v[76:79], a[208:211], a[144:147], 0
    v_mov_b32 v47, 0x3f803f80
    s_and_b32 s90, s2, 7
    s_lshl_b32 s90, s90, 4
    s_lshl_b32 s91, s16, 2
    v_mfma_f32_16x16x32_bf16 v[76:79], a[212:215], a[148:151], v[76:79]
    buffer_store_dwordx4 v[216:219], v2, s[36:39], s40 offen sc1
    s_add_u32 s40, s40, s100
    s_add_u32 s80, s90, s91
    v_mfma_f32_16x16x32_bf16 v[76:79], a[216:219], a[152:155], v[76:79]
    s_lshr_b32 s92, s2, 3
    s_lshl_b32 s92, s92, 17
    s_lshl_b32 s90, s80, 10
    s_add_u32 s90, s90, s92
    v_mfma_f32_16x16x32_bf16 v[76:79], a[220:223], a[156:159], v[76:79]
    s_add_u32 s83, s90, 50331648
    s_add_u32 s84, s90, 54525952
    s_and_b32 s81, s80, 63
    s_cmp_eq_u32 s81, 0
    s_cselect_b32 s93, 0, 1024
    v_mfma_f32_16x16x32_bf16 v[68:71], a[220:223], a[140:143], 0
    s_sub_u32 s85, s84, s93
    s_lshl_b32 s90, s80, 9
    s_add_u32 s90, s90, s92
    s_add_u32 s86, s90, 58720256
    v_mfma_f32_16x16x32_bf16 v[68:71], a[216:219], a[136:139], v[68:71]
    buffer_store_dwordx4 v[220:223], v2, s[36:39], s40 offen sc1
    s_add_u32 s40, s40, s100
    s_sub_u32 s87, s86, s93
    v_mfma_f32_16x16x32_bf16 v[68:71], a[212:215], a[132:135], v[68:71]
    s_add_u32 s88, s86, 65536
    s_add_u32 s89, s87, 65536
    v_and_b32 v48, 15, v1
    v_lshrrev_b32 v49, 4, v1
    v_mfma_f32_16x16x32_bf16 v[68:71], a[208:211], a[128:131], v[68:71]
    v_lshlrev_b32 v49, 2, v49
    v_sub_u32 v48, v48, v49
    v_cmp_le_i32 vcc, 0, v48
    s_nop 1
    v_cndmask_b32 v16, v9, 0, vcc
    ds_read_b128 a[208:211], v6 offset:12288
    ds_read_b128 a[212:215], v6 offset:13312
    ds_read_b128 a[216:219], v6 offset:14336
    ds_read_b128 a[220:223], v6 offset:15360
    v_cmp_le_i32 vcc, 1, v48
    s_nop 1
    v_cndmask_b32 v17, v9, 0, vcc
    v_cmp_le_i32 vcc, 2, v48
    s_nop 1
    v_cndmask_b32 v18, v9, 0, vcc
    v_cmp_le_i32 vcc, 3, v48
    s_nop 1
    v_cndmask_b32 v19, v9, 0, vcc
    s_mov_b32 s62, 8945792
    s_mov_b32 s63, 0
    s_sub_u32 s90, s67, 1
    s_bitset1_b64 s[62:63], s90
    s_sub_u32 s90, s68, 1
    s_bitset1_b64 s[62:63], s90
    s_sub_u32 s90, s69, 1
    s_bitset1_b64 s[62:63], s90
    s_sub_u32 s90, s70, 1
    s_bitset1_b64 s[62:63], s90
    s_sub_u32 s90, s71, 1
    s_bitset1_b64 s[62:63], s90
    s_sub_u32 s90, s72, 1
    s_bitset1_b64 s[62:63], s90
    s_add_u32 s53, s69, 8
    s_sub_u32 s90, s53, 1
    s_bitset1_b64 s[62:63], s90
    s_cmp_ge_u32 s2, 224
    s_cselect_b32 s90, 2048, 0
    s_or_b32 s62, s62, s90
    s_lshr_b32 s90, s2, 5
    s_cmp_eq_u32 s90, 3
    s_cselect_b32 s44, s50, s48
    s_cselect_b32 s45, s51, s49
    s_lshl_b32 s90, s90, 3
    s_or_b32 s90, s90, 0x80000
    s_mov_b32 s92, 136321805
    s_mov_b32 s93, 538976288
    s_bfe_u64 s[92:93], s[92:93], s90
    s_lshl_b32 s46, s92, 18
    s_mov_b32 s92, 1772800
    s_mov_b32 s93, 538976288
    s_bfe_u64 s[92:93], s[92:93], s90
    s_lshl_b32 s94, s92, 18
    s_and_b32 s90, s2, 31
    s_lshl_b32 s90, s90, 2
    s_add_u32 s90, s90, s16
    s_lshl_b32 s90, s90, 11
    s_add_u32 s94, s94, s90
    s_mov_b32 s64, 1
    s_nop 3
    s_cmp_lg_u32 s67, 0
    s_cbranch_scc1 m_z91
    v_add_f32 v80, v80, v16
    v_mov_b32 v84, v9
    v_add_f32 v92, v92, v16
    v_add_f32 v81, v81, v17
    v_mov_b32 v85, v9
    v_add_f32 v93, v93, v17
    v_add_f32 v82, v82, v18
    v_mov_b32 v86, v9
    v_add_f32 v94, v94, v18
    v_add_f32 v83, v83, v19
    v_mov_b32 v87, v9
    v_add_f32 v95, v95, v19
m_z91:
    v_max3_f32 v48, v64, v65, v66
    v_max3_f32 v49, v72, v73, v74
    v_max3_f32 v50, v80, v81, v82
    v_max3_f32 v51, v88, v89, v90
    v_max3_f32 v48, v48, v67, v68
    v_max3_f32 v49, v49, v75, v76
    v_max3_f32 v50, v50, v83, v84
    v_max3_f32 v51, v51, v91, v92
    v_max3_f32 v48, v48, v69, v70
    v_max3_f32 v49, v49, v77, v78
    v_max3_f32 v50, v50, v85, v86
    v_max3_f32 v51, v51, v93, v94
    v_max_f32 v48, v48, v71
    v_max_f32 v49, v49, v79
    v_max_f32 v50, v50, v87
    v_max_f32 v51, v51, v95
    v_mov_b32 v52, v48
    v_mov_b32 v53, v49
    v_mov_b32 v54, v50
    v_mov_b32 v55, v51
    s_nop 1
    v_permlane32_swap_b32 v48, v52
    v_permlane32_swap_b32 v49, v53
    v_permlane32_swap_b32 v50, v54
    v_permlane32_swap_b32 v51, v55
    s_nop 1
    v_max_f32 v48, v48, v52
    v_max_f32 v49, v49, v53
    v_max_f32 v50, v50, v54
    v_max_f32 v51, v51, v55
    v_mov_b32 v52, v48
    v_mov_b32 v53, v49
    v_mov_b32 v54, v50
    v_mov_b32 v55, v51
    s_nop 1
    v_permlane16_swap_b32 v48, v52
    v_permlane16_swap_b32 v49, v53
    v_permlane16_swap_b32 v50, v54
    v_permlane16_swap_b32 v51, v55
    s_nop 1
    v_max_f32 v48, v48, v52
    v_max_f32 v49, v49, v53
    v_max_f32 v50, v50, v54
    v_max_f32 v51, v51, v55
    v_sub_f32 v160, 0, v48
    v_sub_f32 v161, 0, v48
    v_sub_f32 v168, 0, v49
    v_sub_f32 v169, 0, v49
    v_sub_f32 v176, 0, v50
    v_sub_f32 v177, 0, v50
    v_sub_f32 v184, 0, v51
    v_sub_f32 v185, 0, v51
    v_mov_b64 v[162:163], v[160:161]
    v_mov_b64 v[164:165], v[160:161]
    v_mov_b64 v[166:167], v[160:161]
    v_mov_b64 v[170:171], v[168:169]
    v_mov_b64 v[172:173], v[168:169]
    v_mov_b64 v[174:175], v[168:169]
    v_mov_b64 v[178:179], v[176:177]
    v_mov_b64 v[180:181], v[176:177]
    v_mov_b64 v[182:183], v[176:177]
    v_mov_b64 v[186:187], v[184:185]
    v_mov_b64 v[188:189], v[184:185]
    v_mov_b64 v[190:191], v[184:185]
    v_pk_add_f32 v[64:65], v[64:65], v[160:161]
    v_pk_add_f32 v[66:67], v[66:67], v[160:161]
    v_pk_add_f32 v[68:69], v[68:69], v[160:161]
    v_pk_add_f32 v[70:71], v[70:71], v[160:161]
    v_pk_add_f32 v[72:73], v[72:73], v[168:169]
    v_pk_add_f32 v[74:75], v[74:75], v[168:169]
    v_pk_add_f32 v[76:77], v[76:77], v[168:169]
    v_pk_add_f32 v[78:79], v[78:79], v[168:169]
    v_pk_add_f32 v[80:81], v[80:81], v[176:177]
    v_pk_add_f32 v[82:83], v[82:83], v[176:177]
    v_pk_add_f32 v[84:85], v[84:85], v[176:177]
    v_pk_add_f32 v[86:87], v[86:87], v[176:177]
    v_pk_add_f32 v[88:89], v[88:89], v[184:185]
    v_pk_add_f32 v[90:91], v[90:91], v[184:185]
    v_pk_add_f32 v[92:93], v[92:93], v[184:185]
    v_pk_add_f32 v[94:95], v[94:95], v[184:185]
    s_cmp_eq_u32 s64, s67
    s_cbranch_scc1 m_eb92
m_er93:
    s_cmp_eq_u32 s64, s68
    s_cbranch_scc1 m_eb94
m_er95:
    v_lshrrev_b32 v200, 2, v1
    v_lshlrev_b32 v200, 7, v200
    v_add_u32 v200, s94, v200
    s_waitcnt lgkmcnt(0)
    v_mfma_f32_16x16x32_bf16 v[96:99], a[192:195], a[128:131], v[160:163]
    s_bitcmp1_b64 s[62:63], s64
    s_cselect_b32 s66, -1.0, s65
    v_exp_f32 v20, v64
    v_mfma_f32_16x16x32_bf16 v[96:99], a[196:199], a[132:135], v[96:99]
    s_add_u32 s64, s64, 1
    v_exp_f32 v21, v65
    v_exp_f32 v22, v66
    v_mfma_f32_16x16x32_bf16 v[96:99], a[200:203], a[136:139], v[96:99]
    buffer_store_dwordx4 v[224:227], v2, s[36:39], s40 offen sc1
    v_cvt_pk_bf16_f32 v128, v20, v21
    v_mfma_f32_16x16x32_bf16 v[96:99], a[204:207], a[140:143], v[96:99]
    s_add_u32 s40, s40, s100
    v_add_f32 v12, v12, v28
    v_exp_f32 v23, v67
    v_mfma_f32_16x16x32_bf16 v[104:107], a[204:207], a[156:159], v[168:171]
    v_exp_f32 v24, v68
    v_cvt_pk_bf16_f32 v129, v22, v23
    v_mfma_f32_16x16x32_bf16 v[104:107], a[200:203], a[152:155], v[104:107]
    buffer_store_dwordx4 v[228:231], v2, s[36:39], s40 offen sc1
    v_exp_f32 v25, v69
    v_mfma_f32_16x16x32_bf16 v[104:107], a[196:199], a[148:151], v[104:107]
    s_add_u32 s40, s40, s100
    v_exp_f32 v26, v70
    v_cvt_pk_bf16_f32 v130, v24, v25
    v_mfma_f32_16x16x32_bf16 v[104:107], a[192:195], a[144:147], v[104:107]
    v_exp_f32 v27, v71
    v_add_f32 v13, v13, v32
    v_mfma_f32_16x16x32_bf16 v[112:115], a[192:195], a[160:163], v[176:179]
    v_exp_f32 v20, v72
    v_cvt_pk_bf16_f32 v131, v26, v27
    v_mfma_f32_16x16x32_bf16 v[112:115], a[196:199], a[164:167], v[112:115]
    buffer_store_dwordx4 v[232:235], v2, s[36:39], s40 offen sc1
    v_exp_f32 v21, v73
    v_mfma_f32_16x16x32_bf16 v[28:31], v[44:47], v[128:131], 0
    v_exp_f32 v22, v74
    v_cvt_pk_bf16_f32 v132, v20, v21
    v_mfma_f32_16x16x32_bf16 v[112:115], a[200:203], a[168:171], v[112:115]
    s_add_u32 s40, s40, s100
    v_exp_f32 v23, v75
    v_add_f32 v14, v14, v36
    v_mfma_f32_16x16x32_bf16 v[112:115], a[204:207], a[172:175], v[112:115]
    v_exp_f32 v24, v76
    v_cvt_pk_bf16_f32 v133, v22, v23
    v_mfma_f32_16x16x32_bf16 v[120:123], a[204:207], a[188:191], v[184:187]
    buffer_store_dwordx4 v[236:239], v2, s[36:39], s40 offen sc1
    v_exp_f32 v25, v77
    v_mfma_f32_16x16x32_bf16 v[120:123], a[200:203], a[184:187], v[120:123]
    s_mov_b32 s40, s98
    v_exp_f32 v26, v78
    v_cvt_pk_bf16_f32 v134, v24, v25
    v_mfma_f32_16x16x32_bf16 v[120:123], a[196:199], a[180:183], v[120:123]
    v_exp_f32 v27, v79
    v_add_f32 v15, v15, v40
    v_mfma_f32_16x16x32_bf16 v[120:123], a[192:195], a[176:179], v[120:123]
    s_waitcnt lgkmcnt(0)
    v_exp_f32 v20, v80
    v_cvt_pk_bf16_f32 v135, v26, v27
    v_mfma_f32_16x16x32_bf16 v[124:127], a[208:211], a[176:179], v[188:191]
    v_exp_f32 v21, v81
    v_exp_f32 v22, v82
    v_mfma_f32_16x16x32_bf16 v[32:35], v[44:47], v[132:135], 0
    v_cvt_pk_bf16_f32 v136, v20, v21
    v_exp_f32 v23, v83
    v_mfma_f32_16x16x32_bf16 v[124:127], a[212:215], a[180:183], v[124:127]
    buffer_store_dwordx4 v[240:243], v2, s[36:39], s40 offen sc1
    v_cvt_pk_bf16_f32 v137, v22, v23
    v_mfma_f32_16x16x32_bf16 v[124:127], a[216:219], a[184:187], v[124:127]
    s_add_u32 s40, s40, s100
    v_exp_f32 v24, v84
    v_mfma_f32_16x16x32_bf16 v[124:127], a[220:223], a[188:191], v[124:127]
    v_exp_f32 v25, v85
    v_exp_f32 v26, v86
    v_cvt_pk_bf16_f32 v138, v24, v25
    v_mfma_f32_16x16x32_bf16 v[116:119], a[220:223], a[172:175], v[180:183]
    buffer_store_dwordx4 v[244:247], v2, s[36:39], s40 offen sc1
    v_mfma_f32_16x16x32_bf16 v[116:119], a[216:219], a[168:171], v[116:119]
    s_add_u32 s40, s40, s100
    v_exp_f32 v27, v87
    v_exp_f32 v20, v88
    v_mfma_f32_16x16x32_bf16 v[116:119], a[212:215], a[164:167], v[116:119]
    v_cvt_pk_bf16_f32 v139, v26, v27
    v_exp_f32 v21, v89
    v_mfma_f32_16x16x32_bf16 v[116:119], a[208:211], a[160:163], v[116:119]
    buffer_store_dwordx4 v[248:251], v2, s[36:39], s40 offen sc1
    v_exp_f32 v22, v90
    v_mfma_f32_16x16x32_bf16 v[36:39], v[44:47], v[136:139], 0
    v_cvt_pk_bf16_f32 v140, v20, v21
    v_exp_f32 v23, v91
    v_mfma_f32_16x16x32_bf16 v[108:111], a[208:211], a[144:147], v[172:175]
    s_add_u32 s40, s40, s100
    v_exp_f32 v24, v92
    v_cvt_pk_bf16_f32 v141, v22, v23
    v_mfma_f32_16x16x32_bf16 v[108:111], a[212:215], a[148:151], v[108:111]
    v_exp_f32 v25, v93
    v_mfma_f32_16x16x32_bf16 v[108:111], a[216:219], a[152:155], v[108:111]
    buffer_store_dwordx4 v[252:255], v2, s[36:39], s40 offen sc1
    v_exp_f32 v26, v94
    v_cvt_pk_bf16_f32 v142, v24, v25
    v_mfma_f32_16x16x32_bf16 v[108:111], a[220:223], a[156:159], v[108:111]
    s_add_u32 s40, s40, s100
    v_exp_f32 v27, v95
    s_nop 0
    v_cvt_pk_bf16_f32 v143, v26, v27
    s_nop 1
    v_mfma_f32_16x16x32_bf16 v[40:43], v[44:47], v[140:143], 0
    s_nop 2
    v_mfma_f32_16x16x32_bf16 v[100:103], a[220:223], a[140:143], v[164:167]
    s_nop 2
    v_mfma_f32_16x16x32_bf16 v[100:103], a[216:219], a[136:139], v[100:103]
    v_max3_f32 v8, v28, v32, v36
    v_max_f32 v8, v8, v40
    v_mfma_f32_16x16x32_bf16 v[100:103], a[212:215], a[132:135], v[100:103]
    v_cmp_nge_f32 vcc, s66, v8
    v_mfma_f32_16x16x32_bf16 v[100:103], a[208:211], a[128:131], v[100:103]
    s_waitcnt vmcnt(48) lgkmcnt(0)
    s_barrier
    s_add_u32 s59, s58, s60
    s_add_u32 s58, s58, 32768
    s_cmp_ge_u32 s58, 163840
    s_cselect_b32 s58, 0, s58
    v_add_u32 v6, s58, v2
    ds_read_b128 a[192:195], v6 offset:0
    ds_read_b128 a[196:199], v6 offset:1024
    ds_read_b128 a[200:203], v6 offset:2048
    ds_read_b128 a[204:207], v6 offset:3072
    ds_read_b128 a[208:211], v6 offset:4096
    ds_read_b128 a[212:215], v6 offset:5120
    ds_read_b128 a[216:219], v6 offset:6144
    ds_read_b128 a[220:223], v6 offset:7168
    s_waitcnt lgkmcnt(0)
    s_cbranch_vccnz m_stub96
m_ret97:
.p2align 3
m_dual98:
    v_mfma_f32_16x16x32_bf16 v[64:67], a[192:195], a[128:131], v[160:163]
    s_bitcmp1_b64 s[62:63], s64
    s_cselect_b32 s66, -1.0, s65
    v_add_f32 v12, v12, v28
    v_mfma_f32_16x16x32_bf16 v[64:67], a[196:199], a[132:135], v[64:67]
    s_add_u32 s64, s64, 1
    ds_read_b128 a[224:227], v6 offset:16384
    v_add_f32 v13, v13, v32
    v_mfma_f32_16x16x32_bf16 v[64:67], a[200:203], a[136:139], v[64:67]
    v_exp_f32 v20, v96
    v_mfma_f32_16x16x32_bf16 v[64:67], a[204:207], a[140:143], v[64:67]
    v_exp_f32 v21, v97
    v_mfma_f32_16x16x32_bf16 v[72:75], a[204:207], a[156:159], v[168:171]
    s_mov_b32 m0, s59
    ds_read_b128 a[228:231], v6 offset:17408
    v_cvt_pk_bf16_f32 v144, v20, v21
    v_mfma_f32_16x16x32_bf16 v[72:75], a[200:203], a[152:155], v[72:75]
    buffer_load_dwordx4 v7, s[24:27], s56 offen offset:0 sc1 lds
    v_mfma_f32_16x16x32_bf16 v[72:75], a[196:199], a[148:151], v[72:75]
    v_exp_f32 v22, v98
    v_mfma_f32_16x16x32_bf16 v[72:75], a[192:195], a[144:147], v[72:75]
    ds_read_b128 a[232:235], v6 offset:18432
    v_add_f32 v14, v14, v36
    v_mfma_f32_16x16x32_bf16 v[80:83], a[192:195], a[160:163], v[176:179]
    v_exp_f32 v23, v99
    v_mfma_f32_16x16x32_bf16 v[80:83], a[196:199], a[164:167], v[80:83]
    v_exp_f32 v24, v100
    v_mfma_f32_16x16x32_bf16 v[80:83], a[200:203], a[168:171], v[80:83]
    ds_read_b128 a[236:239], v6 offset:19456
    v_cvt_pk_bf16_f32 v145, v22, v23
    v_mfma_f32_16x16x32_bf16 v[80:83], a[204:207], a[172:175], v[80:83]
    v_exp_f32 v25, v101
    v_mfma_f32_16x16x32_bf16 v[88:91], a[204:207], a[188:191], v[184:187]
    v_exp_f32 v26, v102
    v_mfma_f32_16x16x32_bf16 v[88:91], a[200:203], a[184:187], v[88:91]
    ds_read_b128 a[240:243], v6 offset:20480
    v_cvt_pk_bf16_f32 v146, v24, v25
    v_mfma_f32_16x16x32_bf16 v[88:91], a[196:199], a[180:183], v[88:91]
    v_exp_f32 v27, v103
    v_mfma_f32_16x16x32_bf16 v[88:91], a[192:195], a[176:179], v[88:91]
    s_waitcnt lgkmcnt(5)
    v_exp_f32 v20, v104
    v_mfma_f32_16x16x32_bf16 v[92:95], a[208:211], a[176:179], v[188:191]
    ds_read_b128 a[244:247], v6 offset:21504
    v_cvt_pk_bf16_f32 v147, v26, v27
    v_mfma_f32_16x16x32_bf16 v[92:95], a[212:215], a[180:183], v[92:95]
    v_exp_f32 v21, v105
    v_mfma_f32_16x16x32_bf16 v[28:31], v[44:47], v[144:147], 0
    v_exp_f32 v22, v106
    v_mfma_f32_16x16x32_bf16 v[92:95], a[216:219], a[184:187], v[92:95]
    buffer_load_dwordx4 v7, s[24:27], s56 offen offset:1024 sc1 lds
    v_mfma_f32_16x16x32_bf16 v[92:95], a[220:223], a[188:191], v[92:95]
    ds_read_b128 a[248:251], v6 offset:22528
    v_cvt_pk_bf16_f32 v148, v20, v21
    v_mfma_f32_16x16x32_bf16 v[84:87], a[220:223], a[172:175], v[180:183]
    v_exp_f32 v23, v107
    v_mfma_f32_16x16x32_bf16 v[84:87], a[216:219], a[168:171], v[84:87]
    v_exp_f32 v24, v108
    v_mfma_f32_16x16x32_bf16 v[84:87], a[212:215], a[164:167], v[84:87]
    ds_read_b128 a[252:255], v6 offset:23552
    v_cvt_pk_bf16_f32 v149, v22, v23
    v_mfma_f32_16x16x32_bf16 v[84:87], a[208:211], a[160:163], v[84:87]
    v_exp_f32 v25, v109
    v_mfma_f32_16x16x32_bf16 v[76:79], a[208:211], a[144:147], v[172:175]
    v_exp_f32 v26, v110
    v_mfma_f32_16x16x32_bf16 v[76:79], a[212:215], a[148:151], v[76:79]
    v_cvt_pk_bf16_f32 v150, v24, v25
    v_add_f32 v15, v15, v40
    v_mfma_f32_16x16x32_bf16 v[76:79], a[216:219], a[152:155], v[76:79]
    v_exp_f32 v27, v111
    v_mfma_f32_16x16x32_bf16 v[76:79], a[220:223], a[156:159], v[76:79]
    buffer_load_dwordx4 v7, s[24:27], s56 offen offset:2048 sc1 lds
    v_mfma_f32_16x16x32_bf16 v[68:71], a[220:223], a[140:143], v[164:167]
    v_exp_f32 v20, v112
    v_mfma_f32_16x16x32_bf16 v[68:71], a[216:219], a[136:139], v[68:71]
    v_cvt_pk_bf16_f32 v151, v26, v27
    v_mfma_f32_16x16x32_bf16 v[68:71], a[212:215], a[132:135], v[68:71]
    v_exp_f32 v21, v113
    v_mfma_f32_16x16x32_bf16 v[32:35], v[44:47], v[148:151], 0
    v_exp_f32 v22, v114
    v_mfma_f32_16x16x32_bf16 v[68:71], a[208:211], a[128:131], v[68:71]
    s_waitcnt lgkmcnt(0)
    v_cvt_pk_bf16_f32 v152, v20, v21
    v_mfma_f32_16x16x32_bf16 a[0:3], a[224:227], v[128:131], a[0:3]
    ds_read_b128 a[192:195], v6 offset:8192
    v_mfma_f32_16x16x32_bf16 a[32:35], a[224:227], v[132:135], a[32:35]
    v_exp_f32 v23, v115
    v_mfma_f32_16x16x32_bf16 a[64:67], a[224:227], v[136:139], a[64:67]
    v_exp_f32 v24, v116
    v_mfma_f32_16x16x32_bf16 a[96:99], a[224:227], v[140:143], a[96:99]
    ds_read_b128 a[196:199], v6 offset:9216
    v_cvt_pk_bf16_f32 v153, v22, v23
    v_mfma_f32_16x16x32_bf16 a[100:103], a[228:231], v[140:143], a[100:103]
    v_exp_f32 v25, v117
    v_mfma_f32_16x16x32_bf16 a[68:71], a[228:231], v[136:139], a[68:71]
    v_exp_f32 v26, v118
    v_mfma_f32_16x16x32_bf16 a[36:39], a[228:231], v[132:135], a[36:39]
    ds_read_b128 a[200:203], v6 offset:10240
    v_cvt_pk_bf16_f32 v154, v24, v25
    v_mfma_f32_16x16x32_bf16 a[4:7], a[228:231], v[128:131], a[4:7]
    v_exp_f32 v27, v119
    v_mfma_f32_16x16x32_bf16 a[8:11], a[232:235], v[128:131], a[8:11]
    v_exp_f32 v20, v120
    v_mfma_f32_16x16x32_bf16 a[40:43], a[232:235], v[132:135], a[40:43]
    ds_read_b128 a[204:207], v6 offset:11264
    v_cvt_pk_bf16_f32 v155, v26, v27
    v_mfma_f32_16x16x32_bf16 a[72:75], a[232:235], v[136:139], a[72:75]
    v_exp_f32 v21, v121
    v_mfma_f32_16x16x32_bf16 v[36:39], v[44:47], v[152:155], 0
    v_exp_f32 v22, v122
    v_mfma_f32_16x16x32_bf16 a[104:107], a[232:235], v[140:143], a[104:107]
    buffer_load_dwordx4 v7, s[24:27], s56 offen offset:3072 sc1 lds
    v_mfma_f32_16x16x32_bf16 a[108:111], a[236:239], v[140:143], a[108:111]
    s_add_u32 s56, s56, 16384
    v_cvt_pk_bf16_f32 v156, v20, v21
    v_mfma_f32_16x16x32_bf16 a[76:79], a[236:239], v[136:139], a[76:79]
    v_exp_f32 v23, v123
    v_mfma_f32_16x16x32_bf16 a[44:47], a[236:239], v[132:135], a[44:47]
    v_exp_f32 v24, v124
    v_mfma_f32_16x16x32_bf16 a[12:15], a[236:239], v[128:131], a[12:15]
    v_cvt_pk_bf16_f32 v157, v22, v23
    v_mfma_f32_16x16x32_bf16 a[16:19], a[240:243], v[128:131], a[16:19]
    v_exp_f32 v25, v125
    v_mfma_f32_16x16x32_bf16 a[48:51], a[240:243], v[132:135], a[48:51]
    v_exp_f32 v26, v126
    v_mfma_f32_16x16x32_bf16 a[80:83], a[240:243], v[136:139], a[80:83]
    v_cvt_pk_bf16_f32 v158, v24, v25
    v_mfma_f32_16x16x32_bf16 a[112:115], a[240:243], v[140:143], a[112:115]
    s_add_u32 m0, s59, 16384
    v_exp_f32 v27, v127
    v_mfma_f32_16x16x32_bf16 a[116:119], a[244:247], v[140:143], a[116:119]
    buffer_load_dwordx4 v7, s[28:31], s57 offen offset:0 sc1 lds
    v_mfma_f32_16x16x32_bf16 a[84:87], a[244:247], v[136:139], a[84:87]
    v_cvt_pk_bf16_f32 v159, v26, v27
    v_mfma_f32_16x16x32_bf16 a[52:55], a[244:247], v[132:135], a[52:55]
    v_mfma_f32_16x16x32_bf16 a[20:23], a[244:247], v[128:131], a[20:23]
    v_mfma_f32_16x16x32_bf16 v[40:43], v[44:47], v[156:159], 0
    s_nop 2
    v_mfma_f32_16x16x32_bf16 a[24:27], a[248:251], v[128:131], a[24:27]
    s_nop 2
    v_mfma_f32_16x16x32_bf16 a[56:59], a[248:251], v[132:135], a[56:59]
    v_max3_f32 v8, v28, v32, v36
    v_max_f32 v8, v8, v40
    v_mfma_f32_16x16x32_bf16 a[88:91], a[248:251], v[136:139], a[88:91]
    v_cmp_nge_f32 vcc, s66, v8
    v_mfma_f32_16x16x32_bf16 a[120:123], a[248:251], v[140:143], a[120:123]
    ds_read_b128 a[208:211], v6 offset:12288
    v_mfma_f32_16x16x32_bf16 a[124:127], a[252:255], v[140:143], a[124:127]
    ds_read_b128 a[212:215], v6 offset:13312
    v_mfma_f32_16x16x32_bf16 a[92:95], a[252:255], v[136:139], a[92:95]
    ds_read_b128 a[216:219], v6 offset:14336
    v_mfma_f32_16x16x32_bf16 a[60:63], a[252:255], v[132:135], a[60:63]
    ds_read_b128 a[220:223], v6 offset:15360
    v_mfma_f32_16x16x32_bf16 a[28:31], a[252:255], v[128:131], a[28:31]
    s_waitcnt lgkmcnt(4)
    s_cbranch_vccnz m_stub99
m_ret100:
    v_mfma_f32_16x16x32_bf16 v[96:99], a[192:195], a[128:131], v[160:163]
    s_add_u32 s59, s58, s60
    v_exp_f32 v20, v64
    v_mfma_f32_16x16x32_bf16 v[96:99], a[196:199], a[132:135], v[96:99]
    s_add_u32 s58, s58, 32768
    ds_read_b128 a[224:227], v6 offset:24576
    v_add_f32 v12, v12, v28
    v_mfma_f32_16x16x32_bf16 v[96:99], a[200:203], a[136:139], v[96:99]
    s_cmp_ge_u32 s58, 163840
    s_cselect_b32 s58, 0, s58
    v_exp_f32 v21, v65
    v_mfma_f32_16x16x32_bf16 v[96:99], a[204:207], a[140:143], v[96:99]
    s_bitcmp1_b64 s[62:63], s64
    s_cselect_b32 s66, -1.0, s65
    v_cvt_pk_bf16_f32 v128, v20, v21
    v_mfma_f32_16x16x32_bf16 v[104:107], a[204:207], a[156:159], v[168:171]
    s_add_u32 s64, s64, 1
    ds_read_b128 a[228:231], v6 offset:25600
    v_add_f32 v13, v13, v32
    v_mfma_f32_16x16x32_bf16 v[104:107], a[200:203], a[152:155], v[104:107]
    v_exp_f32 v22, v66
    v_mfma_f32_16x16x32_bf16 v[104:107], a[196:199], a[148:151], v[104:107]
    buffer_load_dwordx4 v7, s[28:31], s57 offen offset:1024 sc1 lds
    v_mfma_f32_16x16x32_bf16 v[104:107], a[192:195], a[144:147], v[104:107]
    ds_read_b128 a[232:235], v6 offset:26624
    v_add_f32 v14, v14, v36
    v_mfma_f32_16x16x32_bf16 v[112:115], a[192:195], a[160:163], v[176:179]
    v_exp_f32 v23, v67
    v_mfma_f32_16x16x32_bf16 v[112:115], a[196:199], a[164:167], v[112:115]
    v_exp_f32 v24, v68
    v_mfma_f32_16x16x32_bf16 v[112:115], a[200:203], a[168:171], v[112:115]
    ds_read_b128 a[236:239], v6 offset:27648
    v_cvt_pk_bf16_f32 v129, v22, v23
    v_mfma_f32_16x16x32_bf16 v[112:115], a[204:207], a[172:175], v[112:115]
    v_exp_f32 v25, v69
    v_mfma_f32_16x16x32_bf16 v[120:123], a[204:207], a[188:191], v[184:187]
    v_exp_f32 v26, v70
    v_mfma_f32_16x16x32_bf16 v[120:123], a[200:203], a[184:187], v[120:123]
    ds_read_b128 a[240:243], v6 offset:28672
    v_cvt_pk_bf16_f32 v130, v24, v25
    v_mfma_f32_16x16x32_bf16 v[120:123], a[196:199], a[180:183], v[120:123]
    v_exp_f32 v27, v71
    v_mfma_f32_16x16x32_bf16 v[120:123], a[192:195], a[176:179], v[120:123]
    s_waitcnt lgkmcnt(5)
    v_exp_f32 v20, v72
    v_mfma_f32_16x16x32_bf16 v[124:127], a[208:211], a[176:179], v[188:191]
    ds_read_b128 a[244:247], v6 offset:29696
    v_cvt_pk_bf16_f32 v131, v26, v27
    v_mfma_f32_16x16x32_bf16 v[124:127], a[212:215], a[180:183], v[124:127]
    v_exp_f32 v21, v73
    v_mfma_f32_16x16x32_bf16 v[28:31], v[44:47], v[128:131], 0
    v_exp_f32 v22, v74
    v_mfma_f32_16x16x32_bf16 v[124:127], a[216:219], a[184:187], v[124:127]
    buffer_load_dwordx4 v7, s[28:31], s57 offen offset:2048 sc1 lds
    v_mfma_f32_16x16x32_bf16 v[124:127], a[220:223], a[188:191], v[124:127]
    ds_read_b128 a[248:251], v6 offset:30720
    v_cvt_pk_bf16_f32 v132, v20, v21
    v_mfma_f32_16x16x32_bf16 v[116:119], a[220:223], a[172:175], v[180:183]
    v_exp_f32 v23, v75
    v_mfma_f32_16x16x32_bf16 v[116:119], a[216:219], a[168:171], v[116:119]
    v_exp_f32 v24, v76
    v_mfma_f32_16x16x32_bf16 v[116:119], a[212:215], a[164:167], v[116:119]
    ds_read_b128 a[252:255], v6 offset:31744
    v_cvt_pk_bf16_f32 v133, v22, v23
    v_mfma_f32_16x16x32_bf16 v[116:119], a[208:211], a[160:163], v[116:119]
    v_exp_f32 v25, v77
    v_mfma_f32_16x16x32_bf16 v[108:111], a[208:211], a[144:147], v[172:175]
    v_exp_f32 v26, v78
    v_mfma_f32_16x16x32_bf16 v[108:111], a[212:215], a[148:151], v[108:111]
    v_cvt_pk_bf16_f32 v134, v24, v25
    v_add_f32 v15, v15, v40
    v_mfma_f32_16x16x32_bf16 v[108:111], a[216:219], a[152:155], v[108:111]
    v_exp_f32 v27, v79
    v_mfma_f32_16x16x32_bf16 v[108:111], a[220:223], a[156:159], v[108:111]
    buffer_load_dwordx4 v7, s[28:31], s57 offen offset:3072 sc1 lds
    v_mfma_f32_16x16x32_bf16 v[100:103], a[220:223], a[140:143], v[164:167]
    s_add_u32 s57, s57, 16384
    v_exp_f32 v20, v80
    v_mfma_f32_16x16x32_bf16 v[100:103], a[216:219], a[136:139], v[100:103]
    v_cvt_pk_bf16_f32 v135, v26, v27
    v_mfma_f32_16x16x32_bf16 v[100:103], a[212:215], a[132:135], v[100:103]
    v_exp_f32 v21, v81
    v_mfma_f32_16x16x32_bf16 v[32:35], v[44:47], v[132:135], 0
    v_exp_f32 v22, v82
    v_mfma_f32_16x16x32_bf16 v[100:103], a[208:211], a[128:131], v[100:103]
    s_waitcnt vmcnt(27) lgkmcnt(0)
    v_add_u32 v6, s58, v2
    v_cvt_pk_bf16_f32 v136, v20, v21
    v_mfma_f32_16x16x32_bf16 a[0:3], a[224:227], v[144:147], a[0:3]
    s_barrier
    v_mfma_f32_16x16x32_bf16 a[32:35], a[224:227], v[148:151], a[32:35]
    ds_read_b128 a[192:195], v6 offset:0
    v_mfma_f32_16x16x32_bf16 a[64:67], a[224:227], v[152:155], a[64:67]
    v_exp_f32 v23, v83
    v_mfma_f32_16x16x32_bf16 a[96:99], a[224:227], v[156:159], a[96:99]
    v_exp_f32 v24, v84
    v_mfma_f32_16x16x32_bf16 a[100:103], a[228:231], v[156:159], a[100:103]
    ds_read_b128 a[196:199], v6 offset:1024
    v_cvt_pk_bf16_f32 v137, v22, v23
    v_mfma_f32_16x16x32_bf16 a[68:71], a[228:231], v[152:155], a[68:71]
    v_exp_f32 v25, v85
    v_mfma_f32_16x16x32_bf16 a[36:39], a[228:231], v[148:151], a[36:39]
    v_exp_f32 v26, v86
    v_mfma_f32_16x16x32_bf16 a[4:7], a[228:231], v[144:147], a[4:7]
    ds_read_b128 a[200:203], v6 offset:2048
    v_cvt_pk_bf16_f32 v138, v24, v25
    v_mfma_f32_16x16x32_bf16 a[8:11], a[232:235], v[144:147], a[8:11]
    v_exp_f32 v27, v87
    v_mfma_f32_16x16x32_bf16 a[40:43], a[232:235], v[148:151], a[40:43]
    v_exp_f32 v20, v88
    v_mfma_f32_16x16x32_bf16 a[72:75], a[232:235], v[152:155], a[72:75]
    ds_read_b128 a[204:207], v6 offset:3072
    v_cvt_pk_bf16_f32 v139, v26, v27
    v_mfma_f32_16x16x32_bf16 a[104:107], a[232:235], v[156:159], a[104:107]
    v_exp_f32 v21, v89
    v_mfma_f32_16x16x32_bf16 v[36:39], v[44:47], v[136:139], 0
    v_exp_f32 v22, v90
    v_mfma_f32_16x16x32_bf16 a[108:111], a[236:239], v[156:159], a[108:111]
    v_cvt_pk_bf16_f32 v140, v20, v21
    v_mfma_f32_16x16x32_bf16 a[76:79], a[236:239], v[152:155], a[76:79]
    v_exp_f32 v23, v91
    v_mfma_f32_16x16x32_bf16 a[44:47], a[236:239], v[148:151], a[44:47]
    v_exp_f32 v24, v92
    v_mfma_f32_16x16x32_bf16 a[12:15], a[236:239], v[144:147], a[12:15]
    buffer_load_dword v255, v200, s[44:47], 0 offen
    v_add_u32 v200, 262144, v200
    v_mfma_f32_16x16x32_bf16 a[16:19], a[240:243], v[144:147], a[16:19]
    v_cvt_pk_bf16_f32 v141, v22, v23
    v_mfma_f32_16x16x32_bf16 a[48:51], a[240:243], v[148:151], a[48:51]
    v_exp_f32 v25, v93
    v_mfma_f32_16x16x32_bf16 a[80:83], a[240:243], v[152:155], a[80:83]
    v_exp_f32 v26, v94
    v_mfma_f32_16x16x32_bf16 a[112:115], a[240:243], v[156:159], a[112:115]
    v_cvt_pk_bf16_f32 v142, v24, v25
    v_mfma_f32_16x16x32_bf16 a[116:119], a[244:247], v[156:159], a[116:119]
    v_exp_f32 v27, v95
    v_mfma_f32_16x16x32_bf16 a[84:87], a[244:247], v[152:155], a[84:87]
    v_cvt_pk_bf16_f32 v143, v26, v27
    v_mfma_f32_16x16x32_bf16 a[52:55], a[244:247], v[148:151], a[52:55]
    v_mfma_f32_16x16x32_bf16 a[20:23], a[244:247], v[144:147], a[20:23]
    v_mfma_f32_16x16x32_bf16 v[40:43], v[44:47], v[140:143], 0
    s_nop 2
    v_mfma_f32_16x16x32_bf16 a[24:27], a[248:251], v[144:147], a[24:27]
    s_nop 2
    v_mfma_f32_16x16x32_bf16 a[56:59], a[248:251], v[148:151], a[56:59]
    v_max3_f32 v8, v28, v32, v36
    v_max_f32 v8, v8, v40
    v_mfma_f32_16x16x32_bf16 a[88:91], a[248:251], v[152:155], a[88:91]
    v_cmp_nge_f32 vcc, s66, v8
    v_mfma_f32_16x16x32_bf16 a[120:123], a[248:251], v[156:159], a[120:123]
    ds_read_b128 a[208:211], v6 offset:4096
    v_mfma_f32_16x16x32_bf16 a[124:127], a[252:255], v[156:159], a[124:127]
    ds_read_b128 a[212:215], v6 offset:5120
    v_mfma_f32_16x16x32_bf16 a[92:95], a[252:255], v[152:155], a[92:95]
    ds_read_b128 a[216:219], v6 offset:6144
    v_mfma_f32_16x16x32_bf16 a[60:63], a[252:255], v[148:151], a[60:63]
    ds_read_b128 a[220:223], v6 offset:7168
    v_mfma_f32_16x16x32_bf16 a[28:31], a[252:255], v[144:147], a[28:31]
    s_waitcnt lgkmcnt(4)
    s_cbranch_vccz m_dual98
    v_cmp_lt_f32 vcc, s65, v8
    s_cmp_eq_u32 s64, s67
    s_cbranch_scc1 m_eb102
m_er103:
    s_cmp_eq_u32 s64, s68
    s_cbranch_scc1 m_eb104
m_er105:
    s_cmp_eq_u32 s64, s70
    s_cbranch_scc1 m_eb106
m_er107:
    s_cmp_eq_u32 s64, s53
    s_cbranch_scc1 m_eb108
m_er109:
    s_cmp_eq_u32 s64, 8
    s_cbranch_scc1 m_eb111
    s_cmp_eq_u32 s64, 12
    s_cbranch_scc1 m_eb112
    s_cmp_eq_u32 s64, 16
    s_cbranch_scc1 m_eb113
    s_cmp_eq_u32 s64, 20
    s_cbranch_scc1 m_eb115
    s_cmp_eq_u32 s64, 24
    s_cbranch_scc1 m_eb116
m_e110:
    s_cbranch_vccnz m_rc118
m_sp101:
    s_cmp_lg_u32 s64, s69
    s_cbranch_scc1 m_dual98
    v_mfma_f32_16x16x32_bf16 v[64:67], a[192:195], a[128:131], v[160:163]
    s_bitcmp1_b64 s[62:63], s64
    s_cselect_b32 s66, -1.0, s65
    v_add_f32 v12, v12, v28
    v_mfma_f32_16x16x32_bf16 v[64:67], a[196:199], a[132:135], v[64:67]
    s_add_u32 s64, s64, 1
    ds_read_b128 a[224:227], v6 offset:16384
    v_exp_f32 v20, v96
    v_mfma_f32_16x16x32_bf16 v[64:67], a[200:203], a[136:139], v[64:67]
    s_mov_b32 m0, s59
    ds_read_b128 a[228:231], v6 offset:17408
    v_add_f32 v13, v13, v32
    v_mfma_f32_16x16x32_bf16 v[64:67], a[204:207], a[140:143], v[64:67]
    buffer_load_dwordx4 v7, s[24:27], s56 offen offset:0 sc1 lds
    v_mfma_f32_16x16x32_bf16 v[72:75], a[204:207], a[156:159], v[168:171]
    ds_read_b128 a[232:235], v6 offset:18432
    v_add_f32 v14, v14, v36
    v_mfma_f32_16x16x32_bf16 v[72:75], a[200:203], a[152:155], v[72:75]
    ds_read_b128 a[236:239], v6 offset:19456
    v_exp_f32 v21, v97
    v_mfma_f32_16x16x32_bf16 v[72:75], a[196:199], a[148:151], v[72:75]
    ds_read_b128 a[240:243], v6 offset:20480
    v_cvt_pk_bf16_f32 v144, v20, v21
    v_mfma_f32_16x16x32_bf16 v[72:75], a[192:195], a[144:147], v[72:75]
    s_waitcnt lgkmcnt(5)
    ds_read_b128 a[244:247], v6 offset:21504
    v_add_f32 v15, v15, v40
    v_mfma_f32_16x16x32_bf16 v[76:79], a[208:211], a[144:147], v[172:175]
    ds_read_b128 a[248:251], v6 offset:22528
    v_exp_f32 v22, v98
    v_mfma_f32_16x16x32_bf16 v[76:79], a[212:215], a[148:151], v[76:79]
    ds_read_b128 a[252:255], v6 offset:23552
    v_exp_f32 v23, v99
    v_mfma_f32_16x16x32_bf16 v[76:79], a[216:219], a[152:155], v[76:79]
    v_exp_f32 v24, v100
    v_mfma_f32_16x16x32_bf16 v[76:79], a[220:223], a[156:159], v[76:79]
    buffer_load_dwordx4 v7, s[24:27], s56 offen offset:1024 sc1 lds
    v_mfma_f32_16x16x32_bf16 v[68:71], a[220:223], a[140:143], v[164:167]
    v_cvt_pk_bf16_f32 v145, v22, v23
    v_exp_f32 v25, v101
    v_mfma_f32_16x16x32_bf16 v[68:71], a[216:219], a[136:139], v[68:71]
    v_exp_f32 v26, v102
    v_mfma_f32_16x16x32_bf16 v[68:71], a[212:215], a[132:135], v[68:71]
    v_cvt_pk_bf16_f32 v146, v24, v25
    v_exp_f32 v27, v103
    v_mfma_f32_16x16x32_bf16 v[68:71], a[208:211], a[128:131], v[68:71]
    s_waitcnt lgkmcnt(0)
    v_exp_f32 v20, v104
    v_mfma_f32_16x16x32_bf16 a[0:3], a[224:227], v[128:131], a[0:3]
    ds_read_b128 a[192:195], v6 offset:8192
    v_cvt_pk_bf16_f32 v147, v26, v27
    v_mfma_f32_16x16x32_bf16 a[32:35], a[224:227], v[132:135], a[32:35]
    v_exp_f32 v21, v105
    v_mfma_f32_16x16x32_bf16 v[28:31], v[44:47], v[144:147], 0
    v_exp_f32 v22, v106
    v_mfma_f32_16x16x32_bf16 a[64:67], a[224:227], v[136:139], a[64:67]
    v_cvt_pk_bf16_f32 v148, v20, v21
    v_exp_f32 v23, v107
    v_mfma_f32_16x16x32_bf16 a[96:99], a[224:227], v[140:143], a[96:99]
    ds_read_b128 a[196:199], v6 offset:9216
    v_cvt_pk_bf16_f32 v149, v22, v23
    v_mfma_f32_16x16x32_bf16 a[100:103], a[228:231], v[140:143], a[100:103]
    v_exp_f32 v24, v108
    v_mfma_f32_16x16x32_bf16 a[68:71], a[228:231], v[136:139], a[68:71]
    buffer_load_dwordx4 v7, s[24:27], s56 offen offset:2048 sc1 lds
    v_mfma_f32_16x16x32_bf16 a[36:39], a[228:231], v[132:135], a[36:39]
    ds_read_b128 a[200:203], v6 offset:10240
    v_exp_f32 v25, v109
    v_mfma_f32_16x16x32_bf16 a[4:7], a[228:231], v[128:131], a[4:7]
    v_exp_f32 v26, v110
    v_mfma_f32_16x16x32_bf16 a[8:11], a[232:235], v[128:131], a[8:11]
    v_cvt_pk_bf16_f32 v150, v24, v25
    v_exp_f32 v27, v111
    v_mfma_f32_16x16x32_bf16 a[40:43], a[232:235], v[132:135], a[40:43]
    ds_read_b128 a[204:207], v6 offset:11264
    v_cvt_pk_bf16_f32 v151, v26, v27
    v_mfma_f32_16x16x32_bf16 a[72:75], a[232:235], v[136:139], a[72:75]
    v_exp_f32 v20, v112
    v_mfma_f32_16x16x32_bf16 v[32:35], v[44:47], v[148:151], 0
    v_exp_f32 v21, v113
    v_mfma_f32_16x16x32_bf16 a[104:107], a[232:235], v[140:143], a[104:107]
    v_exp_f32 v22, v114
    v_mfma_f32_16x16x32_bf16 a[108:111], a[236:239], v[140:143], a[108:111]
    v_cvt_pk_bf16_f32 v152, v20, v21
    v_exp_f32 v23, v115
    v_mfma_f32_16x16x32_bf16 a[76:79], a[236:239], v[136:139], a[76:79]
    v_exp_f32 v24, v116
    v_mfma_f32_16x16x32_bf16 a[44:47], a[236:239], v[132:135], a[44:47]
    v_cvt_pk_bf16_f32 v153, v22, v23
    v_exp_f32 v25, v117
    v_mfma_f32_16x16x32_bf16 a[12:15], a[236:239], v[128:131], a[12:15]
    buffer_load_dwordx4 v7, s[24:27], s56 offen offset:3072 sc1 lds
    v_mfma_f32_16x16x32_bf16 a[16:19], a[240:243], v[128:131], a[16:19]
    s_add_u32 s56, s56, 16384
    v_exp_f32 v26, v118
    v_mfma_f32_16x16x32_bf16 a[48:51], a[240:243], v[132:135], a[48:51]
    v_cvt_pk_bf16_f32 v154, v24, v25
    v_exp_f32 v27, v119
    v_mfma_f32_16x16x32_bf16 a[80:83], a[240:243], v[136:139], a[80:83]
    v_exp_f32 v20, v120
    v_mfma_f32_16x16x32_bf16 a[112:115], a[240:243], v[140:143], a[112:115]
    v_cvt_pk_bf16_f32 v155, v26, v27
    v_exp_f32 v21, v121
    v_mfma_f32_16x16x32_bf16 a[116:119], a[244:247], v[140:143], a[116:119]
    v_exp_f32 v22, v122
    v_mfma_f32_16x16x32_bf16 v[36:39], v[44:47], v[152:155], 0
    v_cvt_pk_bf16_f32 v156, v20, v21
    v_mfma_f32_16x16x32_bf16 a[84:87], a[244:247], v[136:139], a[84:87]
    v_exp_f32 v23, v123
    v_mfma_f32_16x16x32_bf16 a[52:55], a[244:247], v[132:135], a[52:55]
    v_exp_f32 v24, v124
    v_cvt_pk_bf16_f32 v157, v22, v23
    v_mfma_f32_16x16x32_bf16 a[20:23], a[244:247], v[128:131], a[20:23]
    v_exp_f32 v25, v125
    v_mfma_f32_16x16x32_bf16 a[24:27], a[248:251], v[128:131], a[24:27]
    s_add_u32 m0, s59, 16384
    v_exp_f32 v26, v126
    v_mfma_f32_16x16x32_bf16 a[56:59], a[248:251], v[132:135], a[56:59]
    buffer_load_dwordx4 v7, s[28:31], s57 offen offset:0 sc1 lds
    v_mfma_f32_16x16x32_bf16 a[88:91], a[248:251], v[136:139], a[88:91]
    v_cvt_pk_bf16_f32 v158, v24, v25
    v_exp_f32 v27, v127
    v_mfma_f32_16x16x32_bf16 a[120:123], a[248:251], v[140:143], a[120:123]
    ds_read_b128 a[208:211], v6 offset:12288
    v_cvt_pk_bf16_f32 v159, v26, v27
    s_nop 1
    v_mfma_f32_16x16x32_bf16 v[40:43], v[44:47], v[156:159], 0
    s_nop 2
    v_mfma_f32_16x16x32_bf16 a[124:127], a[252:255], v[140:143], a[124:127]
    ds_read_b128 a[212:215], v6 offset:13312
    s_nop 0
    v_mfma_f32_16x16x32_bf16 a[92:95], a[252:255], v[136:139], a[92:95]
    ds_read_b128 a[216:219], v6 offset:14336
    v_max3_f32 v8, v28, v32, v36
    v_mfma_f32_16x16x32_bf16 a[60:63], a[252:255], v[132:135], a[60:63]
    ds_read_b128 a[220:223], v6 offset:15360
    v_max_f32 v8, v8, v40
    v_cmp_nge_f32 vcc, s66, v8
    v_mfma_f32_16x16x32_bf16 a[28:31], a[252:255], v[128:131], a[28:31]
    s_waitcnt lgkmcnt(4)
    s_cbranch_vccnz m_stub119
m_ret120:
    v_mfma_f32_16x16x32_bf16 v[96:99], a[192:195], a[128:131], v[160:163]
    s_add_u32 s59, s58, s60
    v_exp_f32 v20, v64
    v_mfma_f32_16x16x32_bf16 v[96:99], a[196:199], a[132:135], v[96:99]
    s_add_u32 s58, s58, 32768
    ds_read_b128 a[224:227], v6 offset:24576
    v_add_f32 v12, v12, v28
    v_mfma_f32_16x16x32_bf16 v[96:99], a[200:203], a[136:139], v[96:99]
    s_cmp_ge_u32 s58, 163840
    s_cselect_b32 s58, 0, s58
    ds_read_b128 a[228:231], v6 offset:25600
    v_add_f32 v13, v13, v32
    v_mfma_f32_16x16x32_bf16 v[96:99], a[204:207], a[140:143], v[96:99]
    buffer_load_dwordx4 v7, s[28:31], s57 offen offset:1024 sc1 lds
    v_mfma_f32_16x16x32_bf16 v[104:107], a[204:207], a[156:159], v[168:171]
    s_bitcmp1_b64 s[62:63], s64
    s_cselect_b32 s66, -1.0, s65
    ds_read_b128 a[232:235], v6 offset:26624
    v_mfma_f32_16x16x32_bf16 v[104:107], a[200:203], a[152:155], v[104:107]
    s_add_u32 s64, s64, 1
    ds_read_b128 a[236:239], v6 offset:27648
    v_mfma_f32_16x16x32_bf16 v[104:107], a[196:199], a[148:151], v[104:107]
    ds_read_b128 a[240:243], v6 offset:28672
    v_mfma_f32_16x16x32_bf16 v[104:107], a[192:195], a[144:147], v[104:107]
    s_waitcnt lgkmcnt(5)
    ds_read_b128 a[244:247], v6 offset:29696
    v_mfma_f32_16x16x32_bf16 v[108:111], a[208:211], a[144:147], v[172:175]
    buffer_load_dwordx4 v7, s[28:31], s57 offen offset:2048 sc1 lds
    v_mfma_f32_16x16x32_bf16 v[108:111], a[212:215], a[148:151], v[108:111]
    ds_read_b128 a[248:251], v6 offset:30720
    v_mfma_f32_16x16x32_bf16 v[108:111], a[216:219], a[152:155], v[108:111]
    ds_read_b128 a[252:255], v6 offset:31744
    v_mfma_f32_16x16x32_bf16 v[108:111], a[220:223], a[156:159], v[108:111]
    v_exp_f32 v21, v65
    v_mfma_f32_16x16x32_bf16 v[100:103], a[220:223], a[140:143], v[164:167]
    v_exp_f32 v22, v66
    v_mfma_f32_16x16x32_bf16 v[100:103], a[216:219], a[136:139], v[100:103]
    buffer_load_dwordx4 v7, s[28:31], s57 offen offset:3072 sc1 lds
    v_mfma_f32_16x16x32_bf16 v[100:103], a[212:215], a[132:135], v[100:103]
    s_add_u32 s57, s57, 16384
    v_cvt_pk_bf16_f32 v128, v20, v21
    v_mfma_f32_16x16x32_bf16 v[100:103], a[208:211], a[128:131], v[100:103]
    s_waitcnt vmcnt(24) lgkmcnt(0)
    v_add_u32 v6, s58, v2
    v_mfma_f32_16x16x32_bf16 a[0:3], a[224:227], v[144:147], a[0:3]
    s_barrier
    v_mfma_f32_16x16x32_bf16 a[32:35], a[224:227], v[148:151], a[32:35]
    ds_read_b128 a[192:195], v6 offset:0
    v_mfma_f32_16x16x32_bf16 a[64:67], a[224:227], v[152:155], a[64:67]
    v_exp_f32 v23, v67
    v_mfma_f32_16x16x32_bf16 a[96:99], a[224:227], v[156:159], a[96:99]
    v_exp_f32 v24, v68
    v_mfma_f32_16x16x32_bf16 a[100:103], a[228:231], v[156:159], a[100:103]
    ds_read_b128 a[196:199], v6 offset:1024
    v_cvt_pk_bf16_f32 v129, v22, v23
    v_mfma_f32_16x16x32_bf16 a[68:71], a[228:231], v[152:155], a[68:71]
    v_exp_f32 v25, v69
    v_mfma_f32_16x16x32_bf16 a[36:39], a[228:231], v[148:151], a[36:39]
    v_exp_f32 v26, v70
    v_mfma_f32_16x16x32_bf16 a[4:7], a[228:231], v[144:147], a[4:7]
    ds_read_b128 a[200:203], v6 offset:2048
    v_cvt_pk_bf16_f32 v130, v24, v25
    v_mfma_f32_16x16x32_bf16 a[8:11], a[232:235], v[144:147], a[8:11]
    v_exp_f32 v27, v71
    v_mfma_f32_16x16x32_bf16 a[40:43], a[232:235], v[148:151], a[40:43]
    v_exp_f32 v20, v72
    v_mfma_f32_16x16x32_bf16 a[72:75], a[232:235], v[152:155], a[72:75]
    ds_read_b128 a[204:207], v6 offset:3072
    v_cvt_pk_bf16_f32 v131, v26, v27
    v_mfma_f32_16x16x32_bf16 a[104:107], a[232:235], v[156:159], a[104:107]
    v_exp_f32 v21, v73
    v_mfma_f32_16x16x32_bf16 v[28:31], v[44:47], v[128:131], 0
    v_exp_f32 v22, v74
    v_mfma_f32_16x16x32_bf16 a[108:111], a[236:239], v[156:159], a[108:111]
    v_cvt_pk_bf16_f32 v132, v20, v21
    v_mfma_f32_16x16x32_bf16 a[76:79], a[236:239], v[152:155], a[76:79]
    v_exp_f32 v23, v75
    v_mfma_f32_16x16x32_bf16 a[44:47], a[236:239], v[148:151], a[44:47]
    v_exp_f32 v24, v76
    v_mfma_f32_16x16x32_bf16 a[12:15], a[236:239], v[144:147], a[12:15]
    v_cvt_pk_bf16_f32 v133, v22, v23
    v_mfma_f32_16x16x32_bf16 a[16:19], a[240:243], v[144:147], a[16:19]
    v_exp_f32 v25, v77
    v_mfma_f32_16x16x32_bf16 a[48:51], a[240:243], v[148:151], a[48:51]
    v_exp_f32 v26, v78
    v_mfma_f32_16x16x32_bf16 a[80:83], a[240:243], v[152:155], a[80:83]
    v_cvt_pk_bf16_f32 v134, v24, v25
    v_mfma_f32_16x16x32_bf16 a[112:115], a[240:243], v[156:159], a[112:115]
    v_exp_f32 v27, v79
    v_mfma_f32_16x16x32_bf16 a[116:119], a[244:247], v[156:159], a[116:119]
    v_cvt_pk_bf16_f32 v135, v26, v27
    v_mfma_f32_16x16x32_bf16 a[84:87], a[244:247], v[152:155], a[84:87]
    v_mfma_f32_16x16x32_bf16 a[52:55], a[244:247], v[148:151], a[52:55]
    v_mfma_f32_16x16x32_bf16 v[32:35], v[44:47], v[132:135], 0
    s_nop 2
    v_mfma_f32_16x16x32_bf16 a[20:23], a[244:247], v[144:147], a[20:23]
    s_nop 2
    v_mfma_f32_16x16x32_bf16 a[24:27], a[248:251], v[144:147], a[24:27]
    v_max_f32 v8, v28, v32
    v_cmp_nge_f32 vcc, s66, v8
    v_mfma_f32_16x16x32_bf16 a[56:59], a[248:251], v[148:151], a[56:59]
    v_mfma_f32_16x16x32_bf16 a[88:91], a[248:251], v[152:155], a[88:91]
    v_mfma_f32_16x16x32_bf16 a[120:123], a[248:251], v[156:159], a[120:123]
    ds_read_b128 a[208:211], v6 offset:4096
    v_mfma_f32_16x16x32_bf16 a[124:127], a[252:255], v[156:159], a[124:127]
    ds_read_b128 a[212:215], v6 offset:5120
    v_mfma_f32_16x16x32_bf16 a[92:95], a[252:255], v[152:155], a[92:95]
    ds_read_b128 a[216:219], v6 offset:6144
    v_mfma_f32_16x16x32_bf16 a[60:63], a[252:255], v[148:151], a[60:63]
    ds_read_b128 a[220:223], v6 offset:7168
    v_mfma_f32_16x16x32_bf16 a[28:31], a[252:255], v[144:147], a[28:31]
    s_waitcnt lgkmcnt(4)
    s_cbranch_vccnz m_stub121
m_ret122:
    v_add_f32 v20, v14, v36
    v_add_f32 v21, v15, v40
    s_nop 3
    v_rcp_f32 v22, v21
    v_rcp_f32 v20, v20
    s_lshl_b32 s90, s79, 10
    s_add_u32 s90, s90, s82
    s_add_u32 s90, s90, 67108864
    v_accvgpr_read_b32 v48, a64
    v_accvgpr_read_b32 v49, a65
    v_accvgpr_read_b32 v50, a66
    v_accvgpr_read_b32 v51, a67
    v_accvgpr_read_b32 v52, a68
    v_accvgpr_read_b32 v53, a69
    v_accvgpr_read_b32 v54, a70
    v_accvgpr_read_b32 v55, a71
    v_pk_mul_f32 v[48:49], v[48:49], v[20:21] op_sel_hi:[1,0]
    v_pk_mul_f32 v[50:51], v[50:51], v[20:21] op_sel_hi:[1,0]
    v_pk_mul_f32 v[52:53], v[52:53], v[20:21] op_sel_hi:[1,0]
    v_pk_mul_f32 v[54:55], v[54:55], v[20:21] op_sel_hi:[1,0]
    v_cvt_pk_bf16_f32 v48, v48, v49
    v_cvt_pk_bf16_f32 v49, v50, v51
    v_cvt_pk_bf16_f32 v50, v52, v53
    v_cvt_pk_bf16_f32 v51, v54, v55
    buffer_store_dwordx4 v[48:51], v2, s[8:11], s90 offen offset:0 sc1
    v_accvgpr_read_b32 v56, a96
    v_accvgpr_read_b32 v57, a97
    v_accvgpr_read_b32 v58, a98
    v_accvgpr_read_b32 v59, a99
    v_accvgpr_read_b32 v60, a100
    v_accvgpr_read_b32 v61, a101
    v_accvgpr_read_b32 v62, a102
    v_accvgpr_read_b32 v63, a103
    v_pk_mul_f32 v[56:57], v[56:57], v[22:23] op_sel_hi:[1,0]
    v_pk_mul_f32 v[58:59], v[58:59], v[22:23] op_sel_hi:[1,0]
    v_pk_mul_f32 v[60:61], v[60:61], v[22:23] op_sel_hi:[1,0]
    v_pk_mul_f32 v[62:63], v[62:63], v[22:23] op_sel_hi:[1,0]
    v_cvt_pk_bf16_f32 v56, v56, v57
    v_cvt_pk_bf16_f32 v57, v58, v59
    v_cvt_pk_bf16_f32 v58, v60, v61
    v_cvt_pk_bf16_f32 v59, v62, v63
    buffer_store_dwordx4 v[56:59], v2, s[8:11], s90 offen offset:1024 sc1
    s_add_u32 s90, s90, 131072
    v_accvgpr_read_b32 v48, a72
    v_accvgpr_read_b32 v49, a73
    v_accvgpr_read_b32 v50, a74
    v_accvgpr_read_b32 v51, a75
    v_accvgpr_read_b32 v52, a76
    v_accvgpr_read_b32 v53, a77
    v_accvgpr_read_b32 v54, a78
    v_accvgpr_read_b32 v55, a79
    v_pk_mul_f32 v[48:49], v[48:49], v[20:21] op_sel_hi:[1,0]
    v_pk_mul_f32 v[50:51], v[50:51], v[20:21] op_sel_hi:[1,0]
    v_pk_mul_f32 v[52:53], v[52:53], v[20:21] op_sel_hi:[1,0]
    v_pk_mul_f32 v[54:55], v[54:55], v[20:21] op_sel_hi:[1,0]
    v_cvt_pk_bf16_f32 v48, v48, v49
    v_cvt_pk_bf16_f32 v49, v50, v51
    v_cvt_pk_bf16_f32 v50, v52, v53
    v_cvt_pk_bf16_f32 v51, v54, v55
    buffer_store_dwordx4 v[48:51], v2, s[8:11], s90 offen offset:0 sc1
    v_accvgpr_read_b32 v56, a104
    v_accvgpr_read_b32 v57, a105
    v_accvgpr_read_b32 v58, a106
    v_accvgpr_read_b32 v59, a107
    v_accvgpr_read_b32 v60, a108
    v_accvgpr_read_b32 v61, a109
    v_accvgpr_read_b32 v62, a110
    v_accvgpr_read_b32 v63, a111
    v_pk_mul_f32 v[56:57], v[56:57], v[22:23] op_sel_hi:[1,0]
    v_pk_mul_f32 v[58:59], v[58:59], v[22:23] op_sel_hi:[1,0]
    v_pk_mul_f32 v[60:61], v[60:61], v[22:23] op_sel_hi:[1,0]
    v_pk_mul_f32 v[62:63], v[62:63], v[22:23] op_sel_hi:[1,0]
    v_cvt_pk_bf16_f32 v56, v56, v57
    v_cvt_pk_bf16_f32 v57, v58, v59
    v_cvt_pk_bf16_f32 v58, v60, v61
    v_cvt_pk_bf16_f32 v59, v62, v63
    buffer_store_dwordx4 v[56:59], v2, s[8:11], s90 offen offset:1024 sc1
    s_add_u32 s90, s90, 131072
    v_accvgpr_read_b32 v48, a80
    v_accvgpr_read_b32 v49, a81
    v_accvgpr_read_b32 v50, a82
    v_accvgpr_read_b32 v51, a83
    v_accvgpr_read_b32 v52, a84
    v_accvgpr_read_b32 v53, a85
    v_accvgpr_read_b32 v54, a86
    v_accvgpr_read_b32 v55, a87
    v_pk_mul_f32 v[48:49], v[48:49], v[20:21] op_sel_hi:[1,0]
    v_pk_mul_f32 v[50:51], v[50:51], v[20:21] op_sel_hi:[1,0]
    v_pk_mul_f32 v[52:53], v[52:53], v[20:21] op_sel_hi:[1,0]
    v_pk_mul_f32 v[54:55], v[54:55], v[20:21] op_sel_hi:[1,0]
    v_cvt_pk_bf16_f32 v48, v48, v49
    v_cvt_pk_bf16_f32 v49, v50, v51
    v_cvt_pk_bf16_f32 v50, v52, v53
    v_cvt_pk_bf16_f32 v51, v54, v55
    buffer_store_dwordx4 v[48:51], v2, s[8:11], s90 offen offset:0 sc1
    v_accvgpr_read_b32 v56, a112
    v_accvgpr_read_b32 v57, a113
    v_accvgpr_read_b32 v58, a114
    v_accvgpr_read_b32 v59, a115
    v_accvgpr_read_b32 v60, a116
    v_accvgpr_read_b32 v61, a117
    v_accvgpr_read_b32 v62, a118
    v_accvgpr_read_b32 v63, a119
    v_pk_mul_f32 v[56:57], v[56:57], v[22:23] op_sel_hi:[1,0]
    v_pk_mul_f32 v[58:59], v[58:59], v[22:23] op_sel_hi:[1,0]
    v_pk_mul_f32 v[60:61], v[60:61], v[22:23] op_sel_hi:[1,0]
    v_pk_mul_f32 v[62:63], v[62:63], v[22:23] op_sel_hi:[1,0]
    v_cvt_pk_bf16_f32 v56, v56, v57
    v_cvt_pk_bf16_f32 v57, v58, v59
    v_cvt_pk_bf16_f32 v58, v60, v61
    v_cvt_pk_bf16_f32 v59, v62, v63
    buffer_store_dwordx4 v[56:59], v2, s[8:11], s90 offen offset:1024 sc1
    s_add_u32 s90, s90, 131072
    v_accvgpr_read_b32 v48, a88
    v_accvgpr_read_b32 v49, a89
    v_accvgpr_read_b32 v50, a90
    v_accvgpr_read_b32 v51, a91
    v_accvgpr_read_b32 v52, a92
    v_accvgpr_read_b32 v53, a93
    v_accvgpr_read_b32 v54, a94
    v_accvgpr_read_b32 v55, a95
    v_pk_mul_f32 v[48:49], v[48:49], v[20:21] op_sel_hi:[1,0]
    v_pk_mul_f32 v[50:51], v[50:51], v[20:21] op_sel_hi:[1,0]
    v_pk_mul_f32 v[52:53], v[52:53], v[20:21] op_sel_hi:[1,0]
    v_pk_mul_f32 v[54:55], v[54:55], v[20:21] op_sel_hi:[1,0]
    v_cvt_pk_bf16_f32 v48, v48, v49
    v_cvt_pk_bf16_f32 v49, v50, v51
    v_cvt_pk_bf16_f32 v50, v52, v53
    v_cvt_pk_bf16_f32 v51, v54, v55
    buffer_store_dwordx4 v[48:51], v2, s[8:11], s90 offen offset:0 sc1
    v_accvgpr_read_b32 v56, a120
    v_accvgpr_read_b32 v57, a121
    v_accvgpr_read_b32 v58, a122
    v_accvgpr_read_b32 v59, a123
    v_accvgpr_read_b32 v60, a124
    v_accvgpr_read_b32 v61, a125
    v_accvgpr_read_b32 v62, a126
    v_accvgpr_read_b32 v63, a127
    v_pk_mul_f32 v[56:57], v[56:57], v[22:23] op_sel_hi:[1,0]
    v_pk_mul_f32 v[58:59], v[58:59], v[22:23] op_sel_hi:[1,0]
    v_pk_mul_f32 v[60:61], v[60:61], v[22:23] op_sel_hi:[1,0]
    v_pk_mul_f32 v[62:63], v[62:63], v[22:23] op_sel_hi:[1,0]
    v_cvt_pk_bf16_f32 v56, v56, v57
    v_cvt_pk_bf16_f32 v57, v58, v59
    v_cvt_pk_bf16_f32 v58, v60, v61
    v_cvt_pk_bf16_f32 v59, v62, v63
    buffer_store_dwordx4 v[56:59], v2, s[8:11], s90 offen offset:1024 sc1
    s_add_u32 s90, s90, 131072
    s_lshl_b32 s101, s34, 5
    s_add_u32 s101, s101, s32
    s_lshl_b32 s101, s101, 3
    s_add_u32 s101, s101, 7936
    s_cmp_eq_u32 s64, s72
    s_cbranch_scc1 m_singlex124
.p2align 3
m_single123:
    v_mfma_f32_16x16x32_bf16 v[64:67], a[192:195], a[128:131], v[160:163]
    s_bitcmp1_b64 s[62:63], s64
    s_cselect_b32 s66, -1.0, s65
    v_add_f32 v12, v12, v28
    v_mfma_f32_16x16x32_bf16 v[64:67], a[196:199], a[132:135], v[64:67]
    s_mov_b32 m0, s59
    ds_read_b128 a[224:227], v6 offset:16384
    v_add_f32 v13, v13, v32
    v_mfma_f32_16x16x32_bf16 v[64:67], a[200:203], a[136:139], v[64:67]
    buffer_load_dwordx4 v7, s[24:27], s56 offen offset:0 sc1 lds
    v_mfma_f32_16x16x32_bf16 v[64:67], a[204:207], a[140:143], v[64:67]
    s_add_u32 s64, s64, 1
    ds_read_b128 a[228:231], v6 offset:17408
    v_exp_f32 v20, v96
    v_mfma_f32_16x16x32_bf16 v[72:75], a[204:207], a[156:159], v[168:171]
    ds_read_b128 a[232:235], v6 offset:18432
    v_exp_f32 v21, v97
    v_mfma_f32_16x16x32_bf16 v[72:75], a[200:203], a[152:155], v[72:75]
    ds_read_b128 a[236:239], v6 offset:19456
    v_cvt_pk_bf16_f32 v144, v20, v21
    v_mfma_f32_16x16x32_bf16 v[72:75], a[196:199], a[148:151], v[72:75]
    ds_read_b128 a[240:243], v6 offset:20480
    v_exp_f32 v22, v98
    v_mfma_f32_16x16x32_bf16 v[72:75], a[192:195], a[144:147], v[72:75]
    s_waitcnt lgkmcnt(5)
    ds_read_b128 a[244:247], v6 offset:21504
    v_mfma_f32_16x16x32_bf16 v[76:79], a[208:211], a[144:147], v[172:175]
    ds_read_b128 a[248:251], v6 offset:22528
    v_exp_f32 v23, v99
    v_mfma_f32_16x16x32_bf16 v[76:79], a[212:215], a[148:151], v[76:79]
    ds_read_b128 a[252:255], v6 offset:23552
    v_cvt_pk_bf16_f32 v145, v22, v23
    v_mfma_f32_16x16x32_bf16 v[76:79], a[216:219], a[152:155], v[76:79]
    buffer_load_dwordx4 v7, s[24:27], s56 offen offset:1024 sc1 lds
    v_mfma_f32_16x16x32_bf16 v[76:79], a[220:223], a[156:159], v[76:79]
    v_exp_f32 v24, v100
    v_mfma_f32_16x16x32_bf16 v[68:71], a[220:223], a[140:143], v[164:167]
    v_exp_f32 v25, v101
    v_mfma_f32_16x16x32_bf16 v[68:71], a[216:219], a[136:139], v[68:71]
    v_exp_f32 v26, v102
    v_mfma_f32_16x16x32_bf16 v[68:71], a[212:215], a[132:135], v[68:71]
    buffer_load_dwordx4 v7, s[24:27], s56 offen offset:2048 sc1 lds
    v_cvt_pk_bf16_f32 v146, v24, v25
    v_mfma_f32_16x16x32_bf16 v[68:71], a[208:211], a[128:131], v[68:71]
    s_waitcnt lgkmcnt(0)
    v_exp_f32 v27, v103
    v_mfma_f32_16x16x32_bf16 a[0:3], a[224:227], v[128:131], a[0:3]
    ds_read_b128 a[192:195], v6 offset:8192
    v_cvt_pk_bf16_f32 v147, v26, v27
    v_mfma_f32_16x16x32_bf16 a[32:35], a[224:227], v[132:135], a[32:35]
    v_exp_f32 v20, v104
    v_mfma_f32_16x16x32_bf16 v[28:31], v[44:47], v[144:147], 0
    v_exp_f32 v21, v105
    v_mfma_f32_16x16x32_bf16 a[36:39], a[228:231], v[132:135], a[36:39]
    ds_read_b128 a[196:199], v6 offset:9216
    v_exp_f32 v22, v106
    v_mfma_f32_16x16x32_bf16 a[4:7], a[228:231], v[128:131], a[4:7]
    buffer_load_dwordx4 v7, s[24:27], s56 offen offset:3072 sc1 lds
    v_mfma_f32_16x16x32_bf16 a[8:11], a[232:235], v[128:131], a[8:11]
    s_add_u32 s56, s56, 16384
    ds_read_b128 a[200:203], v6 offset:10240
    v_cvt_pk_bf16_f32 v148, v20, v21
    v_mfma_f32_16x16x32_bf16 a[40:43], a[232:235], v[132:135], a[40:43]
    v_exp_f32 v23, v107
    v_mfma_f32_16x16x32_bf16 a[44:47], a[236:239], v[132:135], a[44:47]
    ds_read_b128 a[204:207], v6 offset:11264
    v_exp_f32 v24, v108
    v_mfma_f32_16x16x32_bf16 a[12:15], a[236:239], v[128:131], a[12:15]
    v_cvt_pk_bf16_f32 v149, v22, v23
    v_exp_f32 v25, v109
    v_mfma_f32_16x16x32_bf16 a[16:19], a[240:243], v[128:131], a[16:19]
    v_exp_f32 v26, v110
    v_mfma_f32_16x16x32_bf16 a[48:51], a[240:243], v[132:135], a[48:51]
    v_cvt_pk_bf16_f32 v150, v24, v25
    v_exp_f32 v27, v111
    v_mfma_f32_16x16x32_bf16 a[52:55], a[244:247], v[132:135], a[52:55]
    ds_read_b128 a[208:211], v6 offset:12288
    v_cvt_pk_bf16_f32 v151, v26, v27
    v_mfma_f32_16x16x32_bf16 a[20:23], a[244:247], v[128:131], a[20:23]
    s_add_u32 m0, s59, 16384
    ds_read_b128 a[212:215], v6 offset:13312
    v_mfma_f32_16x16x32_bf16 v[32:35], v[44:47], v[148:151], 0
    s_nop 2
    v_mfma_f32_16x16x32_bf16 a[24:27], a[248:251], v[128:131], a[24:27]
    buffer_load_dwordx4 v7, s[28:31], s57 offen offset:0 sc1 lds
    v_mfma_f32_16x16x32_bf16 a[56:59], a[248:251], v[132:135], a[56:59]
    ds_read_b128 a[216:219], v6 offset:14336
    s_nop 0
    v_mfma_f32_16x16x32_bf16 a[60:63], a[252:255], v[132:135], a[60:63]
    ds_read_b128 a[220:223], v6 offset:15360
    v_max_f32 v8, v28, v32
    v_cmp_nge_f32 vcc, s66, v8
    v_mfma_f32_16x16x32_bf16 a[28:31], a[252:255], v[128:131], a[28:31]
    s_waitcnt lgkmcnt(4)
    s_cbranch_vccnz m_stub125
m_ret126:
    v_mfma_f32_16x16x32_bf16 v[96:99], a[192:195], a[128:131], v[160:163]
    s_add_u32 s59, s58, s60
    v_exp_f32 v20, v64
    v_mfma_f32_16x16x32_bf16 v[96:99], a[196:199], a[132:135], v[96:99]
    s_add_u32 s58, s58, 32768
    ds_read_b128 a[224:227], v6 offset:24576
    v_add_f32 v12, v12, v28
    v_mfma_f32_16x16x32_bf16 v[96:99], a[200:203], a[136:139], v[96:99]
    s_cmp_ge_u32 s58, 163840
    s_cselect_b32 s58, 0, s58
    ds_read_b128 a[228:231], v6 offset:25600
    v_exp_f32 v21, v65
    v_mfma_f32_16x16x32_bf16 v[96:99], a[204:207], a[140:143], v[96:99]
    s_bitcmp1_b64 s[62:63], s64
    s_cselect_b32 s66, -1.0, s65
    ds_read_b128 a[232:235], v6 offset:26624
    v_mfma_f32_16x16x32_bf16 v[104:107], a[204:207], a[156:159], v[168:171]
    buffer_load_dwordx4 v7, s[28:31], s57 offen offset:1024 sc1 lds
    v_mfma_f32_16x16x32_bf16 v[104:107], a[200:203], a[152:155], v[104:107]
    s_add_u32 s64, s64, 1
    ds_read_b128 a[236:239], v6 offset:27648
    v_cvt_pk_bf16_f32 v128, v20, v21
    v_mfma_f32_16x16x32_bf16 v[104:107], a[196:199], a[148:151], v[104:107]
    ds_read_b128 a[240:243], v6 offset:28672
    v_exp_f32 v22, v66
    v_mfma_f32_16x16x32_bf16 v[104:107], a[192:195], a[144:147], v[104:107]
    s_waitcnt lgkmcnt(5)
    ds_read_b128 a[244:247], v6 offset:29696
    v_add_f32 v13, v13, v32
    v_mfma_f32_16x16x32_bf16 v[108:111], a[208:211], a[144:147], v[172:175]
    ds_read_b128 a[248:251], v6 offset:30720
    v_exp_f32 v23, v67
    v_mfma_f32_16x16x32_bf16 v[108:111], a[212:215], a[148:151], v[108:111]
    buffer_load_dwordx4 v7, s[28:31], s57 offen offset:2048 sc1 lds
    v_mfma_f32_16x16x32_bf16 v[108:111], a[216:219], a[152:155], v[108:111]
    ds_read_b128 a[252:255], v6 offset:31744
    v_cvt_pk_bf16_f32 v129, v22, v23
    v_mfma_f32_16x16x32_bf16 v[108:111], a[220:223], a[156:159], v[108:111]
    v_exp_f32 v24, v68
    v_mfma_f32_16x16x32_bf16 v[100:103], a[220:223], a[140:143], v[164:167]
    v_exp_f32 v25, v69
    v_mfma_f32_16x16x32_bf16 v[100:103], a[216:219], a[136:139], v[100:103]
    buffer_load_dwordx4 v7, s[28:31], s57 offen offset:3072 sc1 lds
    v_mfma_f32_16x16x32_bf16 v[100:103], a[212:215], a[132:135], v[100:103]
    s_add_u32 s57, s57, 16384
    v_exp_f32 v26, v70
    v_cvt_pk_bf16_f32 v130, v24, v25
    v_mfma_f32_16x16x32_bf16 v[100:103], a[208:211], a[128:131], v[100:103]
    s_waitcnt vmcnt(24) lgkmcnt(0)
    v_add_u32 v6, s58, v2
    v_exp_f32 v27, v71
    v_mfma_f32_16x16x32_bf16 a[0:3], a[224:227], v[144:147], a[0:3]
    s_barrier
    v_mfma_f32_16x16x32_bf16 a[32:35], a[224:227], v[148:151], a[32:35]
    ds_read_b128 a[192:195], v6 offset:0
    v_cvt_pk_bf16_f32 v131, v26, v27
    v_mfma_f32_16x16x32_bf16 a[36:39], a[228:231], v[148:151], a[36:39]
    v_exp_f32 v20, v72
    v_mfma_f32_16x16x32_bf16 v[28:31], v[44:47], v[128:131], 0
    v_exp_f32 v21, v73
    v_mfma_f32_16x16x32_bf16 a[4:7], a[228:231], v[144:147], a[4:7]
    ds_read_b128 a[196:199], v6 offset:1024
    v_cvt_pk_bf16_f32 v132, v20, v21
    v_mfma_f32_16x16x32_bf16 a[8:11], a[232:235], v[144:147], a[8:11]
    v_exp_f32 v22, v74
    v_mfma_f32_16x16x32_bf16 a[40:43], a[232:235], v[148:151], a[40:43]
    ds_read_b128 a[200:203], v6 offset:2048
    v_exp_f32 v23, v75
    v_mfma_f32_16x16x32_bf16 a[44:47], a[236:239], v[148:151], a[44:47]
    v_exp_f32 v24, v76
    v_mfma_f32_16x16x32_bf16 a[12:15], a[236:239], v[144:147], a[12:15]
    ds_read_b128 a[204:207], v6 offset:3072
    v_cvt_pk_bf16_f32 v133, v22, v23
    v_mfma_f32_16x16x32_bf16 a[16:19], a[240:243], v[144:147], a[16:19]
    v_exp_f32 v25, v77
    v_mfma_f32_16x16x32_bf16 a[48:51], a[240:243], v[148:151], a[48:51]
    v_exp_f32 v26, v78
    v_cvt_pk_bf16_f32 v134, v24, v25
    v_mfma_f32_16x16x32_bf16 a[52:55], a[244:247], v[148:151], a[52:55]
    v_exp_f32 v27, v79
    v_mfma_f32_16x16x32_bf16 a[20:23], a[244:247], v[144:147], a[20:23]
    ds_read_b128 a[208:211], v6 offset:4096
    v_cvt_pk_bf16_f32 v135, v26, v27
    s_nop 1
    v_mfma_f32_16x16x32_bf16 v[32:35], v[44:47], v[132:135], 0
    s_nop 2
    v_mfma_f32_16x16x32_bf16 a[24:27], a[248:251], v[144:147], a[24:27]
    ds_read_b128 a[212:215], v6 offset:5120
    s_nop 0
    v_mfma_f32_16x16x32_bf16 a[56:59], a[248:251], v[148:151], a[56:59]
    ds_read_b128 a[216:219], v6 offset:6144
    v_max_f32 v8, v28, v32
    v_mfma_f32_16x16x32_bf16 a[60:63], a[252:255], v[148:151], a[60:63]
    ds_read_b128 a[220:223], v6 offset:7168
    v_cmp_nge_f32 vcc, s66, v8
    v_mfma_f32_16x16x32_bf16 a[28:31], a[252:255], v[144:147], a[28:31]
    s_waitcnt lgkmcnt(4)
    s_cbranch_vccz m_single123
    v_cmp_lt_f32 vcc, s65, v8
    s_cmp_eq_u32 s64, s70
    s_cbranch_scc1 m_eb128
m_er129:
    s_cmp_eq_u32 s64, s71
    s_cbranch_scc1 m_eb130
m_er131:
    s_cmp_eq_u32 s64, s53
    s_cbranch_scc1 m_eb132
m_er133:
    s_cmp_eq_u32 s64, 8
    s_cbranch_scc1 m_eb135
    s_cmp_eq_u32 s64, 12
    s_cbranch_scc1 m_eb136
    s_cmp_eq_u32 s64, 16
    s_cbranch_scc1 m_eb137
    s_cmp_eq_u32 s64, 20
    s_cbranch_scc1 m_eb139
    s_cmp_eq_u32 s64, 24
    s_cbranch_scc1 m_eb140
m_e134:
    s_cbranch_vccnz m_rc142
m_sp127:
    s_cmp_lg_u32 s64, s72
    s_cbranch_scc1 m_single123
m_singlex124:
    s_bfe_u32 s95, s2, 0x10002
    s_and_b32 s90, s2, 7
    s_bitcmp1_b32 0x63, s90
    s_cselect_b32 s96, s33, s34
    s_sub_u32 s96, s96, 1
    s_and_b32 s90, s2, 1
    s_lshl_b32 s90, s90, 2
    s_bfe_u32 s91, s2, 0x20003
    s_add_u32 s97, s90, s91
    v_and_b32 v10, 31, v1
    v_lshlrev_b32 v10, 3, v10
    s_lshl_b32 s52, s96, 8
    s_add_u32 s52, s52, 117448704
    buffer_load_dwordx2 v[4:5], v10, s[8:11], s52 offen sc1
    ds_read_b128 a[224:227], v6 offset:16384
    ds_read_b128 a[228:231], v6 offset:17408
    ds_read_b128 a[232:235], v6 offset:18432
    ds_read_b128 a[236:239], v6 offset:19456
    ds_read_b128 a[240:243], v6 offset:20480
    ds_read_b128 a[244:247], v6 offset:21504
    ds_read_b128 a[248:251], v6 offset:22528
    ds_read_b128 a[252:255], v6 offset:23552
    s_waitcnt lgkmcnt(0)
    v_mfma_f32_16x16x32_bf16 a[0:3], a[224:227], v[128:131], a[0:3]
    buffer_load_dwordx4 v[192:195], v2, s[8:11], s83 offen offset:0 sc1
    v_exp_f32 v20, v96
    v_mfma_f32_16x16x32_bf16 a[32:35], a[224:227], v[132:135], a[32:35]
    v_exp_f32 v21, v97
    v_exp_f32 v22, v98
    v_mfma_f32_16x16x32_bf16 a[36:39], a[228:231], v[132:135], a[36:39]
    buffer_load_dwordx4 v[196:199], v2, s[8:11], s83 offen offset:1024 sc1
    v_cvt_pk_bf16_f32 v144, v20, v21
    v_add_f32 v12, v12, v28
    v_mfma_f32_16x16x32_bf16 a[4:7], a[228:231], v[128:131], a[4:7]
    v_exp_f32 v23, v99
    v_exp_f32 v24, v100
    v_cvt_pk_bf16_f32 v145, v22, v23
    v_mfma_f32_16x16x32_bf16 a[8:11], a[232:235], v[128:131], a[8:11]
    buffer_load_dwordx4 v[200:203], v2, s[8:11], s83 offen offset:2048 sc1
    v_exp_f32 v25, v101
    v_mfma_f32_16x16x32_bf16 a[40:43], a[232:235], v[132:135], a[40:43]
    v_exp_f32 v26, v102
    v_cvt_pk_bf16_f32 v146, v24, v25
    v_add_f32 v13, v13, v32
    v_mfma_f32_16x16x32_bf16 a[44:47], a[236:239], v[132:135], a[44:47]
    buffer_load_dwordx4 v[204:207], v2, s[8:11], s83 offen offset:3072 sc1
    v_exp_f32 v27, v103
    v_mfma_f32_16x16x32_bf16 a[12:15], a[236:239], v[128:131], a[12:15]
    v_exp_f32 v20, v104
    v_cvt_pk_bf16_f32 v147, v26, v27
    v_mfma_f32_16x16x32_bf16 a[16:19], a[240:243], v[128:131], a[16:19]
    buffer_load_dwordx4 v[212:215], v2, s[8:11], s84 offen offset:0 sc1
    v_exp_f32 v21, v105
    v_mfma_f32_16x16x32_bf16 v[28:31], v[44:47], v[144:147], 0
    v_exp_f32 v22, v106
    v_cvt_pk_bf16_f32 v148, v20, v21
    v_exp_f32 v23, v107
    v_mfma_f32_16x16x32_bf16 a[48:51], a[240:243], v[132:135], a[48:51]
    v_exp_f32 v24, v108
    v_cvt_pk_bf16_f32 v149, v22, v23
    v_exp_f32 v25, v109
    v_mfma_f32_16x16x32_bf16 a[52:55], a[244:247], v[132:135], a[52:55]
    buffer_load_dwordx4 v[216:219], v2, s[8:11], s84 offen offset:1024 sc1
    v_exp_f32 v26, v110
    v_mfma_f32_16x16x32_bf16 a[20:23], a[244:247], v[128:131], a[20:23]
    v_cvt_pk_bf16_f32 v150, v24, v25
    v_exp_f32 v27, v111
    s_nop 0
    v_cvt_pk_bf16_f32 v151, v26, v27
    s_nop 1
    v_mfma_f32_16x16x32_bf16 v[32:35], v[44:47], v[148:151], 0
    s_nop 2
    v_mfma_f32_16x16x32_bf16 a[24:27], a[248:251], v[128:131], a[24:27]
    buffer_load_dwordx4 v[220:223], v2, s[8:11], s84 offen offset:2048 sc1
    v_mfma_f32_16x16x32_bf16 a[56:59], a[248:251], v[132:135], a[56:59]
    s_nop 2
    v_mfma_f32_16x16x32_bf16 a[60:63], a[252:255], v[132:135], a[60:63]
    v_max_f32 v8, v28, v32
    v_cmp_nge_f32 vcc, s65, v8
    v_mfma_f32_16x16x32_bf16 a[28:31], a[252:255], v[128:131], a[28:31]
    s_cbranch_vccnz m_stub143
m_ret144:
    s_nop 1
    s_cmp_ge_u32 s16, 2
    s_cbranch_scc1 m_xb145
    s_waitcnt vmcnt(24)
    s_barrier
m_xb145:
    ds_read_b128 a[224:227], v6 offset:24576
    ds_read_b128 a[228:231], v6 offset:25600
    ds_read_b128 a[232:235], v6 offset:26624
    ds_read_b128 a[236:239], v6 offset:27648
    ds_read_b128 a[240:243], v6 offset:28672
    ds_read_b128 a[244:247], v6 offset:29696
    ds_read_b128 a[248:251], v6 offset:30720
    ds_read_b128 a[252:255], v6 offset:31744
    s_waitcnt lgkmcnt(0)
    v_mfma_f32_16x16x32_bf16 a[0:3], a[224:227], v[144:147], a[0:3]
    buffer_load_dwordx4 v[224:227], v2, s[8:11], s84 offen offset:3072 sc1
    v_mfma_f32_16x16x32_bf16 a[32:35], a[224:227], v[148:151], a[32:35]
    v_mfma_f32_16x16x32_bf16 a[36:39], a[228:231], v[148:151], a[36:39]
    buffer_load_dwordx4 v[208:211], v2, s[8:11], s85 offen offset:0 sc1
    v_mfma_f32_16x16x32_bf16 a[4:7], a[228:231], v[144:147], a[4:7]
    v_mfma_f32_16x16x32_bf16 a[8:11], a[232:235], v[144:147], a[8:11]
    buffer_load_dwordx4 v[232:235], v2, s[8:11], s86 offen offset:0 sc1
    v_mfma_f32_16x16x32_bf16 a[40:43], a[232:235], v[148:151], a[40:43]
    v_mfma_f32_16x16x32_bf16 a[44:47], a[236:239], v[148:151], a[44:47]
    buffer_load_dwordx4 v[236:239], v2, s[8:11], s86 offen offset:1024 sc1
    v_mfma_f32_16x16x32_bf16 a[12:15], a[236:239], v[144:147], a[12:15]
    v_mfma_f32_16x16x32_bf16 a[16:19], a[240:243], v[144:147], a[16:19]
    buffer_load_dwordx4 v[228:231], v2, s[8:11], s87 offen offset:0 sc1
    v_mfma_f32_16x16x32_bf16 a[48:51], a[240:243], v[148:151], a[48:51]
    v_mfma_f32_16x16x32_bf16 a[52:55], a[244:247], v[148:151], a[52:55]
    buffer_load_dwordx4 v[244:247], v2, s[8:11], s88 offen offset:0 sc1
    v_mfma_f32_16x16x32_bf16 a[20:23], a[244:247], v[144:147], a[20:23]
    v_mfma_f32_16x16x32_bf16 a[24:27], a[248:251], v[144:147], a[24:27]
    buffer_load_dwordx4 v[248:251], v2, s[8:11], s88 offen offset:1024 sc1
    v_mfma_f32_16x16x32_bf16 a[56:59], a[248:251], v[148:151], a[56:59]
    v_mfma_f32_16x16x32_bf16 a[60:63], a[252:255], v[148:151], a[60:63]
    buffer_load_dwordx4 v[240:243], v2, s[8:11], s89 offen offset:0 sc1
    v_mfma_f32_16x16x32_bf16 a[28:31], a[252:255], v[144:147], a[28:31]
    v_add_f32 v20, v12, v28
    v_add_f32 v21, v13, v32
    s_nop 3
    v_rcp_f32 v22, v21
    v_rcp_f32 v20, v20
    s_lshl_b32 s90, s78, 10
    s_add_u32 s90, s90, s82
    s_add_u32 s90, s90, 67108864
    v_accvgpr_read_b32 v48, a0
    v_accvgpr_read_b32 v49, a1
    v_accvgpr_read_b32 v50, a2
    v_accvgpr_read_b32 v51, a3
    v_accvgpr_read_b32 v52, a4
    v_accvgpr_read_b32 v53, a5
    v_accvgpr_read_b32 v54, a6
    v_accvgpr_read_b32 v55, a7
    v_pk_mul_f32 v[48:49], v[48:49], v[20:21] op_sel_hi:[1,0]
    v_pk_mul_f32 v[50:51], v[50:51], v[20:21] op_sel_hi:[1,0]
    v_pk_mul_f32 v[52:53], v[52:53], v[20:21] op_sel_hi:[1,0]
    v_pk_mul_f32 v[54:55], v[54:55], v[20:21] op_sel_hi:[1,0]
    v_cvt_pk_bf16_f32 v48, v48, v49
    v_cvt_pk_bf16_f32 v49, v50, v51
    v_cvt_pk_bf16_f32 v50, v52, v53
    v_cvt_pk_bf16_f32 v51, v54, v55
    buffer_store_dwordx4 v[48:51], v2, s[8:11], s90 offen offset:0 sc1
    v_accvgpr_read_b32 v56, a32
    v_accvgpr_read_b32 v57, a33
    v_accvgpr_read_b32 v58, a34
    v_accvgpr_read_b32 v59, a35
    v_accvgpr_read_b32 v60, a36
    v_accvgpr_read_b32 v61, a37
    v_accvgpr_read_b32 v62, a38
    v_accvgpr_read_b32 v63, a39
    v_pk_mul_f32 v[56:57], v[56:57], v[22:23] op_sel_hi:[1,0]
    v_pk_mul_f32 v[58:59], v[58:59], v[22:23] op_sel_hi:[1,0]
    v_pk_mul_f32 v[60:61], v[60:61], v[22:23] op_sel_hi:[1,0]
    v_pk_mul_f32 v[62:63], v[62:63], v[22:23] op_sel_hi:[1,0]
    v_cvt_pk_bf16_f32 v56, v56, v57
    v_cvt_pk_bf16_f32 v57, v58, v59
    v_cvt_pk_bf16_f32 v58, v60, v61
    v_cvt_pk_bf16_f32 v59, v62, v63
    buffer_store_dwordx4 v[56:59], v2, s[8:11], s90 offen offset:1024 sc1
    s_add_u32 s90, s90, 131072
    v_accvgpr_read_b32 v48, a8
    v_accvgpr_read_b32 v49, a9
    v_accvgpr_read_b32 v50, a10
    v_accvgpr_read_b32 v51, a11
    v_accvgpr_read_b32 v52, a12
    v_accvgpr_read_b32 v53, a13
    v_accvgpr_read_b32 v54, a14
    v_accvgpr_read_b32 v55, a15
    v_pk_mul_f32 v[48:49], v[48:49], v[20:21] op_sel_hi:[1,0]
    v_pk_mul_f32 v[50:51], v[50:51], v[20:21] op_sel_hi:[1,0]
    v_pk_mul_f32 v[52:53], v[52:53], v[20:21] op_sel_hi:[1,0]
    v_pk_mul_f32 v[54:55], v[54:55], v[20:21] op_sel_hi:[1,0]
    v_cvt_pk_bf16_f32 v48, v48, v49
    v_cvt_pk_bf16_f32 v49, v50, v51
    v_cvt_pk_bf16_f32 v50, v52, v53
    v_cvt_pk_bf16_f32 v51, v54, v55
    buffer_store_dwordx4 v[48:51], v2, s[8:11], s90 offen offset:0 sc1
    v_accvgpr_read_b32 v56, a40
    v_accvgpr_read_b32 v57, a41
    v_accvgpr_read_b32 v58, a42
    v_accvgpr_read_b32 v59, a43
    v_accvgpr_read_b32 v60, a44
    v_accvgpr_read_b32 v61, a45
    v_accvgpr_read_b32 v62, a46
    v_accvgpr_read_b32 v63, a47
    v_pk_mul_f32 v[56:57], v[56:57], v[22:23] op_sel_hi:[1,0]
    v_pk_mul_f32 v[58:59], v[58:59], v[22:23] op_sel_hi:[1,0]
    v_pk_mul_f32 v[60:61], v[60:61], v[22:23] op_sel_hi:[1,0]
    v_pk_mul_f32 v[62:63], v[62:63], v[22:23] op_sel_hi:[1,0]
    v_cvt_pk_bf16_f32 v56, v56, v57
    v_cvt_pk_bf16_f32 v57, v58, v59
    v_cvt_pk_bf16_f32 v58, v60, v61
    v_cvt_pk_bf16_f32 v59, v62, v63
    buffer_store_dwordx4 v[56:59], v2, s[8:11], s90 offen offset:1024 sc1
    s_add_u32 s90, s90, 131072
    v_accvgpr_read_b32 v48, a16
    v_accvgpr_read_b32 v49, a17
    v_accvgpr_read_b32 v50, a18
    v_accvgpr_read_b32 v51, a19
    v_accvgpr_read_b32 v52, a20
    v_accvgpr_read_b32 v53, a21
    v_accvgpr_read_b32 v54, a22
    v_accvgpr_read_b32 v55, a23
    v_pk_mul_f32 v[48:49], v[48:49], v[20:21] op_sel_hi:[1,0]
    v_pk_mul_f32 v[50:51], v[50:51], v[20:21] op_sel_hi:[1,0]
    v_pk_mul_f32 v[52:53], v[52:53], v[20:21] op_sel_hi:[1,0]
    v_pk_mul_f32 v[54:55], v[54:55], v[20:21] op_sel_hi:[1,0]
    v_cvt_pk_bf16_f32 v48, v48, v49
    v_cvt_pk_bf16_f32 v49, v50, v51
    v_cvt_pk_bf16_f32 v50, v52, v53
    v_cvt_pk_bf16_f32 v51, v54, v55
    buffer_store_dwordx4 v[48:51], v2, s[8:11], s90 offen offset:0 sc1
    v_accvgpr_read_b32 v56, a48
    v_accvgpr_read_b32 v57, a49
    v_accvgpr_read_b32 v58, a50
    v_accvgpr_read_b32 v59, a51
    v_accvgpr_read_b32 v60, a52
    v_accvgpr_read_b32 v61, a53
    v_accvgpr_read_b32 v62, a54
    v_accvgpr_read_b32 v63, a55
    v_pk_mul_f32 v[56:57], v[56:57], v[22:23] op_sel_hi:[1,0]
    v_pk_mul_f32 v[58:59], v[58:59], v[22:23] op_sel_hi:[1,0]
    v_pk_mul_f32 v[60:61], v[60:61], v[22:23] op_sel_hi:[1,0]
    v_pk_mul_f32 v[62:63], v[62:63], v[22:23] op_sel_hi:[1,0]
    v_cvt_pk_bf16_f32 v56, v56, v57
    v_cvt_pk_bf16_f32 v57, v58, v59
    v_cvt_pk_bf16_f32 v58, v60, v61
    v_cvt_pk_bf16_f32 v59, v62, v63
    buffer_store_dwordx4 v[56:59], v2, s[8:11], s90 offen offset:1024 sc1
    s_add_u32 s90, s90, 131072
    v_accvgpr_read_b32 v48, a24
    v_accvgpr_read_b32 v49, a25
    v_accvgpr_read_b32 v50, a26
    v_accvgpr_read_b32 v51, a27
    v_accvgpr_read_b32 v52, a28
    v_accvgpr_read_b32 v53, a29
    v_accvgpr_read_b32 v54, a30
    v_accvgpr_read_b32 v55, a31
    v_pk_mul_f32 v[48:49], v[48:49], v[20:21] op_sel_hi:[1,0]
    v_pk_mul_f32 v[50:51], v[50:51], v[20:21] op_sel_hi:[1,0]
    v_pk_mul_f32 v[52:53], v[52:53], v[20:21] op_sel_hi:[1,0]
    v_pk_mul_f32 v[54:55], v[54:55], v[20:21] op_sel_hi:[1,0]
    v_cvt_pk_bf16_f32 v48, v48, v49
    v_cvt_pk_bf16_f32 v49, v50, v51
    v_cvt_pk_bf16_f32 v50, v52, v53
    v_cvt_pk_bf16_f32 v51, v54, v55
    buffer_store_dwordx4 v[48:51], v2, s[8:11], s90 offen offset:0 sc1
    v_accvgpr_read_b32 v56, a56
    v_accvgpr_read_b32 v57, a57
    v_accvgpr_read_b32 v58, a58
    v_accvgpr_read_b32 v59, a59
    v_accvgpr_read_b32 v60, a60
    v_accvgpr_read_b32 v61, a61
    v_accvgpr_read_b32 v62, a62
    v_accvgpr_read_b32 v63, a63
    v_pk_mul_f32 v[56:57], v[56:57], v[22:23] op_sel_hi:[1,0]
    v_pk_mul_f32 v[58:59], v[58:59], v[22:23] op_sel_hi:[1,0]
    v_pk_mul_f32 v[60:61], v[60:61], v[22:23] op_sel_hi:[1,0]
    v_pk_mul_f32 v[62:63], v[62:63], v[22:23] op_sel_hi:[1,0]
    v_cvt_pk_bf16_f32 v56, v56, v57
    v_cvt_pk_bf16_f32 v57, v58, v59
    v_cvt_pk_bf16_f32 v58, v60, v61
    v_cvt_pk_bf16_f32 v59, v62, v63
    buffer_store_dwordx4 v[56:59], v2, s[8:11], s90 offen offset:1024 sc1
    s_add_u32 s90, s90, 131072
    s_lshr_b32 s53, s16, 1
    s_and_b32 s40, s16, 1
    s_mul_i32 s90, s95, 5242880
    s_lshl_b32 s57, s97, 8
    s_add_u32 s57, s57, s90
    v_lshrrev_b32 v20, 4, v1
    s_lshl_b32 s90, s16, 4
    v_add_u32 v21, s90, v20
    v_lshlrev_b32 v21, 11, v21
    v_lshlrev_b32 v20, 1, v20
    v_and_b32 v22, 15, v1
    v_xor_b32 v20, v20, v22
    v_xor_b32 v22, 0, v20
    v_lshl_add_u32 v16, v22, 4, v21
    v_xor_b32 v22, 8, v20
    v_lshl_add_u32 v17, v22, 4, v21
    v_add_u32 v17, 7168, v17
    v_xor_b32 v22, 0, v20
    v_lshl_add_u32 v18, v22, 4, v21
    v_add_u32 v18, 14336, v18
    v_xor_b32 v22, 8, v20
    v_lshl_add_u32 v19, v22, 4, v21
    v_add_u32 v19, 21504, v19
    s_mov_b32 s24, s48
    s_mov_b32 s25, s49
    s_mov_b32 s26, 8388608
    s_mov_b32 s38, 268435456
    s_mov_b32 s28, s54
    s_mov_b32 s29, s55
    s_mov_b32 s30, 8388608
    s_lshl_b32 s90, s96, 13
    s_lshl_b32 s91, s40, 12
    s_add_u32 s90, s90, s91
    s_lshl_b32 s91, s53, 17
    s_add_u32 s69, s90, s91
    s_mul_i32 s90, s95, 10485760
    s_add_u32 s56, s69, s90
    s_add_u32 s56, s56, 67108864
    s_add_u32 s69, s69, 83886080
    s_lshl_b32 s90, s53, 12
    v_add_u32 v6, s90, v2
    v_lshrrev_b32 v48, 2, v1
    v_lshlrev_b32 v48, 8, v48
    v_and_b32 v49, 3, v1
    v_lshl_add_u32 v48, v49, 3, v48
    v_add_u32 v48, 16384, v48
    v_bfe_u32 v49, v1, 2, 3
    s_lshl_b32 s90, s40, 2
    v_xor_b32 v49, s90, v49
    v_xor_b32 v50, 0, v49
    v_lshl_add_u32 v12, v50, 5, v48
    v_xor_b32 v50, 1, v49
    v_lshl_add_u32 v13, v50, 5, v48
    v_xor_b32 v50, 2, v49
    v_lshl_add_u32 v14, v50, 5, v48
    v_xor_b32 v50, 3, v49
    v_lshl_add_u32 v15, v50, 5, v48
    v_and_b32 v48, 15, v1
    v_lshlrev_b32 v48, 12, v48
    v_lshlrev_b32 v48, s95, v48
    v_bfe_u32 v49, v1, 4, 1
    v_lshl_add_u32 v48, v49, 5, v48
    v_lshrrev_b32 v49, 5, v1
    v_lshl_add_u32 v7, v49, 4, v48
    s_lshl_b32 s90, s96, 3
    s_lshl_b32 s91, s53, 2
    s_add_u32 s90, s90, s91
    s_lshl_b32 s91, s90, 16
    s_add_u32 s91, s91, 2048
    s_and_b32 s92, s90, 63
    s_lshl_b32 s92, s92, 17
    s_lshr_b32 s93, s90, 6
    s_lshl_b32 s93, s93, 12
    s_add_u32 s92, s92, s93
    s_cmp_eq_u32 s95, 1
    s_cselect_b32 s71, s92, s91
    s_lshl_b32 s72, 0x10000, s95
    s_lshl_b32 s92, s97, 8
    s_lshl_b32 s93, s40, 7
    s_add_u32 s71, s71, s92
    s_add_u32 s71, s71, s93
    v_mov_b64 v[64:65], 0
    v_mov_b64 v[66:67], 0
    v_mov_b64 v[68:69], 0
    v_mov_b64 v[70:71], 0
    v_mov_b64 v[72:73], 0
    v_mov_b64 v[74:75], 0
    v_mov_b64 v[76:77], 0
    v_mov_b64 v[78:79], 0
    v_mov_b64 v[80:81], 0
    v_mov_b64 v[82:83], 0
    v_mov_b64 v[84:85], 0
    v_mov_b64 v[86:87], 0
    v_mov_b64 v[88:89], 0
    v_mov_b64 v[90:91], 0
    v_mov_b64 v[92:93], 0
    v_mov_b64 v[94:95], 0
    v_mov_b64 v[96:97], 0
    v_mov_b64 v[98:99], 0
    v_mov_b64 v[100:101], 0
    v_mov_b64 v[102:103], 0
    v_mov_b64 v[104:105], 0
    v_mov_b64 v[106:107], 0
    v_mov_b64 v[108:109], 0
    v_mov_b64 v[110:111], 0
    v_mov_b64 v[112:113], 0
    v_mov_b64 v[114:115], 0
    v_mov_b64 v[116:117], 0
    v_mov_b64 v[118:119], 0
    v_mov_b64 v[120:121], 0
    v_mov_b64 v[122:123], 0
    v_mov_b64 v[124:125], 0
    v_mov_b64 v[126:127], 0
    v_and_b32 v48, 15, v1
    v_lshrrev_b32 v49, 4, v1
    v_lshlrev_b32 v49, 2, v49
    v_sub_u32 v48, v48, v49
    v_cmp_ge_i32 vcc, -9, v48
    v_subrev_u32 v50, 0, v48
    v_cmp_ge_u32 s[76:77], 7, v50
    s_nop 0
    v_cndmask_b32 v128, v9, 0, vcc
    v_cndmask_b32 v132, v9, 0, s[76:77]
    v_cmp_ge_i32 vcc, -8, v48
    v_subrev_u32 v50, 1, v48
    v_cmp_ge_u32 s[76:77], 7, v50
    s_nop 0
    v_cndmask_b32 v129, v9, 0, vcc
    v_cndmask_b32 v133, v9, 0, s[76:77]
    v_cmp_ge_i32 vcc, -7, v48
    v_subrev_u32 v50, 2, v48
    v_cmp_ge_u32 s[76:77], 7, v50
    s_nop 0
    v_cndmask_b32 v130, v9, 0, vcc
    v_cndmask_b32 v134, v9, 0, s[76:77]
    v_cmp_ge_i32 vcc, -6, v48
    v_subrev_u32 v50, 3, v48
    v_cmp_ge_u32 s[76:77], 7, v50
    s_nop 0
    v_cndmask_b32 v131, v9, 0, vcc
    v_cndmask_b32 v135, v9, 0, s[76:77]
    s_cmp_eq_u32 s81, 0
    s_cselect_b64 vcc, -1, 0
    s_nop 0
    v_cndmask_b32 v136, v128, v9, vcc
    v_cndmask_b32 v137, v129, v9, vcc
    v_cndmask_b32 v138, v130, v9, vcc
    v_cndmask_b32 v139, v131, v9, vcc
    s_lshl_b32 s90, s80, 10
    s_lshr_b32 s91, s2, 3
    s_lshl_b32 s91, s91, 17
    s_add_u32 s90, s90, s91
    s_add_u32 s80, s90, 83886080
    s_add_u32 s59, s60, 131072
    s_mov_b32 s58, 0
    s_mov_b32 s100, 32768
    s_mov_b32 s64, 0
    s_mov_b32 s67, 0
    s_waitcnt vmcnt(0)
    s_barrier
    s_lshl_b32 s91, s33, 5
    s_add_u32 s91, s91, s32
    s_lshl_b32 s91, s91, 3
    s_add_u32 s91, s91, 7936
    s_cmp_lg_u32 s16, 0
    s_cbranch_scc1 m_np146
    v_mov_b32 v60, s4
    v_mov_b32 v61, s5
    s_add_u32 s90, s91, 117440512
    s_mov_b64 exec, 1
    buffer_store_dwordx2 v[60:61], off, s[8:11], s90 sc1
    s_mov_b64 exec, -1
m_np146:
    s_cmp_eq_u32 s101, -1
    s_cbranch_scc1 m_pb147
    s_cmp_lg_u32 s16, 0
    s_cbranch_scc1 m_np149
    v_mov_b32 v60, s4
    v_mov_b32 v61, s5
    s_add_u32 s90, s101, 117440512
    s_mov_b64 exec, 1
    buffer_store_dwordx2 v[60:61], off, s[8:11], s90 sc1
    s_mov_b64 exec, -1
m_np149:
m_pb147:
    v_cmp_ne_u64 s[76:77], s[4:5], v[4:5]
    s_mul_i32 s91, s95, 20
    s_nop 2
    s_lshr_b32 s90, s76, s91
    s_ff1_i32_b32 s90, s90
    s_lshl_b32 s68, s90, 1
    s_mul_i32 s91, s95, 0
    s_sub_i32 s68, s68, s91
    s_cmp_lt_i32 s90, 0
    s_cselect_b32 s68, 1000, s68
    s_add_u32 m0, s60, 16384
    s_nop 0
    buffer_load_dwordx4 v16, s[24:27], s57 offen offset:0 sc1 lds
    buffer_load_dwordx4 v17, s[24:27], s57 offen offset:1024 sc1 lds
    buffer_load_dwordx4 v18, s[24:27], s57 offen offset:2048 sc1 lds
    buffer_load_dwordx4 v19, s[24:27], s57 offen offset:3072 sc1 lds
    s_add_u32 s57, s57, 131072
    s_add_u32 m0, s60, 49152
    s_nop 0
    buffer_load_dwordx4 v16, s[24:27], s57 offen offset:0 sc1 lds
    buffer_load_dwordx4 v17, s[24:27], s57 offen offset:1024 sc1 lds
    buffer_load_dwordx4 v18, s[24:27], s57 offen offset:2048 sc1 lds
    buffer_load_dwordx4 v19, s[24:27], s57 offen offset:3072 sc1 lds
    s_add_u32 s57, s57, 131072
    s_add_u32 m0, s60, 81920
    s_nop 0
    buffer_load_dwordx4 v16, s[24:27], s57 offen offset:0 sc1 lds
    buffer_load_dwordx4 v17, s[24:27], s57 offen offset:1024 sc1 lds
    buffer_load_dwordx4 v18, s[24:27], s57 offen offset:2048 sc1 lds
    buffer_load_dwordx4 v19, s[24:27], s57 offen offset:3072 sc1 lds
    s_add_u32 s57, s57, 131072
    s_add_u32 m0, s60, 114688
    s_nop 0
    buffer_load_dwordx4 v16, s[24:27], s57 offen offset:0 sc1 lds
    buffer_load_dwordx4 v17, s[24:27], s57 offen offset:1024 sc1 lds
    buffer_load_dwordx4 v18, s[24:27], s57 offen offset:2048 sc1 lds
    buffer_load_dwordx4 v19, s[24:27], s57 offen offset:3072 sc1 lds
    s_add_u32 s57, s57, 131072
    s_cmp_gt_i32 s68, 4
    s_cbranch_scc1 m_x3148
    s_mov_b32 s3, 262144
m_spin150:
    buffer_load_dwordx2 v[4:5], v10, s[8:11], s52 offen sc1
    s_waitcnt vmcnt(0)
    v_cmp_ne_u64 s[76:77], s[4:5], v[4:5]
    s_mul_i32 s91, s95, 20
    s_nop 2
    s_lshr_b32 s90, s76, s91
    s_ff1_i32_b32 s90, s90
    s_lshl_b32 s68, s90, 1
    s_mul_i32 s91, s95, 0
    s_sub_i32 s68, s68, s91
    s_cmp_lt_i32 s90, 0
    s_cselect_b32 s68, 1000, s68
    s_cmp_gt_i32 s68, 4
    s_cbranch_scc1 m_ok151
    s_sub_u32 s3, s3, 1
    s_cbranch_scc1 m_ok151
    s_sleep 4
    s_branch m_spin150
m_ok151:
m_x3148:
    s_add_u32 m0, s60, 0
    s_nop 0
    buffer_load_dwordx4 v2, s[36:39], s56 offen offset:0 sc1 lds
    buffer_load_dwordx4 v2, s[36:39], s56 offen offset:1024 sc1 lds
    buffer_load_dwordx4 v2, s[36:39], s56 offen offset:2048 sc1 lds
    buffer_load_dwordx4 v2, s[36:39], s56 offen offset:3072 sc1 lds
    s_add_u32 s56, s56, 262144
    s_add_u32 m0, s60, 32768
    s_nop 0
    buffer_load_dwordx4 v2, s[36:39], s56 offen offset:0 sc1 lds
    buffer_load_dwordx4 v2, s[36:39], s56 offen offset:1024 sc1 lds
    buffer_load_dwordx4 v2, s[36:39], s56 offen offset:2048 sc1 lds
    buffer_load_dwordx4 v2, s[36:39], s56 offen offset:3072 sc1 lds
    s_add_u32 s56, s56, 262144
    s_add_u32 m0, s60, 65536
    s_nop 0
    buffer_load_dwordx4 v2, s[36:39], s56 offen offset:0 sc1 lds
    buffer_load_dwordx4 v2, s[36:39], s56 offen offset:1024 sc1 lds
    buffer_load_dwordx4 v2, s[36:39], s56 offen offset:2048 sc1 lds
    buffer_load_dwordx4 v2, s[36:39], s56 offen offset:3072 sc1 lds
    s_add_u32 s56, s56, 262144
    s_add_u32 m0, s60, 98304
    s_nop 0
    buffer_load_dwordx4 v2, s[36:39], s56 offen offset:0 sc1 lds
    buffer_load_dwordx4 v2, s[36:39], s56 offen offset:1024 sc1 lds
    buffer_load_dwordx4 v2, s[36:39], s56 offen offset:2048 sc1 lds
    buffer_load_dwordx4 v2, s[36:39], s56 offen offset:3072 sc1 lds
    s_add_u32 s56, s56, 262144
    s_add_u32 m0, s60, 131072
    s_nop 0
    buffer_load_dwordx4 v2, s[36:39], s56 offen offset:0 sc1 lds
    buffer_load_dwordx4 v2, s[36:39], s56 offen offset:1024 sc1 lds
    buffer_load_dwordx4 v2, s[36:39], s56 offen offset:2048 sc1 lds
    buffer_load_dwordx4 v2, s[36:39], s56 offen offset:3072 sc1 lds
    s_add_u32 s56, s56, 262144
    s_waitcnt vmcnt(16)
    s_barrier
    ds_read_b128 a[0:3], v6 offset:0
    ds_read_b64_tr_b16 a[16:17], v12 offset:0
    ds_read_b64_tr_b16 a[18:19], v12 offset:4096
    ds_read_b128 a[4:7], v6 offset:1024
    ds_read_b128 a[8:11], v6 offset:2048
    ds_read_b128 a[12:15], v6 offset:3072
    ds_read_b64_tr_b16 a[20:21], v13 offset:0
    ds_read_b64_tr_b16 a[22:23], v13 offset:4096
    ds_read_b64_tr_b16 a[24:25], v14 offset:0
    ds_read_b64_tr_b16 a[26:27], v14 offset:4096
    ds_read_b64_tr_b16 a[28:29], v15 offset:0
    ds_read_b64_tr_b16 a[30:31], v15 offset:4096
    s_cmp_gt_i32 s68, 5
    s_cbranch_scc0 m_lp157
m_lr158:
    s_waitcnt lgkmcnt(9)
    v_mfma_f32_16x16x32_bf16 v[64:67], a[16:19], a[0:3], v[64:67]
    s_add_u32 m0, s59, 16384
    ds_read_b128 a[32:35], v6 offset:8192
    v_mfma_f32_16x16x32_bf16 v[148:151], v[208:211], v[192:195], v[136:139]
    v_mfma_f32_16x16x32_bf16 v[152:155], v[212:215], v[192:195], v[132:135]
    s_waitcnt lgkmcnt(9)
    v_mfma_f32_16x16x32_bf16 v[72:75], a[16:19], a[4:7], v[72:75]
    ds_read_b64_tr_b16 a[48:49], v12 offset:8192
    buffer_load_dwordx4 v16, s[24:27], s57 offen offset:0 sc1 lds
    v_mfma_f32_16x16x32_bf16 v[156:159], v[212:215], v[196:199], v[128:131]
    s_waitcnt lgkmcnt(9)
    v_mfma_f32_16x16x32_bf16 v[80:83], a[16:19], a[8:11], v[80:83]
    s_add_u32 s59, s58, s60
    ds_read_b64_tr_b16 a[50:51], v12 offset:12288
    v_mfma_f32_16x16x32_bf16 v[160:163], v[216:219], v[196:199], v[132:135]
    v_mfma_f32_16x16x32_bf16 v[164:167], v[216:219], v[200:203], v[128:131]
    s_waitcnt lgkmcnt(9)
    v_mfma_f32_16x16x32_bf16 v[88:91], a[16:19], a[12:15], v[88:91]
    s_add_u32 s58, s58, 32768
    ds_read_b128 a[36:39], v6 offset:9216
    v_mfma_f32_16x16x32_bf16 v[168:171], v[220:223], v[200:203], v[132:135]
    v_mfma_f32_16x16x32_bf16 v[172:175], v[220:223], v[204:207], v[128:131]
    s_waitcnt lgkmcnt(8)
    v_mfma_f32_16x16x32_bf16 v[68:71], a[20:23], a[0:3], v[68:71]
    s_cmp_ge_u32 s58, 163840
    ds_read_b128 a[40:43], v6 offset:10240
    v_mfma_f32_16x16x32_bf16 v[176:179], v[224:227], v[204:207], v[132:135]
    s_nop 1
    v_mfma_f32_16x16x32_bf16 v[76:79], a[20:23], a[4:7], v[76:79]
    ds_read_b128 a[44:47], v6 offset:11264
    buffer_load_dwordx4 v17, s[24:27], s57 offen offset:1024 sc1 lds
    s_nop 1
    v_mfma_f32_16x16x32_bf16 v[84:87], a[20:23], a[8:11], v[84:87]
    s_cselect_b32 s66, 4294836224, s100
    ds_read_b64_tr_b16 a[52:53], v13 offset:8192
    s_nop 1
    s_nop 1
    v_mfma_f32_16x16x32_bf16 v[92:95], a[20:23], a[12:15], v[92:95]
    s_cselect_b32 s58, 0, s58
    ds_read_b64_tr_b16 a[54:55], v13 offset:12288
    v_max3_f32 v140, v148, v149, v150
    v_max3_f32 v141, v156, v157, v158
    s_waitcnt lgkmcnt(10)
    v_mfma_f32_16x16x32_bf16 v[96:99], a[24:27], a[0:3], v[96:99]
    ds_read_b64_tr_b16 a[56:57], v14 offset:8192
    v_max3_f32 v142, v164, v165, v166
    v_max3_f32 v143, v172, v173, v174
    v_mfma_f32_16x16x32_bf16 v[104:107], a[24:27], a[4:7], v[104:107]
    ds_read_b64_tr_b16 a[58:59], v14 offset:12288
    buffer_load_dwordx4 v18, s[24:27], s57 offen offset:2048 sc1 lds
    v_max3_f32 v140, v140, v151, v152
    v_mfma_f32_16x16x32_bf16 v[112:115], a[24:27], a[8:11], v[112:115]
    ds_read_b64_tr_b16 a[60:61], v15 offset:8192
    v_max3_f32 v141, v141, v159, v160
    v_max3_f32 v142, v142, v167, v168
    v_mfma_f32_16x16x32_bf16 v[120:123], a[24:27], a[12:15], v[120:123]
    ds_read_b64_tr_b16 a[62:63], v15 offset:12288
    v_max3_f32 v143, v143, v175, v176
    v_max3_f32 v140, v140, v153, v154
    s_waitcnt lgkmcnt(12)
    v_mfma_f32_16x16x32_bf16 v[100:103], a[28:31], a[0:3], v[100:103]
    v_add_u32 v6, s66, v6
    v_add_u32 v12, s66, v12
    v_max3_f32 v141, v141, v161, v162
    v_mfma_f32_16x16x32_bf16 v[108:111], a[28:31], a[4:7], v[108:111]
    buffer_load_dwordx4 v19, s[24:27], s57 offen offset:3072 sc1 lds
    v_max3_f32 v142, v142, v169, v170
    v_mfma_f32_16x16x32_bf16 v[116:119], a[28:31], a[8:11], v[116:119]
    s_add_u32 s57, s57, 131072
    v_add_u32 v13, s66, v13
    v_add_u32 v14, s66, v14
    v_max3_f32 v143, v143, v177, v178
    v_mfma_f32_16x16x32_bf16 v[124:127], a[28:31], a[12:15], v[124:127]
    s_mov_b32 m0, s59
    v_add_u32 v15, s66, v15
    v_max_f32 v140, v140, v155
    s_waitcnt vmcnt(16) lgkmcnt(0)
    v_mfma_f32_16x16x32_bf16 v[64:67], a[48:51], a[32:35], v[64:67]
    s_barrier
    v_max_f32 v141, v141, v163
    v_max_f32 v142, v142, v171
    v_mfma_f32_16x16x32_bf16 v[72:75], a[48:51], a[36:39], v[72:75]
    ds_read_b128 a[0:3], v6 offset:0
    buffer_load_dwordx4 v2, s[36:39], s56 offen offset:0 sc1 lds
    v_max_f32 v143, v143, v179
    v_mfma_f32_16x16x32_bf16 v[80:83], a[48:51], a[40:43], v[80:83]
    ds_read_b64_tr_b16 a[16:17], v12 offset:0
    v_mov_b32 v144, v140
    v_mov_b32 v145, v141
    v_mfma_f32_16x16x32_bf16 v[88:91], a[48:51], a[44:47], v[88:91]
    ds_read_b64_tr_b16 a[18:19], v12 offset:4096
    v_mov_b32 v146, v142
    v_mov_b32 v147, v143
    v_mfma_f32_16x16x32_bf16 v[68:71], a[52:55], a[32:35], v[68:71]
    ds_read_b128 a[4:7], v6 offset:1024
    s_nop 1
    v_permlane32_swap_b32 v140, v144
    v_mfma_f32_16x16x32_bf16 v[76:79], a[52:55], a[36:39], v[76:79]
    ds_read_b128 a[8:11], v6 offset:2048
    buffer_load_dwordx4 v2, s[36:39], s56 offen offset:1024 sc1 lds
    v_permlane32_swap_b32 v141, v145
    v_mfma_f32_16x16x32_bf16 v[84:87], a[52:55], a[40:43], v[84:87]
    ds_read_b128 a[12:15], v6 offset:3072
    v_permlane32_swap_b32 v142, v146
    v_permlane32_swap_b32 v143, v147
    v_mfma_f32_16x16x32_bf16 v[92:95], a[52:55], a[44:47], v[92:95]
    ds_read_b64_tr_b16 a[20:21], v13 offset:0
    s_nop 1
    v_max_f32 v140, v140, v144
    v_mfma_f32_16x16x32_bf16 v[96:99], a[56:59], a[32:35], v[96:99]
    ds_read_b64_tr_b16 a[22:23], v13 offset:4096
    v_max_f32 v141, v141, v145
    v_max_f32 v142, v142, v146
    v_mfma_f32_16x16x32_bf16 v[104:107], a[56:59], a[36:39], v[104:107]
    ds_read_b64_tr_b16 a[24:25], v14 offset:0
    buffer_load_dwordx4 v2, s[36:39], s56 offen offset:2048 sc1 lds
    v_max_f32 v143, v143, v147
    v_mfma_f32_16x16x32_bf16 v[112:115], a[56:59], a[40:43], v[112:115]
    ds_read_b64_tr_b16 a[26:27], v14 offset:4096
    v_mov_b32 v144, v140
    v_mov_b32 v145, v141
    v_mfma_f32_16x16x32_bf16 v[120:123], a[56:59], a[44:47], v[120:123]
    ds_read_b64_tr_b16 a[28:29], v15 offset:0
    v_mov_b32 v146, v142
    v_mov_b32 v147, v143
    v_mfma_f32_16x16x32_bf16 v[100:103], a[60:63], a[32:35], v[100:103]
    s_add_u32 s64, s64, 1
    ds_read_b64_tr_b16 a[30:31], v15 offset:4096
    s_nop 1
    v_permlane16_swap_b32 v140, v144
    v_mfma_f32_16x16x32_bf16 v[108:111], a[60:63], a[36:39], v[108:111]
    buffer_load_dwordx4 v2, s[36:39], s56 offen offset:3072 sc1 lds
    v_permlane16_swap_b32 v141, v145
    v_mfma_f32_16x16x32_bf16 v[116:119], a[60:63], a[40:43], v[116:119]
    s_add_u32 s56, s56, 262144
    v_permlane16_swap_b32 v142, v146
    v_permlane16_swap_b32 v143, v147
    v_mfma_f32_16x16x32_bf16 v[124:127], a[60:63], a[44:47], v[124:127]
    s_nop 1
    v_max_f32 v140, v140, v144
    s_cmp_gt_i32 s68, 6
    s_cbranch_scc0 m_lp159
m_lr160:
    s_waitcnt lgkmcnt(9)
    v_mfma_f32_16x16x32_bf16 v[64:67], a[16:19], a[0:3], v[64:67]
    s_add_u32 m0, s59, 16384
    ds_read_b128 a[32:35], v6 offset:8192
    v_max_f32 v141, v141, v145
    v_max_f32 v142, v142, v146
    s_waitcnt lgkmcnt(9)
    v_mfma_f32_16x16x32_bf16 v[72:75], a[16:19], a[4:7], v[72:75]
    ds_read_b64_tr_b16 a[48:49], v12 offset:8192
    buffer_load_dwordx4 v16, s[24:27], s57 offen offset:0 sc1 lds
    v_max_f32 v143, v143, v147
    s_waitcnt lgkmcnt(9)
    v_mfma_f32_16x16x32_bf16 v[80:83], a[16:19], a[8:11], v[80:83]
    s_add_u32 s59, s58, s60
    ds_read_b64_tr_b16 a[50:51], v12 offset:12288
    v_sub_f32 v148, v148, v140
    v_sub_f32 v149, v149, v140
    s_waitcnt lgkmcnt(9)
    v_mfma_f32_16x16x32_bf16 v[88:91], a[16:19], a[12:15], v[88:91]
    s_add_u32 s58, s58, 32768
    ds_read_b128 a[36:39], v6 offset:9216
    v_sub_f32 v150, v150, v140
    v_sub_f32 v151, v151, v140
    s_waitcnt lgkmcnt(8)
    v_mfma_f32_16x16x32_bf16 v[68:71], a[20:23], a[0:3], v[68:71]
    s_cmp_ge_u32 s58, 163840
    ds_read_b128 a[40:43], v6 offset:10240
    v_sub_f32 v152, v152, v140
    v_sub_f32 v153, v153, v140
    v_mfma_f32_16x16x32_bf16 v[76:79], a[20:23], a[4:7], v[76:79]
    ds_read_b128 a[44:47], v6 offset:11264
    buffer_load_dwordx4 v17, s[24:27], s57 offen offset:1024 sc1 lds
    v_sub_f32 v154, v154, v140
    v_mfma_f32_16x16x32_bf16 v[84:87], a[20:23], a[8:11], v[84:87]
    s_cselect_b32 s66, 4294836224, s100
    ds_read_b64_tr_b16 a[52:53], v13 offset:8192
    v_sub_f32 v155, v155, v140
    v_sub_f32 v156, v156, v141
    v_mfma_f32_16x16x32_bf16 v[92:95], a[20:23], a[12:15], v[92:95]
    s_cselect_b32 s58, 0, s58
    ds_read_b64_tr_b16 a[54:55], v13 offset:12288
    v_sub_f32 v157, v157, v141
    v_sub_f32 v158, v158, v141
    s_waitcnt lgkmcnt(10)
    v_mfma_f32_16x16x32_bf16 v[96:99], a[24:27], a[0:3], v[96:99]
    ds_read_b64_tr_b16 a[56:57], v14 offset:8192
    v_sub_f32 v159, v159, v141
    v_sub_f32 v160, v160, v141
    v_mfma_f32_16x16x32_bf16 v[104:107], a[24:27], a[4:7], v[104:107]
    ds_read_b64_tr_b16 a[58:59], v14 offset:12288
    buffer_load_dwordx4 v18, s[24:27], s57 offen offset:2048 sc1 lds
    v_sub_f32 v161, v161, v141
    v_mfma_f32_16x16x32_bf16 v[112:115], a[24:27], a[8:11], v[112:115]
    ds_read_b64_tr_b16 a[60:61], v15 offset:8192
    v_sub_f32 v162, v162, v141
    v_sub_f32 v163, v163, v141
    v_mfma_f32_16x16x32_bf16 v[120:123], a[24:27], a[12:15], v[120:123]
    ds_read_b64_tr_b16 a[62:63], v15 offset:12288
    v_sub_f32 v164, v164, v142
    v_sub_f32 v165, v165, v142
    s_waitcnt lgkmcnt(12)
    v_mfma_f32_16x16x32_bf16 v[100:103], a[28:31], a[0:3], v[100:103]
    v_add_u32 v6, s66, v6
    v_add_u32 v12, s66, v12
    v_sub_f32 v166, v166, v142
    v_mfma_f32_16x16x32_bf16 v[108:111], a[28:31], a[4:7], v[108:111]
    buffer_load_dwordx4 v19, s[24:27], s57 offen offset:3072 sc1 lds
    v_sub_f32 v167, v167, v142
    v_mfma_f32_16x16x32_bf16 v[116:119], a[28:31], a[8:11], v[116:119]
    s_add_u32 s57, s57, 131072
    v_add_u32 v13, s66, v13
    v_add_u32 v14, s66, v14
    v_sub_f32 v168, v168, v142
    v_mfma_f32_16x16x32_bf16 v[124:127], a[28:31], a[12:15], v[124:127]
    s_mov_b32 m0, s59
    v_add_u32 v15, s66, v15
    v_sub_f32 v169, v169, v142
    s_waitcnt vmcnt(20) lgkmcnt(0)
    v_mfma_f32_16x16x32_bf16 v[64:67], a[48:51], a[32:35], v[64:67]
    s_barrier
    v_sub_f32 v170, v170, v142
    v_sub_f32 v171, v171, v142
    v_mfma_f32_16x16x32_bf16 v[72:75], a[48:51], a[36:39], v[72:75]
    ds_read_b128 a[0:3], v6 offset:0
    buffer_load_dwordx4 v2, s[36:39], s56 offen offset:0 sc1 lds
    v_sub_f32 v172, v172, v143
    v_mfma_f32_16x16x32_bf16 v[80:83], a[48:51], a[40:43], v[80:83]
    ds_read_b64_tr_b16 a[16:17], v12 offset:0
    v_sub_f32 v173, v173, v143
    v_sub_f32 v174, v174, v143
    v_mfma_f32_16x16x32_bf16 v[88:91], a[48:51], a[44:47], v[88:91]
    ds_read_b64_tr_b16 a[18:19], v12 offset:4096
    v_sub_f32 v175, v175, v143
    v_sub_f32 v176, v176, v143
    v_mfma_f32_16x16x32_bf16 v[68:71], a[52:55], a[32:35], v[68:71]
    ds_read_b128 a[4:7], v6 offset:1024
    v_sub_f32 v177, v177, v143
    v_sub_f32 v178, v178, v143
    v_mfma_f32_16x16x32_bf16 v[76:79], a[52:55], a[36:39], v[76:79]
    ds_read_b128 a[8:11], v6 offset:2048
    buffer_load_dwordx4 v2, s[36:39], s56 offen offset:1024 sc1 lds
    v_sub_f32 v179, v179, v143
    v_mfma_f32_16x16x32_bf16 v[84:87], a[52:55], a[40:43], v[84:87]
    ds_read_b128 a[12:15], v6 offset:3072
    v_exp_f32 v148, v148
    v_exp_f32 v149, v149
    v_mfma_f32_16x16x32_bf16 v[92:95], a[52:55], a[44:47], v[92:95]
    ds_read_b64_tr_b16 a[20:21], v13 offset:0
    v_exp_f32 v150, v150
    v_exp_f32 v151, v151
    v_mfma_f32_16x16x32_bf16 v[96:99], a[56:59], a[32:35], v[96:99]
    ds_read_b64_tr_b16 a[22:23], v13 offset:4096
    v_exp_f32 v152, v152
    v_exp_f32 v153, v153
    v_mfma_f32_16x16x32_bf16 v[104:107], a[56:59], a[36:39], v[104:107]
    ds_read_b64_tr_b16 a[24:25], v14 offset:0
    buffer_load_dwordx4 v2, s[36:39], s56 offen offset:2048 sc1 lds
    v_exp_f32 v154, v154
    v_mfma_f32_16x16x32_bf16 v[112:115], a[56:59], a[40:43], v[112:115]
    ds_read_b64_tr_b16 a[26:27], v14 offset:4096
    v_exp_f32 v155, v155
    v_exp_f32 v156, v156
    v_mfma_f32_16x16x32_bf16 v[120:123], a[56:59], a[44:47], v[120:123]
    ds_read_b64_tr_b16 a[28:29], v15 offset:0
    v_exp_f32 v157, v157
    v_exp_f32 v158, v158
    v_mfma_f32_16x16x32_bf16 v[100:103], a[60:63], a[32:35], v[100:103]
    s_add_u32 s64, s64, 1
    ds_read_b64_tr_b16 a[30:31], v15 offset:4096
    v_exp_f32 v159, v159
    v_exp_f32 v160, v160
    v_mfma_f32_16x16x32_bf16 v[108:111], a[60:63], a[36:39], v[108:111]
    buffer_load_dwordx4 v2, s[36:39], s56 offen offset:3072 sc1 lds
    v_exp_f32 v161, v161
    v_mfma_f32_16x16x32_bf16 v[116:119], a[60:63], a[40:43], v[116:119]
    s_add_u32 s56, s56, 262144
    v_exp_f32 v162, v162
    v_exp_f32 v163, v163
    v_mfma_f32_16x16x32_bf16 v[124:127], a[60:63], a[44:47], v[124:127]
    v_exp_f32 v164, v164
    v_exp_f32 v165, v165
    s_cmp_gt_i32 s68, 7
    s_cbranch_scc0 m_lp161
m_lr162:
    s_waitcnt lgkmcnt(9)
    v_mfma_f32_16x16x32_bf16 v[64:67], a[16:19], a[0:3], v[64:67]
    s_add_u32 m0, s59, 16384
    ds_read_b128 a[32:35], v6 offset:8192
    v_exp_f32 v166, v166
    v_exp_f32 v167, v167
    s_waitcnt lgkmcnt(9)
    v_mfma_f32_16x16x32_bf16 v[72:75], a[16:19], a[4:7], v[72:75]
    ds_read_b64_tr_b16 a[48:49], v12 offset:8192
    buffer_load_dwordx4 v16, s[24:27], s57 offen offset:0 sc1 lds
    v_exp_f32 v168, v168
    s_waitcnt lgkmcnt(9)
    v_mfma_f32_16x16x32_bf16 v[80:83], a[16:19], a[8:11], v[80:83]
    s_add_u32 s59, s58, s60
    ds_read_b64_tr_b16 a[50:51], v12 offset:12288
    v_exp_f32 v169, v169
    v_exp_f32 v170, v170
    s_waitcnt lgkmcnt(9)
    v_mfma_f32_16x16x32_bf16 v[88:91], a[16:19], a[12:15], v[88:91]
    s_add_u32 s58, s58, 32768
    ds_read_b128 a[36:39], v6 offset:9216
    v_exp_f32 v171, v171
    v_exp_f32 v172, v172
    s_waitcnt lgkmcnt(8)
    v_mfma_f32_16x16x32_bf16 v[68:71], a[20:23], a[0:3], v[68:71]
    s_cmp_ge_u32 s58, 163840
    ds_read_b128 a[40:43], v6 offset:10240
    v_exp_f32 v173, v173
    v_exp_f32 v174, v174
    v_mfma_f32_16x16x32_bf16 v[76:79], a[20:23], a[4:7], v[76:79]
    ds_read_b128 a[44:47], v6 offset:11264
    buffer_load_dwordx4 v17, s[24:27], s57 offen offset:1024 sc1 lds
    v_exp_f32 v175, v175
    v_mfma_f32_16x16x32_bf16 v[84:87], a[20:23], a[8:11], v[84:87]
    s_cselect_b32 s66, 4294836224, s100
    ds_read_b64_tr_b16 a[52:53], v13 offset:8192
    v_exp_f32 v176, v176
    v_exp_f32 v177, v177
    v_mfma_f32_16x16x32_bf16 v[92:95], a[20:23], a[12:15], v[92:95]
    s_cselect_b32 s58, 0, s58
    ds_read_b64_tr_b16 a[54:55], v13 offset:12288
    v_exp_f32 v178, v178
    v_exp_f32 v179, v179
    s_waitcnt lgkmcnt(10)
    v_mfma_f32_16x16x32_bf16 v[96:99], a[24:27], a[0:3], v[96:99]
    ds_read_b64_tr_b16 a[56:57], v14 offset:8192
    v_cvt_pk_bf16_f32 v192, v148, v149
    v_cvt_pk_bf16_f32 v193, v150, v151
    v_mfma_f32_16x16x32_bf16 v[104:107], a[24:27], a[4:7], v[104:107]
    ds_read_b64_tr_b16 a[58:59], v14 offset:12288
    buffer_load_dwordx4 v18, s[24:27], s57 offen offset:2048 sc1 lds
    v_cvt_pk_bf16_f32 v194, v152, v153
    v_mfma_f32_16x16x32_bf16 v[112:115], a[24:27], a[8:11], v[112:115]
    ds_read_b64_tr_b16 a[60:61], v15 offset:8192
    v_cvt_pk_bf16_f32 v195, v154, v155
    v_cvt_pk_bf16_f32 v196, v156, v157
    v_mfma_f32_16x16x32_bf16 v[120:123], a[24:27], a[12:15], v[120:123]
    ds_read_b64_tr_b16 a[62:63], v15 offset:12288
    v_cvt_pk_bf16_f32 v197, v158, v159
    v_cvt_pk_bf16_f32 v198, v160, v161
    s_waitcnt lgkmcnt(12)
    v_mfma_f32_16x16x32_bf16 v[100:103], a[28:31], a[0:3], v[100:103]
    v_add_u32 v6, s66, v6
    v_add_u32 v12, s66, v12
    v_cvt_pk_bf16_f32 v199, v162, v163
    v_mfma_f32_16x16x32_bf16 v[108:111], a[28:31], a[4:7], v[108:111]
    buffer_load_dwordx4 v19, s[24:27], s57 offen offset:3072 sc1 lds
    v_cvt_pk_bf16_f32 v200, v164, v165
    v_mfma_f32_16x16x32_bf16 v[116:119], a[28:31], a[8:11], v[116:119]
    s_add_u32 s57, s57, 131072
    v_add_u32 v13, s66, v13
    v_add_u32 v14, s66, v14
    v_cvt_pk_bf16_f32 v201, v166, v167
    v_mfma_f32_16x16x32_bf16 v[124:127], a[28:31], a[12:15], v[124:127]
    s_mov_b32 m0, s59
    v_add_u32 v15, s66, v15
    v_cvt_pk_bf16_f32 v202, v168, v169
    s_waitcnt vmcnt(24) lgkmcnt(0)
    v_mfma_f32_16x16x32_bf16 v[64:67], a[48:51], a[32:35], v[64:67]
    s_barrier
    v_cvt_pk_bf16_f32 v203, v170, v171
    v_cvt_pk_bf16_f32 v204, v172, v173
    v_mfma_f32_16x16x32_bf16 v[72:75], a[48:51], a[36:39], v[72:75]
    ds_read_b128 a[0:3], v6 offset:0
    buffer_load_dwordx4 v2, s[36:39], s56 offen offset:0 sc1 lds
    v_cvt_pk_bf16_f32 v205, v174, v175
    v_mfma_f32_16x16x32_bf16 v[80:83], a[48:51], a[40:43], v[80:83]
    ds_read_b64_tr_b16 a[16:17], v12 offset:0
    v_cvt_pk_bf16_f32 v206, v176, v177
    v_cvt_pk_bf16_f32 v207, v178, v179
    v_mfma_f32_16x16x32_bf16 v[88:91], a[48:51], a[44:47], v[88:91]
    ds_read_b64_tr_b16 a[18:19], v12 offset:4096
    s_nop 1
    v_mfma_f32_16x16x32_bf16 v[20:23], v[44:47], v[192:195], 0
    v_mfma_f32_16x16x32_bf16 v[68:71], a[52:55], a[32:35], v[68:71]
    ds_read_b128 a[4:7], v6 offset:1024
    v_mfma_f32_16x16x32_bf16 v[24:27], v[44:47], v[196:199], 0
    v_mfma_f32_16x16x32_bf16 v[28:31], v[44:47], v[200:203], 0
    v_mfma_f32_16x16x32_bf16 v[76:79], a[52:55], a[36:39], v[76:79]
    ds_read_b128 a[8:11], v6 offset:2048
    buffer_load_dwordx4 v2, s[36:39], s56 offen offset:1024 sc1 lds
    v_mfma_f32_16x16x32_bf16 v[32:35], v[44:47], v[204:207], 0
    v_mfma_f32_16x16x32_bf16 v[84:87], a[52:55], a[40:43], v[84:87]
    ds_read_b128 a[12:15], v6 offset:3072
    v_mfma_f32_16x16x32_bf16 v[148:151], v[230:233], v[192:195], 0
    v_mfma_f32_16x16x32_bf16 v[152:155], v[242:245], v[192:195], 0
    v_mfma_f32_16x16x32_bf16 v[92:95], a[52:55], a[44:47], v[92:95]
    ds_read_b64_tr_b16 a[20:21], v13 offset:0
    v_mfma_f32_16x16x32_bf16 v[156:159], v[232:235], v[196:199], 0
    v_mfma_f32_16x16x32_bf16 v[160:163], v[244:247], v[196:199], 0
    v_mfma_f32_16x16x32_bf16 v[96:99], a[56:59], a[32:35], v[96:99]
    ds_read_b64_tr_b16 a[22:23], v13 offset:4096
    v_mfma_f32_16x16x32_bf16 v[164:167], v[234:237], v[200:203], 0
    v_mfma_f32_16x16x32_bf16 v[168:171], v[246:249], v[200:203], 0
    v_mfma_f32_16x16x32_bf16 v[104:107], a[56:59], a[36:39], v[104:107]
    ds_read_b64_tr_b16 a[24:25], v14 offset:0
    buffer_load_dwordx4 v2, s[36:39], s56 offen offset:2048 sc1 lds
    v_mfma_f32_16x16x32_bf16 v[172:175], v[236:239], v[204:207], 0
    v_mfma_f32_16x16x32_bf16 v[112:115], a[56:59], a[40:43], v[112:115]
    ds_read_b64_tr_b16 a[26:27], v14 offset:4096
    v_mfma_f32_16x16x32_bf16 v[176:179], v[248:251], v[204:207], 0
    v_rcp_f32 v140, v20
    v_mfma_f32_16x16x32_bf16 v[120:123], a[56:59], a[44:47], v[120:123]
    ds_read_b64_tr_b16 a[28:29], v15 offset:0
    v_rcp_f32 v141, v24
    v_rcp_f32 v142, v28
    v_mfma_f32_16x16x32_bf16 v[100:103], a[60:63], a[32:35], v[100:103]
    s_add_u32 s64, s64, 1
    ds_read_b64_tr_b16 a[30:31], v15 offset:4096
    v_rcp_f32 v143, v32
    s_nop 1
    v_mfma_f32_16x16x32_bf16 v[108:111], a[60:63], a[36:39], v[108:111]
    buffer_load_dwordx4 v2, s[36:39], s56 offen offset:3072 sc1 lds
    s_nop 1
    v_mfma_f32_16x16x32_bf16 v[116:119], a[60:63], a[40:43], v[116:119]
    s_add_u32 s56, s56, 262144
    v_mul_f32 v148, v148, v140
    v_mul_f32 v149, v149, v140
    v_mfma_f32_16x16x32_bf16 v[124:127], a[60:63], a[44:47], v[124:127]
    v_mul_f32 v150, v150, v140
    v_mul_f32 v151, v151, v140
    s_cmp_gt_i32 s68, 8
    s_cbranch_scc0 m_lp163
m_lr164:
    s_waitcnt lgkmcnt(9)
    v_mfma_f32_16x16x32_bf16 v[64:67], a[16:19], a[0:3], v[64:67]
    s_add_u32 m0, s59, 16384
    ds_read_b128 a[32:35], v6 offset:8192
    v_mul_f32 v152, v152, v140
    v_mul_f32 v153, v153, v140
    s_waitcnt lgkmcnt(9)
    v_mfma_f32_16x16x32_bf16 v[72:75], a[16:19], a[4:7], v[72:75]
    ds_read_b64_tr_b16 a[48:49], v12 offset:8192
    buffer_load_dwordx4 v16, s[24:27], s57 offen offset:0 sc1 lds
    v_mul_f32 v154, v154, v140
    s_waitcnt lgkmcnt(9)
    v_mfma_f32_16x16x32_bf16 v[80:83], a[16:19], a[8:11], v[80:83]
    s_add_u32 s59, s58, s60
    ds_read_b64_tr_b16 a[50:51], v12 offset:12288
    v_mul_f32 v155, v155, v140
    v_cvt_pk_bf16_f32 v148, v148, v149
    s_waitcnt lgkmcnt(9)
    v_mfma_f32_16x16x32_bf16 v[88:91], a[16:19], a[12:15], v[88:91]
    s_add_u32 s58, s58, 32768
    ds_read_b128 a[36:39], v6 offset:9216
    v_cvt_pk_bf16_f32 v149, v150, v151
    v_cvt_pk_bf16_f32 v150, v152, v153
    s_waitcnt lgkmcnt(8)
    v_mfma_f32_16x16x32_bf16 v[68:71], a[20:23], a[0:3], v[68:71]
    s_cmp_ge_u32 s58, 163840
    ds_read_b128 a[40:43], v6 offset:10240
    v_cvt_pk_bf16_f32 v151, v154, v155
    buffer_store_dwordx4 v[148:151], v2, s[8:11], s80 offen offset:0 sc1
    v_mfma_f32_16x16x32_bf16 v[76:79], a[20:23], a[4:7], v[76:79]
    ds_read_b128 a[44:47], v6 offset:11264
    buffer_load_dwordx4 v17, s[24:27], s57 offen offset:1024 sc1 lds
    v_mul_f32 v156, v156, v141
    v_mfma_f32_16x16x32_bf16 v[84:87], a[20:23], a[8:11], v[84:87]
    s_cselect_b32 s66, 4294836224, s100
    ds_read_b64_tr_b16 a[52:53], v13 offset:8192
    v_mul_f32 v157, v157, v141
    v_mul_f32 v158, v158, v141
    v_mfma_f32_16x16x32_bf16 v[92:95], a[20:23], a[12:15], v[92:95]
    s_cselect_b32 s58, 0, s58
    ds_read_b64_tr_b16 a[54:55], v13 offset:12288
    v_mul_f32 v159, v159, v141
    v_mul_f32 v160, v160, v141
    s_waitcnt lgkmcnt(10)
    v_mfma_f32_16x16x32_bf16 v[96:99], a[24:27], a[0:3], v[96:99]
    ds_read_b64_tr_b16 a[56:57], v14 offset:8192
    v_mul_f32 v161, v161, v141
    v_mul_f32 v162, v162, v141
    v_mfma_f32_16x16x32_bf16 v[104:107], a[24:27], a[4:7], v[104:107]
    ds_read_b64_tr_b16 a[58:59], v14 offset:12288
    buffer_load_dwordx4 v18, s[24:27], s57 offen offset:2048 sc1 lds
    v_mul_f32 v163, v163, v141
    v_mfma_f32_16x16x32_bf16 v[112:115], a[24:27], a[8:11], v[112:115]
    ds_read_b64_tr_b16 a[60:61], v15 offset:8192
    v_cvt_pk_bf16_f32 v156, v156, v157
    v_cvt_pk_bf16_f32 v157, v158, v159
    v_mfma_f32_16x16x32_bf16 v[120:123], a[24:27], a[12:15], v[120:123]
    ds_read_b64_tr_b16 a[62:63], v15 offset:12288
    v_cvt_pk_bf16_f32 v158, v160, v161
    v_cvt_pk_bf16_f32 v159, v162, v163
    s_waitcnt lgkmcnt(12)
    v_mfma_f32_16x16x32_bf16 v[100:103], a[28:31], a[0:3], v[100:103]
    v_add_u32 v6, s66, v6
    v_add_u32 v12, s66, v12
    buffer_store_dwordx4 v[156:159], v2, s[8:11], s80 offen offset:1024 sc1
    v_mfma_f32_16x16x32_bf16 v[108:111], a[28:31], a[4:7], v[108:111]
    buffer_load_dwordx4 v19, s[24:27], s57 offen offset:3072 sc1 lds
    v_mul_f32 v164, v164, v142
    v_mfma_f32_16x16x32_bf16 v[116:119], a[28:31], a[8:11], v[116:119]
    s_add_u32 s57, s57, 131072
    v_add_u32 v13, s66, v13
    v_add_u32 v14, s66, v14
    v_mul_f32 v165, v165, v142
    v_mfma_f32_16x16x32_bf16 v[124:127], a[28:31], a[12:15], v[124:127]
    s_mov_b32 m0, s59
    v_add_u32 v15, s66, v15
    v_mul_f32 v166, v166, v142
    s_waitcnt vmcnt(24) lgkmcnt(0)
    v_mfma_f32_16x16x32_bf16 v[64:67], a[48:51], a[32:35], v[64:67]
    s_barrier
    v_mul_f32 v167, v167, v142
    v_mul_f32 v168, v168, v142
    v_mfma_f32_16x16x32_bf16 v[72:75], a[48:51], a[36:39], v[72:75]
    ds_read_b128 a[0:3], v6 offset:0
    buffer_load_dwordx4 v2, s[36:39], s56 offen offset:0 sc1 lds
    v_mul_f32 v169, v169, v142
    v_mfma_f32_16x16x32_bf16 v[80:83], a[48:51], a[40:43], v[80:83]
    ds_read_b64_tr_b16 a[16:17], v12 offset:0
    v_mul_f32 v170, v170, v142
    v_mul_f32 v171, v171, v142
    v_mfma_f32_16x16x32_bf16 v[88:91], a[48:51], a[44:47], v[88:91]
    ds_read_b64_tr_b16 a[18:19], v12 offset:4096
    v_cvt_pk_bf16_f32 v164, v164, v165
    v_cvt_pk_bf16_f32 v165, v166, v167
    v_mfma_f32_16x16x32_bf16 v[68:71], a[52:55], a[32:35], v[68:71]
    ds_read_b128 a[4:7], v6 offset:1024
    v_cvt_pk_bf16_f32 v166, v168, v169
    v_cvt_pk_bf16_f32 v167, v170, v171
    v_mfma_f32_16x16x32_bf16 v[76:79], a[52:55], a[36:39], v[76:79]
    ds_read_b128 a[8:11], v6 offset:2048
    buffer_load_dwordx4 v2, s[36:39], s56 offen offset:1024 sc1 lds
    buffer_store_dwordx4 v[164:167], v2, s[8:11], s80 offen offset:2048 sc1
    v_mfma_f32_16x16x32_bf16 v[84:87], a[52:55], a[40:43], v[84:87]
    ds_read_b128 a[12:15], v6 offset:3072
    v_mul_f32 v172, v172, v143
    v_mul_f32 v173, v173, v143
    v_mfma_f32_16x16x32_bf16 v[92:95], a[52:55], a[44:47], v[92:95]
    ds_read_b64_tr_b16 a[20:21], v13 offset:0
    v_mul_f32 v174, v174, v143
    v_mul_f32 v175, v175, v143
    v_mfma_f32_16x16x32_bf16 v[96:99], a[56:59], a[32:35], v[96:99]
    ds_read_b64_tr_b16 a[22:23], v13 offset:4096
    v_mul_f32 v176, v176, v143
    v_mul_f32 v177, v177, v143
    v_mfma_f32_16x16x32_bf16 v[104:107], a[56:59], a[36:39], v[104:107]
    ds_read_b64_tr_b16 a[24:25], v14 offset:0
    buffer_load_dwordx4 v2, s[36:39], s56 offen offset:2048 sc1 lds
    v_mul_f32 v178, v178, v143
    v_mfma_f32_16x16x32_bf16 v[112:115], a[56:59], a[40:43], v[112:115]
    ds_read_b64_tr_b16 a[26:27], v14 offset:4096
    v_mul_f32 v179, v179, v143
    v_cvt_pk_bf16_f32 v172, v172, v173
    v_mfma_f32_16x16x32_bf16 v[120:123], a[56:59], a[44:47], v[120:123]
    ds_read_b64_tr_b16 a[28:29], v15 offset:0
    v_cvt_pk_bf16_f32 v173, v174, v175
    v_cvt_pk_bf16_f32 v174, v176, v177
    v_mfma_f32_16x16x32_bf16 v[100:103], a[60:63], a[32:35], v[100:103]
    s_add_u32 s64, s64, 1
    ds_read_b64_tr_b16 a[30:31], v15 offset:4096
    v_cvt_pk_bf16_f32 v175, v178, v179
    buffer_store_dwordx4 v[172:175], v2, s[8:11], s80 offen offset:3072 sc1
    v_mfma_f32_16x16x32_bf16 v[108:111], a[60:63], a[36:39], v[108:111]
    buffer_load_dwordx4 v2, s[36:39], s56 offen offset:3072 sc1 lds
    v_mfma_f32_16x16x32_bf16 v[116:119], a[60:63], a[40:43], v[116:119]
    s_add_u32 s56, s56, 262144
    v_mfma_f32_16x16x32_bf16 v[124:127], a[60:63], a[44:47], v[124:127]
    s_branch m_l3e153
m_lp157:
    s_mov_b32 s3, 262144
m_spin165:
    buffer_load_dwordx2 v[4:5], v10, s[8:11], s52 offen sc1
    s_waitcnt vmcnt(0)
    v_cmp_ne_u64 s[76:77], s[4:5], v[4:5]
    s_mul_i32 s91, s95, 20
    s_nop 2
    s_lshr_b32 s90, s76, s91
    s_ff1_i32_b32 s90, s90
    s_lshl_b32 s68, s90, 1
    s_mul_i32 s91, s95, 0
    s_sub_i32 s68, s68, s91
    s_cmp_lt_i32 s90, 0
    s_cselect_b32 s68, 1000, s68
    s_cmp_gt_i32 s68, 5
    s_cbranch_scc1 m_ok166
    s_sub_u32 s3, s3, 1
    s_cbranch_scc1 m_ok166
    s_sleep 4
    s_branch m_spin165
m_ok166:
    s_branch m_lr158
m_lp159:
    s_mov_b32 s3, 262144
m_spin167:
    buffer_load_dwordx2 v[4:5], v10, s[8:11], s52 offen sc1
    s_waitcnt vmcnt(0)
    v_cmp_ne_u64 s[76:77], s[4:5], v[4:5]
    s_mul_i32 s91, s95, 20
    s_nop 2
    s_lshr_b32 s90, s76, s91
    s_ff1_i32_b32 s90, s90
    s_lshl_b32 s68, s90, 1
    s_mul_i32 s91, s95, 0
    s_sub_i32 s68, s68, s91
    s_cmp_lt_i32 s90, 0
    s_cselect_b32 s68, 1000, s68
    s_cmp_gt_i32 s68, 6
    s_cbranch_scc1 m_ok168
    s_sub_u32 s3, s3, 1
    s_cbranch_scc1 m_ok168
    s_sleep 4
    s_branch m_spin167
m_ok168:
    s_branch m_lr160
m_lp161:
    s_mov_b32 s3, 262144
m_spin169:
    buffer_load_dwordx2 v[4:5], v10, s[8:11], s52 offen sc1
    s_waitcnt vmcnt(0)
    v_cmp_ne_u64 s[76:77], s[4:5], v[4:5]
    s_mul_i32 s91, s95, 20
    s_nop 2
    s_lshr_b32 s90, s76, s91
    s_ff1_i32_b32 s90, s90
    s_lshl_b32 s68, s90, 1
    s_mul_i32 s91, s95, 0
    s_sub_i32 s68, s68, s91
    s_cmp_lt_i32 s90, 0
    s_cselect_b32 s68, 1000, s68
    s_cmp_gt_i32 s68, 7
    s_cbranch_scc1 m_ok170
    s_sub_u32 s3, s3, 1
    s_cbranch_scc1 m_ok170
    s_sleep 4
    s_branch m_spin169
m_ok170:
    s_branch m_lr162
m_lp163:
    s_mov_b32 s3, 262144
m_spin171:
    buffer_load_dwordx2 v[4:5], v10, s[8:11], s52 offen sc1
    s_waitcnt vmcnt(0)
    v_cmp_ne_u64 s[76:77], s[4:5], v[4:5]
    s_mul_i32 s91, s95, 20
    s_nop 2
    s_lshr_b32 s90, s76, s91
    s_ff1_i32_b32 s90, s90
    s_lshl_b32 s68, s90, 1
    s_mul_i32 s91, s95, 0
    s_sub_i32 s68, s68, s91
    s_cmp_lt_i32 s90, 0
    s_cselect_b32 s68, 1000, s68
    s_cmp_gt_i32 s68, 8
    s_cbranch_scc1 m_ok172
    s_sub_u32 s3, s3, 1
    s_cbranch_scc1 m_ok172
    s_sleep 4
    s_branch m_spin171
m_ok172:
    s_branch m_lr164
.p2align 3
m_l3152:
    s_waitcnt lgkmcnt(9)
    v_mfma_f32_16x16x32_bf16 v[64:67], a[16:19], a[0:3], v[64:67]
    s_add_u32 m0, s59, 16384
    ds_read_b128 a[32:35], v6 offset:8192
    s_waitcnt lgkmcnt(9)
    v_mfma_f32_16x16x32_bf16 v[72:75], a[16:19], a[4:7], v[72:75]
    ds_read_b64_tr_b16 a[48:49], v12 offset:8192
    buffer_load_dwordx4 v16, s[24:27], s57 offen offset:0 sc1 lds
    s_waitcnt lgkmcnt(9)
    v_mfma_f32_16x16x32_bf16 v[80:83], a[16:19], a[8:11], v[80:83]
    s_add_u32 s59, s58, s60
    ds_read_b64_tr_b16 a[50:51], v12 offset:12288
    s_waitcnt lgkmcnt(9)
    v_mfma_f32_16x16x32_bf16 v[88:91], a[16:19], a[12:15], v[88:91]
    s_add_u32 s58, s58, 32768
    ds_read_b128 a[36:39], v6 offset:9216
    s_waitcnt lgkmcnt(8)
    v_mfma_f32_16x16x32_bf16 v[68:71], a[20:23], a[0:3], v[68:71]
    s_cmp_ge_u32 s58, 163840
    ds_read_b128 a[40:43], v6 offset:10240
    v_mfma_f32_16x16x32_bf16 v[76:79], a[20:23], a[4:7], v[76:79]
    ds_read_b128 a[44:47], v6 offset:11264
    buffer_load_dwordx4 v17, s[24:27], s57 offen offset:1024 sc1 lds
    v_mfma_f32_16x16x32_bf16 v[84:87], a[20:23], a[8:11], v[84:87]
    s_cselect_b32 s66, 4294836224, s100
    ds_read_b64_tr_b16 a[52:53], v13 offset:8192
    v_mfma_f32_16x16x32_bf16 v[92:95], a[20:23], a[12:15], v[92:95]
    s_cselect_b32 s58, 0, s58
    ds_read_b64_tr_b16 a[54:55], v13 offset:12288
    s_waitcnt lgkmcnt(10)
    v_mfma_f32_16x16x32_bf16 v[96:99], a[24:27], a[0:3], v[96:99]
    ds_read_b64_tr_b16 a[56:57], v14 offset:8192
    v_mfma_f32_16x16x32_bf16 v[104:107], a[24:27], a[4:7], v[104:107]
    ds_read_b64_tr_b16 a[58:59], v14 offset:12288
    buffer_load_dwordx4 v18, s[24:27], s57 offen offset:2048 sc1 lds
    v_mfma_f32_16x16x32_bf16 v[112:115], a[24:27], a[8:11], v[112:115]
    ds_read_b64_tr_b16 a[60:61], v15 offset:8192
    v_mfma_f32_16x16x32_bf16 v[120:123], a[24:27], a[12:15], v[120:123]
    ds_read_b64_tr_b16 a[62:63], v15 offset:12288
    s_waitcnt lgkmcnt(12)
    v_mfma_f32_16x16x32_bf16 v[100:103], a[28:31], a[0:3], v[100:103]
    v_add_u32 v6, s66, v6
    v_add_u32 v12, s66, v12
    v_mfma_f32_16x16x32_bf16 v[108:111], a[28:31], a[4:7], v[108:111]
    buffer_load_dwordx4 v19, s[24:27], s57 offen offset:3072 sc1 lds
    v_mfma_f32_16x16x32_bf16 v[116:119], a[28:31], a[8:11], v[116:119]
    s_add_u32 s57, s57, 131072
    v_add_u32 v13, s66, v13
    v_add_u32 v14, s66, v14
    v_mfma_f32_16x16x32_bf16 v[124:127], a[28:31], a[12:15], v[124:127]
    s_mov_b32 m0, s59
    v_add_u32 v15, s66, v15
    s_waitcnt vmcnt(24) lgkmcnt(0)
    v_mfma_f32_16x16x32_bf16 v[64:67], a[48:51], a[32:35], v[64:67]
    s_barrier
    v_mfma_f32_16x16x32_bf16 v[72:75], a[48:51], a[36:39], v[72:75]
    ds_read_b128 a[0:3], v6 offset:0
    buffer_load_dwordx4 v2, s[36:39], s56 offen offset:0 sc1 lds
    v_mfma_f32_16x16x32_bf16 v[80:83], a[48:51], a[40:43], v[80:83]
    ds_read_b64_tr_b16 a[16:17], v12 offset:0
    v_mfma_f32_16x16x32_bf16 v[88:91], a[48:51], a[44:47], v[88:91]
    ds_read_b64_tr_b16 a[18:19], v12 offset:4096
    v_mfma_f32_16x16x32_bf16 v[68:71], a[52:55], a[32:35], v[68:71]
    ds_read_b128 a[4:7], v6 offset:1024
    v_mfma_f32_16x16x32_bf16 v[76:79], a[52:55], a[36:39], v[76:79]
    ds_read_b128 a[8:11], v6 offset:2048
    buffer_load_dwordx4 v2, s[36:39], s56 offen offset:1024 sc1 lds
    v_mfma_f32_16x16x32_bf16 v[84:87], a[52:55], a[40:43], v[84:87]
    ds_read_b128 a[12:15], v6 offset:3072
    v_mfma_f32_16x16x32_bf16 v[92:95], a[52:55], a[44:47], v[92:95]
    ds_read_b64_tr_b16 a[20:21], v13 offset:0
    v_mfma_f32_16x16x32_bf16 v[96:99], a[56:59], a[32:35], v[96:99]
    ds_read_b64_tr_b16 a[22:23], v13 offset:4096
    v_mfma_f32_16x16x32_bf16 v[104:107], a[56:59], a[36:39], v[104:107]
    ds_read_b64_tr_b16 a[24:25], v14 offset:0
    buffer_load_dwordx4 v2, s[36:39], s56 offen offset:2048 sc1 lds
    v_mfma_f32_16x16x32_bf16 v[112:115], a[56:59], a[40:43], v[112:115]
    ds_read_b64_tr_b16 a[26:27], v14 offset:4096
    v_mfma_f32_16x16x32_bf16 v[120:123], a[56:59], a[44:47], v[120:123]
    ds_read_b64_tr_b16 a[28:29], v15 offset:0
    v_mfma_f32_16x16x32_bf16 v[100:103], a[60:63], a[32:35], v[100:103]
    s_add_u32 s64, s64, 1
    ds_read_b64_tr_b16 a[30:31], v15 offset:4096
    v_mfma_f32_16x16x32_bf16 v[108:111], a[60:63], a[36:39], v[108:111]
    buffer_load_dwordx4 v2, s[36:39], s56 offen offset:3072 sc1 lds
    v_mfma_f32_16x16x32_bf16 v[116:119], a[60:63], a[40:43], v[116:119]
    s_add_u32 s56, s56, 262144
    s_cmp_lt_u32 s64, s67
    v_mfma_f32_16x16x32_bf16 v[124:127], a[60:63], a[44:47], v[124:127]
    s_cbranch_scc1 m_l3152
m_l3e153:
    s_add_u32 s92, s64, 5
    s_cmp_gt_i32 s68, s92
    s_cbranch_scc1 m_rdy173
    s_mov_b32 s3, 262144
m_spin174:
    buffer_load_dwordx2 v[4:5], v10, s[8:11], s52 offen sc1
    s_waitcnt vmcnt(0)
    v_cmp_ne_u64 s[76:77], s[4:5], v[4:5]
    s_mul_i32 s91, s95, 20
    s_nop 2
    s_lshr_b32 s90, s76, s91
    s_ff1_i32_b32 s90, s90
    s_lshl_b32 s68, s90, 1
    s_mul_i32 s91, s95, 0
    s_sub_i32 s68, s68, s91
    s_cmp_lt_i32 s90, 0
    s_cselect_b32 s68, 1000, s68
    s_cmp_gt_i32 s68, s92
    s_cbranch_scc1 m_ok175
    s_sub_u32 s3, s3, 1
    s_cbranch_scc1 m_ok175
    s_sleep 4
    s_branch m_spin174
m_ok175:
m_rdy173:
    s_mov_b32 s67, 8
    s_cmp_lt_u32 s64, 8
    s_cbranch_scc1 m_l3n156
    s_cmp_eq_u32 s64, 8
    s_cbranch_scc1 m_o1176
m_o2177:
    s_cmp_eq_u32 s95, 0
    s_cbranch_scc1 m_l3c155
    s_mov_b32 s67, 18
    s_cmp_lt_u32 s64, 18
    s_cbranch_scc1 m_l3n156
    s_cmp_lg_u32 s64, 18
    s_cbranch_scc1 m_n178
    s_mov_b32 s68, 1000
    s_lshr_b32 s90, s96, 1
    s_lshl_b32 s90, s90, 8
    s_add_u32 s90, s90, 117452800
    buffer_load_dwordx2 v[4:5], v10, s[8:11], s90 offen sc1
    s_mov_b32 s67, 19
    s_branch m_l3152
m_n178:
    s_cmp_lg_u32 s64, 19
    s_cbranch_scc1 m_n179
    s_waitcnt vmcnt(8)
    s_waitcnt vmcnt(16)
    s_mov_b32 s3, 262144
m_spin180:
    v_cmp_ne_u64 s[76:77], s[4:5], v[4:5]
    s_nop 3
    s_cmp_eq_u64 s[76:77], 0
    s_cbranch_scc1 m_ok181
    s_sub_u32 s3, s3, 1
    s_cbranch_scc1 m_ok181
    s_sleep 8
    s_lshr_b32 s90, s96, 1
    s_lshl_b32 s90, s90, 8
    s_add_u32 s90, s90, 117452800
    buffer_load_dwordx2 v[4:5], v10, s[8:11], s90 offen sc1
    s_waitcnt vmcnt(0)
    s_branch m_spin180
m_ok181:
    s_mov_b32 s56, s69
    s_mov_b32 s67, 20
    s_branch m_l3152
m_n179:
    s_cmp_lg_u32 s64, 20
    s_cbranch_scc1 m_n182
    s_mov_b32 s24, s50
    s_mov_b32 s25, s51
    s_mov_b32 s26, 2097152
    s_lshl_b32 s57, s97, 8
    s_mov_b32 s67, 24
    s_branch m_l3152
m_n182:
    s_cmp_lg_u32 s64, 24
    s_cbranch_scc1 m_n183
    s_lshl_b32 s90, s96, 3
    s_add_u32 s90, s90, s97
    s_lshl_b32 s90, s90, 15
    s_lshl_b32 s91, s16, 13
    s_add_u32 s90, s90, s91
    s_add_u32 s70, s90, 100663296
    s_nop 3
    v_cvt_pk_bf16_f32 v128, v64, v65
    v_cvt_pk_bf16_f32 v129, v66, v67
    v_cvt_pk_bf16_f32 v130, v68, v69
    v_cvt_pk_bf16_f32 v131, v70, v71
    v_cvt_pk_bf16_f32 v132, v72, v73
    v_cvt_pk_bf16_f32 v133, v74, v75
    v_cvt_pk_bf16_f32 v134, v76, v77
    v_cvt_pk_bf16_f32 v135, v78, v79
    v_cvt_pk_bf16_f32 v136, v80, v81
    v_cvt_pk_bf16_f32 v137, v82, v83
    v_cvt_pk_bf16_f32 v138, v84, v85
    v_cvt_pk_bf16_f32 v139, v86, v87
    v_cvt_pk_bf16_f32 v140, v88, v89
    v_cvt_pk_bf16_f32 v141, v90, v91
    v_cvt_pk_bf16_f32 v142, v92, v93
    v_cvt_pk_bf16_f32 v143, v94, v95
    v_cvt_pk_bf16_f32 v144, v96, v97
    v_cvt_pk_bf16_f32 v145, v98, v99
    v_cvt_pk_bf16_f32 v146, v100, v101
    v_cvt_pk_bf16_f32 v147, v102, v103
    v_cvt_pk_bf16_f32 v148, v104, v105
    v_cvt_pk_bf16_f32 v149, v106, v107
    v_cvt_pk_bf16_f32 v150, v108, v109
    v_cvt_pk_bf16_f32 v151, v110, v111
    v_cvt_pk_bf16_f32 v152, v112, v113
    v_cvt_pk_bf16_f32 v153, v114, v115
    v_cvt_pk_bf16_f32 v154, v116, v117
    v_cvt_pk_bf16_f32 v155, v118, v119
    v_cvt_pk_bf16_f32 v156, v120, v121
    v_cvt_pk_bf16_f32 v157, v122, v123
    v_cvt_pk_bf16_f32 v158, v124, v125
    v_cvt_pk_bf16_f32 v159, v126, v127
    v_mov_b64 v[64:65], 0
    v_mov_b64 v[66:67], 0
    v_mov_b64 v[68:69], 0
    v_mov_b64 v[70:71], 0
    v_mov_b64 v[72:73], 0
    v_mov_b64 v[74:75], 0
    v_mov_b64 v[76:77], 0
    v_mov_b64 v[78:79], 0
    v_mov_b64 v[80:81], 0
    v_mov_b64 v[82:83], 0
    v_mov_b64 v[84:85], 0
    v_mov_b64 v[86:87], 0
    v_mov_b64 v[88:89], 0
    v_mov_b64 v[90:91], 0
    v_mov_b64 v[92:93], 0
    v_mov_b64 v[94:95], 0
    v_mov_b64 v[96:97], 0
    v_mov_b64 v[98:99], 0
    v_mov_b64 v[100:101], 0
    v_mov_b64 v[102:103], 0
    v_mov_b64 v[104:105], 0
    v_mov_b64 v[106:107], 0
    v_mov_b64 v[108:109], 0
    v_mov_b64 v[110:111], 0
    v_mov_b64 v[112:113], 0
    v_mov_b64 v[114:115], 0
    v_mov_b64 v[116:117], 0
    v_mov_b64 v[118:119], 0
    v_mov_b64 v[120:121], 0
    v_mov_b64 v[122:123], 0
    v_mov_b64 v[124:125], 0
    v_mov_b64 v[126:127], 0
    s_nop 1
    s_waitcnt lgkmcnt(9)
    v_mfma_f32_16x16x32_bf16 v[64:67], a[16:19], a[0:3], v[64:67]
    s_add_u32 m0, s59, 16384
    ds_read_b128 a[32:35], v6 offset:8192
    s_waitcnt lgkmcnt(9)
    v_mfma_f32_16x16x32_bf16 v[72:75], a[16:19], a[4:7], v[72:75]
    ds_read_b64_tr_b16 a[48:49], v12 offset:8192
    buffer_load_dwordx4 v16, s[24:27], s57 offen offset:0 sc1 lds
    s_waitcnt lgkmcnt(9)
    v_mfma_f32_16x16x32_bf16 v[80:83], a[16:19], a[8:11], v[80:83]
    s_add_u32 s59, s58, s60
    ds_read_b64_tr_b16 a[50:51], v12 offset:12288
    s_waitcnt lgkmcnt(9)
    v_mfma_f32_16x16x32_bf16 v[88:91], a[16:19], a[12:15], v[88:91]
    s_add_u32 s58, s58, 32768
    ds_read_b128 a[36:39], v6 offset:9216
    s_waitcnt lgkmcnt(8)
    v_mfma_f32_16x16x32_bf16 v[68:71], a[20:23], a[0:3], v[68:71]
    s_cmp_ge_u32 s58, 163840
    ds_read_b128 a[40:43], v6 offset:10240
    v_mfma_f32_16x16x32_bf16 v[76:79], a[20:23], a[4:7], v[76:79]
    ds_read_b128 a[44:47], v6 offset:11264
    buffer_load_dwordx4 v17, s[24:27], s57 offen offset:1024 sc1 lds
    v_mfma_f32_16x16x32_bf16 v[84:87], a[20:23], a[8:11], v[84:87]
    s_cselect_b32 s66, 4294836224, s100
    ds_read_b64_tr_b16 a[52:53], v13 offset:8192
    v_mfma_f32_16x16x32_bf16 v[92:95], a[20:23], a[12:15], v[92:95]
    s_cselect_b32 s58, 0, s58
    ds_read_b64_tr_b16 a[54:55], v13 offset:12288
    s_waitcnt lgkmcnt(10)
    v_mfma_f32_16x16x32_bf16 v[96:99], a[24:27], a[0:3], v[96:99]
    ds_read_b64_tr_b16 a[56:57], v14 offset:8192
    v_mfma_f32_16x16x32_bf16 v[104:107], a[24:27], a[4:7], v[104:107]
    ds_read_b64_tr_b16 a[58:59], v14 offset:12288
    buffer_load_dwordx4 v18, s[24:27], s57 offen offset:2048 sc1 lds
    v_mfma_f32_16x16x32_bf16 v[112:115], a[24:27], a[8:11], v[112:115]
    ds_read_b64_tr_b16 a[60:61], v15 offset:8192
    v_mfma_f32_16x16x32_bf16 v[120:123], a[24:27], a[12:15], v[120:123]
    ds_read_b64_tr_b16 a[62:63], v15 offset:12288
    buffer_store_dwordx4 v[128:131], v2, s[8:11], s70 offen offset:0 sc1
    s_waitcnt lgkmcnt(12)
    v_mfma_f32_16x16x32_bf16 v[100:103], a[28:31], a[0:3], v[100:103]
    v_add_u32 v6, s66, v6
    v_add_u32 v12, s66, v12
    v_mfma_f32_16x16x32_bf16 v[108:111], a[28:31], a[4:7], v[108:111]
    buffer_load_dwordx4 v19, s[24:27], s57 offen offset:3072 sc1 lds
    v_mfma_f32_16x16x32_bf16 v[116:119], a[28:31], a[8:11], v[116:119]
    s_add_u32 s57, s57, 131072
    v_add_u32 v13, s66, v13
    v_add_u32 v14, s66, v14
    v_mfma_f32_16x16x32_bf16 v[124:127], a[28:31], a[12:15], v[124:127]
    s_mov_b32 m0, s59
    v_add_u32 v15, s66, v15
    s_waitcnt vmcnt(24) lgkmcnt(0)
    v_mfma_f32_16x16x32_bf16 v[64:67], a[48:51], a[32:35], v[64:67]
    s_barrier
    v_mfma_f32_16x16x32_bf16 v[72:75], a[48:51], a[36:39], v[72:75]
    ds_read_b128 a[0:3], v6 offset:0
    buffer_load_dwordx4 v2, s[36:39], s56 offen offset:0 sc1 lds
    v_mfma_f32_16x16x32_bf16 v[80:83], a[48:51], a[40:43], v[80:83]
    ds_read_b64_tr_b16 a[16:17], v12 offset:0
    v_mfma_f32_16x16x32_bf16 v[88:91], a[48:51], a[44:47], v[88:91]
    ds_read_b64_tr_b16 a[18:19], v12 offset:4096
    v_mfma_f32_16x16x32_bf16 v[68:71], a[52:55], a[32:35], v[68:71]
    ds_read_b128 a[4:7], v6 offset:1024
    v_mfma_f32_16x16x32_bf16 v[76:79], a[52:55], a[36:39], v[76:79]
    ds_read_b128 a[8:11], v6 offset:2048
    buffer_load_dwordx4 v2, s[36:39], s56 offen offset:1024 sc1 lds
    v_mfma_f32_16x16x32_bf16 v[84:87], a[52:55], a[40:43], v[84:87]
    ds_read_b128 a[12:15], v6 offset:3072
    v_mfma_f32_16x16x32_bf16 v[92:95], a[52:55], a[44:47], v[92:95]
    ds_read_b64_tr_b16 a[20:21], v13 offset:0
    v_mfma_f32_16x16x32_bf16 v[96:99], a[56:59], a[32:35], v[96:99]
    ds_read_b64_tr_b16 a[22:23], v13 offset:4096
    v_mfma_f32_16x16x32_bf16 v[104:107], a[56:59], a[36:39], v[104:107]
    ds_read_b64_tr_b16 a[24:25], v14 offset:0
    buffer_load_dwordx4 v2, s[36:39], s56 offen offset:2048 sc1 lds
    v_mfma_f32_16x16x32_bf16 v[112:115], a[56:59], a[40:43], v[112:115]
    ds_read_b64_tr_b16 a[26:27], v14 offset:4096
    v_mfma_f32_16x16x32_bf16 v[120:123], a[56:59], a[44:47], v[120:123]
    ds_read_b64_tr_b16 a[28:29], v15 offset:0
    buffer_store_dwordx4 v[132:135], v2, s[8:11], s70 offen offset:1024 sc1
    v_mfma_f32_16x16x32_bf16 v[100:103], a[60:63], a[32:35], v[100:103]
    s_add_u32 s64, s64, 1
    ds_read_b64_tr_b16 a[30:31], v15 offset:4096
    v_mfma_f32_16x16x32_bf16 v[108:111], a[60:63], a[36:39], v[108:111]
    buffer_load_dwordx4 v2, s[36:39], s56 offen offset:3072 sc1 lds
    v_mfma_f32_16x16x32_bf16 v[116:119], a[60:63], a[40:43], v[116:119]
    s_add_u32 s56, s56, 262144
    v_mfma_f32_16x16x32_bf16 v[124:127], a[60:63], a[44:47], v[124:127]
    s_waitcnt lgkmcnt(9)
    v_mfma_f32_16x16x32_bf16 v[64:67], a[16:19], a[0:3], v[64:67]
    s_add_u32 m0, s59, 16384
    ds_read_b128 a[32:35], v6 offset:8192
    s_waitcnt lgkmcnt(9)
    v_mfma_f32_16x16x32_bf16 v[72:75], a[16:19], a[4:7], v[72:75]
    ds_read_b64_tr_b16 a[48:49], v12 offset:8192
    buffer_load_dwordx4 v16, s[24:27], s57 offen offset:0 sc1 lds
    s_waitcnt lgkmcnt(9)
    v_mfma_f32_16x16x32_bf16 v[80:83], a[16:19], a[8:11], v[80:83]
    s_add_u32 s59, s58, s60
    ds_read_b64_tr_b16 a[50:51], v12 offset:12288
    s_waitcnt lgkmcnt(9)
    v_mfma_f32_16x16x32_bf16 v[88:91], a[16:19], a[12:15], v[88:91]
    s_add_u32 s58, s58, 32768
    ds_read_b128 a[36:39], v6 offset:9216
    s_waitcnt lgkmcnt(8)
    v_mfma_f32_16x16x32_bf16 v[68:71], a[20:23], a[0:3], v[68:71]
    s_cmp_ge_u32 s58, 163840
    ds_read_b128 a[40:43], v6 offset:10240
    v_mfma_f32_16x16x32_bf16 v[76:79], a[20:23], a[4:7], v[76:79]
    ds_read_b128 a[44:47], v6 offset:11264
    buffer_load_dwordx4 v17, s[24:27], s57 offen offset:1024 sc1 lds
    v_mfma_f32_16x16x32_bf16 v[84:87], a[20:23], a[8:11], v[84:87]
    s_cselect_b32 s66, 4294836224, s100
    ds_read_b64_tr_b16 a[52:53], v13 offset:8192
    v_mfma_f32_16x16x32_bf16 v[92:95], a[20:23], a[12:15], v[92:95]
    s_cselect_b32 s58, 0, s58
    ds_read_b64_tr_b16 a[54:55], v13 offset:12288
    s_waitcnt lgkmcnt(10)
    v_mfma_f32_16x16x32_bf16 v[96:99], a[24:27], a[0:3], v[96:99]
    ds_read_b64_tr_b16 a[56:57], v14 offset:8192
    v_mfma_f32_16x16x32_bf16 v[104:107], a[24:27], a[4:7], v[104:107]
    ds_read_b64_tr_b16 a[58:59], v14 offset:12288
    buffer_load_dwordx4 v18, s[24:27], s57 offen offset:2048 sc1 lds
    v_mfma_f32_16x16x32_bf16 v[112:115], a[24:27], a[8:11], v[112:115]
    ds_read_b64_tr_b16 a[60:61], v15 offset:8192
    v_mfma_f32_16x16x32_bf16 v[120:123], a[24:27], a[12:15], v[120:123]
    ds_read_b64_tr_b16 a[62:63], v15 offset:12288
    buffer_store_dwordx4 v[136:139], v2, s[8:11], s70 offen offset:2048 sc1
    s_waitcnt lgkmcnt(12)
    v_mfma_f32_16x16x32_bf16 v[100:103], a[28:31], a[0:3], v[100:103]
    v_add_u32 v6, s66, v6
    v_add_u32 v12, s66, v12
    v_mfma_f32_16x16x32_bf16 v[108:111], a[28:31], a[4:7], v[108:111]
    buffer_load_dwordx4 v19, s[24:27], s57 offen offset:3072 sc1 lds
    v_mfma_f32_16x16x32_bf16 v[116:119], a[28:31], a[8:11], v[116:119]
    s_add_u32 s57, s57, 131072
    v_add_u32 v13, s66, v13
    v_add_u32 v14, s66, v14
    v_mfma_f32_16x16x32_bf16 v[124:127], a[28:31], a[12:15], v[124:127]
    s_mov_b32 m0, s59
    v_add_u32 v15, s66, v15
    s_waitcnt vmcnt(24) lgkmcnt(0)
    v_mfma_f32_16x16x32_bf16 v[64:67], a[48:51], a[32:35], v[64:67]
    s_barrier
    v_mfma_f32_16x16x32_bf16 v[72:75], a[48:51], a[36:39], v[72:75]
    ds_read_b128 a[0:3], v6 offset:0
    buffer_load_dwordx4 v2, s[36:39], s56 offen offset:0 sc1 lds
    v_mfma_f32_16x16x32_bf16 v[80:83], a[48:51], a[40:43], v[80:83]
    ds_read_b64_tr_b16 a[16:17], v12 offset:0
    v_mfma_f32_16x16x32_bf16 v[88:91], a[48:51], a[44:47], v[88:91]
    ds_read_b64_tr_b16 a[18:19], v12 offset:4096
    v_mfma_f32_16x16x32_bf16 v[68:71], a[52:55], a[32:35], v[68:71]
    ds_read_b128 a[4:7], v6 offset:1024
    v_mfma_f32_16x16x32_bf16 v[76:79], a[52:55], a[36:39], v[76:79]
    ds_read_b128 a[8:11], v6 offset:2048
    buffer_load_dwordx4 v2, s[36:39], s56 offen offset:1024 sc1 lds
    v_mfma_f32_16x16x32_bf16 v[84:87], a[52:55], a[40:43], v[84:87]
    ds_read_b128 a[12:15], v6 offset:3072
    v_mfma_f32_16x16x32_bf16 v[92:95], a[52:55], a[44:47], v[92:95]
    ds_read_b64_tr_b16 a[20:21], v13 offset:0
    v_mfma_f32_16x16x32_bf16 v[96:99], a[56:59], a[32:35], v[96:99]
    ds_read_b64_tr_b16 a[22:23], v13 offset:4096
    v_mfma_f32_16x16x32_bf16 v[104:107], a[56:59], a[36:39], v[104:107]
    ds_read_b64_tr_b16 a[24:25], v14 offset:0
    buffer_load_dwordx4 v2, s[36:39], s56 offen offset:2048 sc1 lds
    v_mfma_f32_16x16x32_bf16 v[112:115], a[56:59], a[40:43], v[112:115]
    ds_read_b64_tr_b16 a[26:27], v14 offset:4096
    v_mfma_f32_16x16x32_bf16 v[120:123], a[56:59], a[44:47], v[120:123]
    ds_read_b64_tr_b16 a[28:29], v15 offset:0
    buffer_store_dwordx4 v[140:143], v2, s[8:11], s70 offen offset:3072 sc1
    s_add_u32 s70, s70, 4096
    v_mfma_f32_16x16x32_bf16 v[100:103], a[60:63], a[32:35], v[100:103]
    s_add_u32 s64, s64, 1
    ds_read_b64_tr_b16 a[30:31], v15 offset:4096
    v_mfma_f32_16x16x32_bf16 v[108:111], a[60:63], a[36:39], v[108:111]
    buffer_load_dwordx4 v2, s[36:39], s56 offen offset:3072 sc1 lds
    v_mfma_f32_16x16x32_bf16 v[116:119], a[60:63], a[40:43], v[116:119]
    s_add_u32 s56, s56, 262144
    v_mfma_f32_16x16x32_bf16 v[124:127], a[60:63], a[44:47], v[124:127]
    s_waitcnt lgkmcnt(9)
    v_mfma_f32_16x16x32_bf16 v[64:67], a[16:19], a[0:3], v[64:67]
    s_add_u32 m0, s59, 16384
    ds_read_b128 a[32:35], v6 offset:8192
    s_waitcnt lgkmcnt(9)
    v_mfma_f32_16x16x32_bf16 v[72:75], a[16:19], a[4:7], v[72:75]
    ds_read_b64_tr_b16 a[48:49], v12 offset:8192
    buffer_load_dwordx4 v16, s[24:27], s57 offen offset:0 sc1 lds
    s_waitcnt lgkmcnt(9)
    v_mfma_f32_16x16x32_bf16 v[80:83], a[16:19], a[8:11], v[80:83]
    s_add_u32 s59, s58, s60
    ds_read_b64_tr_b16 a[50:51], v12 offset:12288
    s_waitcnt lgkmcnt(9)
    v_mfma_f32_16x16x32_bf16 v[88:91], a[16:19], a[12:15], v[88:91]
    s_add_u32 s58, s58, 32768
    ds_read_b128 a[36:39], v6 offset:9216
    s_waitcnt lgkmcnt(8)
    v_mfma_f32_16x16x32_bf16 v[68:71], a[20:23], a[0:3], v[68:71]
    s_cmp_ge_u32 s58, 163840
    ds_read_b128 a[40:43], v6 offset:10240
    v_mfma_f32_16x16x32_bf16 v[76:79], a[20:23], a[4:7], v[76:79]
    ds_read_b128 a[44:47], v6 offset:11264
    buffer_load_dwordx4 v17, s[24:27], s57 offen offset:1024 sc1 lds
    v_mfma_f32_16x16x32_bf16 v[84:87], a[20:23], a[8:11], v[84:87]
    s_cselect_b32 s66, 4294836224, s100
    ds_read_b64_tr_b16 a[52:53], v13 offset:8192
    v_mfma_f32_16x16x32_bf16 v[92:95], a[20:23], a[12:15], v[92:95]
    s_cselect_b32 s58, 0, s58
    ds_read_b64_tr_b16 a[54:55], v13 offset:12288
    s_waitcnt lgkmcnt(10)
    v_mfma_f32_16x16x32_bf16 v[96:99], a[24:27], a[0:3], v[96:99]
    ds_read_b64_tr_b16 a[56:57], v14 offset:8192
    v_mfma_f32_16x16x32_bf16 v[104:107], a[24:27], a[4:7], v[104:107]
    ds_read_b64_tr_b16 a[58:59], v14 offset:12288
    buffer_load_dwordx4 v18, s[24:27], s57 offen offset:2048 sc1 lds
    v_mfma_f32_16x16x32_bf16 v[112:115], a[24:27], a[8:11], v[112:115]
    ds_read_b64_tr_b16 a[60:61], v15 offset:8192
    v_mfma_f32_16x16x32_bf16 v[120:123], a[24:27], a[12:15], v[120:123]
    ds_read_b64_tr_b16 a[62:63], v15 offset:12288
    buffer_store_dwordx4 v[144:147], v2, s[8:11], s70 offen offset:0 sc1
    s_waitcnt lgkmcnt(12)
    v_mfma_f32_16x16x32_bf16 v[100:103], a[28:31], a[0:3], v[100:103]
    v_add_u32 v6, s66, v6
    v_add_u32 v12, s66, v12
    v_mfma_f32_16x16x32_bf16 v[108:111], a[28:31], a[4:7], v[108:111]
    buffer_load_dwordx4 v19, s[24:27], s57 offen offset:3072 sc1 lds
    v_mfma_f32_16x16x32_bf16 v[116:119], a[28:31], a[8:11], v[116:119]
    s_add_u32 s57, s57, 131072
    v_add_u32 v13, s66, v13
    v_add_u32 v14, s66, v14
    v_mfma_f32_16x16x32_bf16 v[124:127], a[28:31], a[12:15], v[124:127]
    s_mov_b32 m0, s59
    v_add_u32 v15, s66, v15
    s_waitcnt vmcnt(24) lgkmcnt(0)
    v_mfma_f32_16x16x32_bf16 v[64:67], a[48:51], a[32:35], v[64:67]
    s_barrier
    v_mfma_f32_16x16x32_bf16 v[72:75], a[48:51], a[36:39], v[72:75]
    ds_read_b128 a[0:3], v6 offset:0
    buffer_load_dwordx4 v2, s[36:39], s56 offen offset:0 sc1 lds
    v_mfma_f32_16x16x32_bf16 v[80:83], a[48:51], a[40:43], v[80:83]
    ds_read_b64_tr_b16 a[16:17], v12 offset:0
    v_mfma_f32_16x16x32_bf16 v[88:91], a[48:51], a[44:47], v[88:91]
    ds_read_b64_tr_b16 a[18:19], v12 offset:4096
    v_mfma_f32_16x16x32_bf16 v[68:71], a[52:55], a[32:35], v[68:71]
    ds_read_b128 a[4:7], v6 offset:1024
    v_mfma_f32_16x16x32_bf16 v[76:79], a[52:55], a[36:39], v[76:79]
    ds_read_b128 a[8:11], v6 offset:2048
    buffer_load_dwordx4 v2, s[36:39], s56 offen offset:1024 sc1 lds
    v_mfma_f32_16x16x32_bf16 v[84:87], a[52:55], a[40:43], v[84:87]
    ds_read_b128 a[12:15], v6 offset:3072
    v_mfma_f32_16x16x32_bf16 v[92:95], a[52:55], a[44:47], v[92:95]
    ds_read_b64_tr_b16 a[20:21], v13 offset:0
    v_mfma_f32_16x16x32_bf16 v[96:99], a[56:59], a[32:35], v[96:99]
    ds_read_b64_tr_b16 a[22:23], v13 offset:4096
    v_mfma_f32_16x16x32_bf16 v[104:107], a[56:59], a[36:39], v[104:107]
    ds_read_b64_tr_b16 a[24:25], v14 offset:0
    buffer_load_dwordx4 v2, s[36:39], s56 offen offset:2048 sc1 lds
    v_mfma_f32_16x16x32_bf16 v[112:115], a[56:59], a[40:43], v[112:115]
    ds_read_b64_tr_b16 a[26:27], v14 offset:4096
    v_mfma_f32_16x16x32_bf16 v[120:123], a[56:59], a[44:47], v[120:123]
    ds_read_b64_tr_b16 a[28:29], v15 offset:0
    buffer_store_dwordx4 v[148:151], v2, s[8:11], s70 offen offset:1024 sc1
    v_mfma_f32_16x16x32_bf16 v[100:103], a[60:63], a[32:35], v[100:103]
    s_add_u32 s64, s64, 1
    ds_read_b64_tr_b16 a[30:31], v15 offset:4096
    v_mfma_f32_16x16x32_bf16 v[108:111], a[60:63], a[36:39], v[108:111]
    buffer_load_dwordx4 v2, s[36:39], s56 offen offset:3072 sc1 lds
    v_mfma_f32_16x16x32_bf16 v[116:119], a[60:63], a[40:43], v[116:119]
    s_add_u32 s56, s56, 262144
    v_mfma_f32_16x16x32_bf16 v[124:127], a[60:63], a[44:47], v[124:127]
    s_waitcnt lgkmcnt(9)
    v_mfma_f32_16x16x32_bf16 v[64:67], a[16:19], a[0:3], v[64:67]
    s_add_u32 m0, s59, 16384
    ds_read_b128 a[32:35], v6 offset:8192
    s_waitcnt lgkmcnt(9)
    v_mfma_f32_16x16x32_bf16 v[72:75], a[16:19], a[4:7], v[72:75]
    ds_read_b64_tr_b16 a[48:49], v12 offset:8192
    buffer_load_dwordx4 v16, s[24:27], s57 offen offset:0 sc1 lds
    s_waitcnt lgkmcnt(9)
    v_mfma_f32_16x16x32_bf16 v[80:83], a[16:19], a[8:11], v[80:83]
    s_add_u32 s59, s58, s60
    ds_read_b64_tr_b16 a[50:51], v12 offset:12288
    s_waitcnt lgkmcnt(9)
    v_mfma_f32_16x16x32_bf16 v[88:91], a[16:19], a[12:15], v[88:91]
    s_add_u32 s58, s58, 32768
    ds_read_b128 a[36:39], v6 offset:9216
    s_waitcnt lgkmcnt(8)
    v_mfma_f32_16x16x32_bf16 v[68:71], a[20:23], a[0:3], v[68:71]
    s_cmp_ge_u32 s58, 163840
    ds_read_b128 a[40:43], v6 offset:10240
    v_mfma_f32_16x16x32_bf16 v[76:79], a[20:23], a[4:7], v[76:79]
    ds_read_b128 a[44:47], v6 offset:11264
    buffer_load_dwordx4 v17, s[24:27], s57 offen offset:1024 sc1 lds
    v_mfma_f32_16x16x32_bf16 v[84:87], a[20:23], a[8:11], v[84:87]
    s_cselect_b32 s66, 4294836224, s100
    ds_read_b64_tr_b16 a[52:53], v13 offset:8192
    v_mfma_f32_16x16x32_bf16 v[92:95], a[20:23], a[12:15], v[92:95]
    s_cselect_b32 s58, 0, s58
    ds_read_b64_tr_b16 a[54:55], v13 offset:12288
    s_waitcnt lgkmcnt(10)
    v_mfma_f32_16x16x32_bf16 v[96:99], a[24:27], a[0:3], v[96:99]
    ds_read_b64_tr_b16 a[56:57], v14 offset:8192
    v_mfma_f32_16x16x32_bf16 v[104:107], a[24:27], a[4:7], v[104:107]
    ds_read_b64_tr_b16 a[58:59], v14 offset:12288
    buffer_load_dwordx4 v18, s[24:27], s57 offen offset:2048 sc1 lds
    v_mfma_f32_16x16x32_bf16 v[112:115], a[24:27], a[8:11], v[112:115]
    ds_read_b64_tr_b16 a[60:61], v15 offset:8192
    v_mfma_f32_16x16x32_bf16 v[120:123], a[24:27], a[12:15], v[120:123]
    ds_read_b64_tr_b16 a[62:63], v15 offset:12288
    buffer_store_dwordx4 v[152:155], v2, s[8:11], s70 offen offset:2048 sc1
    s_waitcnt lgkmcnt(12)
    v_mfma_f32_16x16x32_bf16 v[100:103], a[28:31], a[0:3], v[100:103]
    v_add_u32 v6, s66, v6
    v_add_u32 v12, s66, v12
    v_mfma_f32_16x16x32_bf16 v[108:111], a[28:31], a[4:7], v[108:111]
    buffer_load_dwordx4 v19, s[24:27], s57 offen offset:3072 sc1 lds
    v_mfma_f32_16x16x32_bf16 v[116:119], a[28:31], a[8:11], v[116:119]
    s_add_u32 s57, s57, 131072
    v_add_u32 v13, s66, v13
    v_add_u32 v14, s66, v14
    v_mfma_f32_16x16x32_bf16 v[124:127], a[28:31], a[12:15], v[124:127]
    s_mov_b32 m0, s59
    v_add_u32 v15, s66, v15
    s_waitcnt vmcnt(24) lgkmcnt(0)
    v_mfma_f32_16x16x32_bf16 v[64:67], a[48:51], a[32:35], v[64:67]
    s_barrier
    v_mfma_f32_16x16x32_bf16 v[72:75], a[48:51], a[36:39], v[72:75]
    ds_read_b128 a[0:3], v6 offset:0
    buffer_load_dwordx4 v2, s[36:39], s56 offen offset:0 sc1 lds
    v_mfma_f32_16x16x32_bf16 v[80:83], a[48:51], a[40:43], v[80:83]
    ds_read_b64_tr_b16 a[16:17], v12 offset:0
    v_mfma_f32_16x16x32_bf16 v[88:91], a[48:51], a[44:47], v[88:91]
    ds_read_b64_tr_b16 a[18:19], v12 offset:4096
    v_mfma_f32_16x16x32_bf16 v[68:71], a[52:55], a[32:35], v[68:71]
    ds_read_b128 a[4:7], v6 offset:1024
    v_mfma_f32_16x16x32_bf16 v[76:79], a[52:55], a[36:39], v[76:79]
    ds_read_b128 a[8:11], v6 offset:2048
    buffer_load_dwordx4 v2, s[36:39], s56 offen offset:1024 sc1 lds
    v_mfma_f32_16x16x32_bf16 v[84:87], a[52:55], a[40:43], v[84:87]
    ds_read_b128 a[12:15], v6 offset:3072
    v_mfma_f32_16x16x32_bf16 v[92:95], a[52:55], a[44:47], v[92:95]
    ds_read_b64_tr_b16 a[20:21], v13 offset:0
    v_mfma_f32_16x16x32_bf16 v[96:99], a[56:59], a[32:35], v[96:99]
    ds_read_b64_tr_b16 a[22:23], v13 offset:4096
    v_mfma_f32_16x16x32_bf16 v[104:107], a[56:59], a[36:39], v[104:107]
    ds_read_b64_tr_b16 a[24:25], v14 offset:0
    buffer_load_dwordx4 v2, s[36:39], s56 offen offset:2048 sc1 lds
    v_mfma_f32_16x16x32_bf16 v[112:115], a[56:59], a[40:43], v[112:115]
    ds_read_b64_tr_b16 a[26:27], v14 offset:4096
    v_mfma_f32_16x16x32_bf16 v[120:123], a[56:59], a[44:47], v[120:123]
    ds_read_b64_tr_b16 a[28:29], v15 offset:0
    buffer_store_dwordx4 v[156:159], v2, s[8:11], s70 offen offset:3072 sc1
    s_add_u32 s70, s70, 4096
    v_mfma_f32_16x16x32_bf16 v[100:103], a[60:63], a[32:35], v[100:103]
    s_add_u32 s64, s64, 1
    ds_read_b64_tr_b16 a[30:31], v15 offset:4096
    v_mfma_f32_16x16x32_bf16 v[108:111], a[60:63], a[36:39], v[108:111]
    buffer_load_dwordx4 v2, s[36:39], s56 offen offset:3072 sc1 lds
    v_mfma_f32_16x16x32_bf16 v[116:119], a[60:63], a[40:43], v[116:119]
    s_add_u32 s56, s56, 262144
    v_mfma_f32_16x16x32_bf16 v[124:127], a[60:63], a[44:47], v[124:127]
    s_mov_b32 s67, 32
    s_branch m_l3152
m_n183:
    s_cmp_lg_u32 s64, 32
    s_cbranch_scc1 m_n184
    s_lshl_b32 s91, s96, 3
    s_add_u32 s91, s91, s97
    s_lshl_b32 s91, s91, 7
    s_add_u32 s91, s91, 16384
    s_cmp_lg_u32 s16, 0
    s_cbranch_scc1 m_np185
    v_mov_b32 v60, s4
    v_mov_b32 v61, s5
    s_add_u32 s90, s91, 117440512
    s_mov_b64 exec, 1
    buffer_store_dwordx2 v[60:61], off, s[8:11], s90 sc1
    s_mov_b64 exec, -1
m_np185:
    s_mov_b32 s67, 35
    s_branch m_l3152
m_n184:
    s_cmp_lg_u32 s64, 35
    s_cbranch_scc1 m_n186
    s_mov_b32 s38, 0
    s_mov_b32 s67, 40
    s_branch m_l3152
m_n186:
    s_branch m_l3x154
m_l3c155:
    s_mov_b32 s67, 34
    s_cmp_lt_u32 s64, 34
    s_cbranch_scc1 m_l3n156
    s_cmp_lg_u32 s64, 34
    s_cbranch_scc1 m_n188
    s_mov_b32 s68, 1000
    s_mov_b32 s67, 35
    s_branch m_l3152
m_n188:
    s_cmp_lg_u32 s64, 35
    s_cbranch_scc1 m_n189
    s_mov_b32 s38, 0
    s_lshl_b32 s91, s96, 3
    s_add_u32 s91, s91, s97
    s_lshl_b32 s91, s91, 7
    s_add_u32 s91, s91, 16384
    s_add_u32 s52, s91, 117440512
    buffer_load_dwordx2 v[4:5], off, s[8:11], s52 sc1
    s_mov_b32 s67, 36
    s_branch m_l3152
m_n189:
    s_cmp_lg_u32 s64, 36
    s_cbranch_scc1 m_n190
    s_mov_b32 s26, 0
    s_mov_b32 s67, 37
    s_branch m_l3152
m_n190:
    s_cmp_lg_u32 s64, 37
    s_cbranch_scc1 m_n191
    s_waitcnt vmcnt(16)
    s_mov_b32 s3, 262144
m_spin192:
    v_cmp_ne_u64 s[76:77], s[4:5], v[4:5]
    s_nop 3
    s_cmp_eq_u64 s[76:77], 0
    s_cbranch_scc1 m_ok193
    s_sub_u32 s3, s3, 1
    s_cbranch_scc1 m_ok193
    s_sleep 8
    buffer_load_dwordx2 v[4:5], off, s[8:11], s52 sc1
    s_waitcnt vmcnt(0)
    s_branch m_spin192
m_ok193:
    s_lshl_b32 s90, s96, 3
    s_add_u32 s90, s90, s97
    s_lshl_b32 s90, s90, 15
    s_lshl_b32 s91, s16, 13
    s_add_u32 s90, s90, s91
    s_add_u32 s70, s90, 100663296
    buffer_load_dwordx4 v[128:131], v2, s[8:11], s70 offen offset:0 sc1
    buffer_load_dwordx4 v[132:135], v2, s[8:11], s70 offen offset:1024 sc1
    buffer_load_dwordx4 v[136:139], v2, s[8:11], s70 offen offset:2048 sc1
    buffer_load_dwordx4 v[140:143], v2, s[8:11], s70 offen offset:3072 sc1
    s_add_u32 s70, s70, 4096
    buffer_load_dwordx4 v[144:147], v2, s[8:11], s70 offen offset:0 sc1
    buffer_load_dwordx4 v[148:151], v2, s[8:11], s70 offen offset:1024 sc1
    buffer_load_dwordx4 v[152:155], v2, s[8:11], s70 offen offset:2048 sc1
    buffer_load_dwordx4 v[156:159], v2, s[8:11], s70 offen offset:3072 sc1
    s_mov_b32 s67, 40
    s_branch m_l3152
m_n191:
    s_branch m_l3x154
m_o1176:
    s_and_b32 s91, s2, 7
    s_lshl_b32 s91, s91, 5
    s_lshr_b32 s92, s2, 3
    s_add_u32 s91, s91, s92
    s_lshl_b32 s91, s91, 3
    s_add_u32 s91, s91, 12288
    s_cmp_lg_u32 s16, 0
    s_cbranch_scc1 m_np195
    v_mov_b32 v60, s4
    v_mov_b32 v61, s5
    s_add_u32 s90, s91, 117440512
    s_mov_b64 exec, 1
    buffer_store_dwordx2 v[60:61], off, s[8:11], s90 sc1
    s_mov_b64 exec, -1
m_np195:
    s_branch m_o2177
m_l3n156:
    s_sub_u32 s90, s68, 5
    s_min_u32 s67, s67, s90
    s_branch m_l3152
m_l3x154:
    s_cmp_eq_u32 s95, 1
    s_cbranch_scc1 m_noadd196
    s_waitcnt vmcnt(0)
    v_lshlrev_b32 v160, 16, v128
    v_and_b32 v161, 0xffff0000, v128
    v_lshlrev_b32 v162, 16, v129
    v_and_b32 v163, 0xffff0000, v129
    v_lshlrev_b32 v164, 16, v130
    v_and_b32 v165, 0xffff0000, v130
    v_lshlrev_b32 v166, 16, v131
    v_and_b32 v167, 0xffff0000, v131
    v_lshlrev_b32 v168, 16, v132
    v_and_b32 v169, 0xffff0000, v132
    v_lshlrev_b32 v170, 16, v133
    v_and_b32 v171, 0xffff0000, v133
    v_lshlrev_b32 v172, 16, v134
    v_and_b32 v173, 0xffff0000, v134
    v_lshlrev_b32 v174, 16, v135
    v_and_b32 v175, 0xffff0000, v135
    v_lshlrev_b32 v176, 16, v136
    v_and_b32 v177, 0xffff0000, v136
    v_lshlrev_b32 v178, 16, v137
    v_and_b32 v179, 0xffff0000, v137
    v_lshlrev_b32 v180, 16, v138
    v_and_b32 v181, 0xffff0000, v138
    v_lshlrev_b32 v182, 16, v139
    v_and_b32 v183, 0xffff0000, v139
    v_lshlrev_b32 v184, 16, v140
    v_and_b32 v185, 0xffff0000, v140
    v_lshlrev_b32 v186, 16, v141
    v_and_b32 v187, 0xffff0000, v141
    v_lshlrev_b32 v188, 16, v142
    v_and_b32 v189, 0xffff0000, v142
    v_lshlrev_b32 v190, 16, v143
    v_and_b32 v191, 0xffff0000, v143
    v_lshlrev_b32 v192, 16, v144
    v_and_b32 v193, 0xffff0000, v144
    v_lshlrev_b32 v194, 16, v145
    v_and_b32 v195, 0xffff0000, v145
    v_lshlrev_b32 v196, 16, v146
    v_and_b32 v197, 0xffff0000, v146
    v_lshlrev_b32 v198, 16, v147
    v_and_b32 v199, 0xffff0000, v147
    v_lshlrev_b32 v200, 16, v148
    v_and_b32 v201, 0xffff0000, v148
    v_lshlrev_b32 v202, 16, v149
    v_and_b32 v203, 0xffff0000, v149
    v_lshlrev_b32 v204, 16, v150
    v_and_b32 v205, 0xffff0000, v150
    v_lshlrev_b32 v206, 16, v151
    v_and_b32 v207, 0xffff0000, v151
    v_lshlrev_b32 v208, 16, v152
    v_and_b32 v209, 0xffff0000, v152
    v_lshlrev_b32 v210, 16, v153
    v_and_b32 v211, 0xffff0000, v153
    v_lshlrev_b32 v212, 16, v154
    v_and_b32 v213, 0xffff0000, v154
    v_lshlrev_b32 v214, 16, v155
    v_and_b32 v215, 0xffff0000, v155
    v_lshlrev_b32 v216, 16, v156
    v_and_b32 v217, 0xffff0000, v156
    v_lshlrev_b32 v218, 16, v157
    v_and_b32 v219, 0xffff0000, v157
    v_lshlrev_b32 v220, 16, v158
    v_and_b32 v221, 0xffff0000, v158
    v_lshlrev_b32 v222, 16, v159
    v_and_b32 v223, 0xffff0000, v159
    v_pk_add_f32 v[64:65], v[64:65], v[160:161]
    v_pk_add_f32 v[66:67], v[66:67], v[162:163]
    v_pk_add_f32 v[68:69], v[68:69], v[164:165]
    v_pk_add_f32 v[70:71], v[70:71], v[166:167]
    v_pk_add_f32 v[72:73], v[72:73], v[168:169]
    v_pk_add_f32 v[74:75], v[74:75], v[170:171]
    v_pk_add_f32 v[76:77], v[76:77], v[172:173]
    v_pk_add_f32 v[78:79], v[78:79], v[174:175]
    v_pk_add_f32 v[80:81], v[80:81], v[176:177]
    v_pk_add_f32 v[82:83], v[82:83], v[178:179]
    v_pk_add_f32 v[84:85], v[84:85], v[180:181]
    v_pk_add_f32 v[86:87], v[86:87], v[182:183]
    v_pk_add_f32 v[88:89], v[88:89], v[184:185]
    v_pk_add_f32 v[90:91], v[90:91], v[186:187]
    v_pk_add_f32 v[92:93], v[92:93], v[188:189]
    v_pk_add_f32 v[94:95], v[94:95], v[190:191]
    v_pk_add_f32 v[96:97], v[96:97], v[192:193]
    v_pk_add_f32 v[98:99], v[98:99], v[194:195]
    v_pk_add_f32 v[100:101], v[100:101], v[196:197]
    v_pk_add_f32 v[102:103], v[102:103], v[198:199]
    v_pk_add_f32 v[104:105], v[104:105], v[200:201]
    v_pk_add_f32 v[106:107], v[106:107], v[202:203]
    v_pk_add_f32 v[108:109], v[108:109], v[204:205]
    v_pk_add_f32 v[110:111], v[110:111], v[206:207]
    v_pk_add_f32 v[112:113], v[112:113], v[208:209]
    v_pk_add_f32 v[114:115], v[114:115], v[210:211]
    v_pk_add_f32 v[116:117], v[116:117], v[212:213]
    v_pk_add_f32 v[118:119], v[118:119], v[214:215]
    v_pk_add_f32 v[120:121], v[120:121], v[216:217]
    v_pk_add_f32 v[122:123], v[122:123], v[218:219]
    v_pk_add_f32 v[124:125], v[124:125], v[220:221]
    v_pk_add_f32 v[126:127], v[126:127], v[222:223]
m_noadd196:
    v_cvt_pk_bf16_f32 v64, v64, v65
    v_cvt_pk_bf16_f32 v65, v66, v67
    v_cvt_pk_bf16_f32 v66, v68, v69
    v_cvt_pk_bf16_f32 v67, v70, v71
    v_cvt_pk_bf16_f32 v96, v96, v97
    v_cvt_pk_bf16_f32 v97, v98, v99
    v_cvt_pk_bf16_f32 v98, v100, v101
    v_cvt_pk_bf16_f32 v99, v102, v103
    s_nop 1
    v_permlane16_swap_b32 v64, v66
    v_permlane16_swap_b32 v65, v67
    v_permlane16_swap_b32 v96, v98
    v_permlane16_swap_b32 v97, v99
    buffer_store_dwordx4 v[64:67], v7, s[28:31], s71 offen offset:0 sc1
    buffer_store_dwordx4 v[96:99], v7, s[28:31], s71 offen offset:64 sc1
    s_add_u32 s71, s71, s72
    v_cvt_pk_bf16_f32 v72, v72, v73
    v_cvt_pk_bf16_f32 v73, v74, v75
    v_cvt_pk_bf16_f32 v74, v76, v77
    v_cvt_pk_bf16_f32 v75, v78, v79
    v_cvt_pk_bf16_f32 v104, v104, v105
    v_cvt_pk_bf16_f32 v105, v106, v107
    v_cvt_pk_bf16_f32 v106, v108, v109
    v_cvt_pk_bf16_f32 v107, v110, v111
    s_nop 1
    v_permlane16_swap_b32 v72, v74
    v_permlane16_swap_b32 v73, v75
    v_permlane16_swap_b32 v104, v106
    v_permlane16_swap_b32 v105, v107
    buffer_store_dwordx4 v[72:75], v7, s[28:31], s71 offen offset:0 sc1
    buffer_store_dwordx4 v[104:107], v7, s[28:31], s71 offen offset:64 sc1
    s_add_u32 s71, s71, s72
    v_cvt_pk_bf16_f32 v80, v80, v81
    v_cvt_pk_bf16_f32 v81, v82, v83
    v_cvt_pk_bf16_f32 v82, v84, v85
    v_cvt_pk_bf16_f32 v83, v86, v87
    v_cvt_pk_bf16_f32 v112, v112, v113
    v_cvt_pk_bf16_f32 v113, v114, v115
    v_cvt_pk_bf16_f32 v114, v116, v117
    v_cvt_pk_bf16_f32 v115, v118, v119
    s_nop 1
    v_permlane16_swap_b32 v80, v82
    v_permlane16_swap_b32 v81, v83
    v_permlane16_swap_b32 v112, v114
    v_permlane16_swap_b32 v113, v115
    buffer_store_dwordx4 v[80:83], v7, s[28:31], s71 offen offset:0 sc1
    buffer_store_dwordx4 v[112:115], v7, s[28:31], s71 offen offset:64 sc1
    s_add_u32 s71, s71, s72
    v_cvt_pk_bf16_f32 v88, v88, v89
    v_cvt_pk_bf16_f32 v89, v90, v91
    v_cvt_pk_bf16_f32 v90, v92, v93
    v_cvt_pk_bf16_f32 v91, v94, v95
    v_cvt_pk_bf16_f32 v120, v120, v121
    v_cvt_pk_bf16_f32 v121, v122, v123
    v_cvt_pk_bf16_f32 v122, v124, v125
    v_cvt_pk_bf16_f32 v123, v126, v127
    s_nop 1
    v_permlane16_swap_b32 v88, v90
    v_permlane16_swap_b32 v89, v91
    v_permlane16_swap_b32 v120, v122
    v_permlane16_swap_b32 v121, v123
    buffer_store_dwordx4 v[88:91], v7, s[28:31], s71 offen offset:0 sc1
    buffer_store_dwordx4 v[120:123], v7, s[28:31], s71 offen offset:64 sc1
    s_add_u32 s71, s71, s72
m_end1:
    s_endpgm
m_stub96:
    v_cmp_lt_f32 vcc, s65, v8
    s_cmp_eq_u32 s64, s67
    s_cbranch_scc1 m_eb198
m_er199:
    s_cmp_eq_u32 s64, s68
    s_cbranch_scc1 m_eb200
m_er201:
    s_cbranch_vccnz m_rc202
m_sp197:
    s_branch m_ret97
m_stub99:
    v_cmp_lt_f32 vcc, s65, v8
    s_cmp_eq_u32 s64, s67
    s_cbranch_scc1 m_eb204
m_er205:
    s_cmp_eq_u32 s64, s68
    s_cbranch_scc1 m_eb206
m_er207:
    s_cbranch_vccnz m_rc208
m_sp203:
    s_branch m_ret100
m_stub119:
    v_cmp_lt_f32 vcc, s65, v8
    s_cmp_eq_u32 s64, s70
    s_cbranch_scc1 m_eb210
m_er211:
    s_cmp_eq_u32 s64, s71
    s_cbranch_scc1 m_eb212
m_er213:
    s_cbranch_vccnz m_rc214
m_sp209:
    s_branch m_ret120
m_stub121:
    v_cmp_lt_f32 vcc, s65, v8
    s_cmp_eq_u32 s64, s70
    s_cbranch_scc1 m_eb216
m_er217:
    s_cmp_eq_u32 s64, s71
    s_cbranch_scc1 m_eb218
m_er219:
    s_cmp_eq_u32 s64, s53
    s_cbranch_scc1 m_eb220
m_er221:
    s_cmp_eq_u32 s64, 8
    s_cbranch_scc1 m_eb223
    s_cmp_eq_u32 s64, 12
    s_cbranch_scc1 m_eb224
    s_cmp_eq_u32 s64, 16
    s_cbranch_scc1 m_eb225
    s_cmp_eq_u32 s64, 20
    s_cbranch_scc1 m_eb227
    s_cmp_eq_u32 s64, 24
    s_cbranch_scc1 m_eb228
m_e222:
    s_cbranch_vccnz m_rc230
m_sp215:
    s_branch m_ret122
m_stub125:
    v_cmp_lt_f32 vcc, s65, v8
    s_cmp_eq_u32 s64, s70
    s_cbranch_scc1 m_eb232
m_er233:
    s_cmp_eq_u32 s64, s71
    s_cbranch_scc1 m_eb234
m_er235:
    s_cbranch_vccnz m_rc236
m_sp231:
    s_branch m_ret126
m_stub143:
    v_cmp_lt_f32 vcc, s65, v8
    s_cbranch_vccnz m_rc238
m_sp237:
    s_branch m_ret144
m_eb92:
    v_pk_add_f32 v[176:177], v[176:177], v[16:17]
    v_pk_add_f32 v[188:189], v[188:189], v[16:17]
    v_pk_add_f32 v[178:179], v[178:179], v[18:19]
    v_pk_add_f32 v[190:191], v[190:191], v[18:19]
    v_mov_b32 v180, v9
    v_mov_b32 v181, v9
    v_mov_b64 v[182:183], v[180:181]
    s_branch m_er93
m_eb94:
    v_mov_b32 v176, v9
    v_mov_b32 v177, v9
    v_mov_b64 v[178:179], v[176:177]
    v_mov_b64 v[180:181], v[176:177]
    v_mov_b64 v[182:183], v[176:177]
    v_mov_b64 v[184:185], v[176:177]
    v_mov_b64 v[186:187], v[176:177]
    v_mov_b64 v[188:189], v[176:177]
    v_mov_b64 v[190:191], v[176:177]
    s_branch m_er95
m_eb102:
    v_pk_add_f32 v[176:177], v[176:177], v[16:17]
    v_pk_add_f32 v[188:189], v[188:189], v[16:17]
    v_pk_add_f32 v[178:179], v[178:179], v[18:19]
    v_pk_add_f32 v[190:191], v[190:191], v[18:19]
    v_mov_b32 v180, v9
    v_mov_b32 v181, v9
    v_mov_b64 v[182:183], v[180:181]
    s_branch m_er103
m_eb104:
    v_mov_b32 v176, v9
    v_mov_b32 v177, v9
    v_mov_b64 v[178:179], v[176:177]
    v_mov_b64 v[180:181], v[176:177]
    v_mov_b64 v[182:183], v[176:177]
    v_mov_b64 v[184:185], v[176:177]
    v_mov_b64 v[186:187], v[176:177]
    v_mov_b64 v[188:189], v[176:177]
    v_mov_b64 v[190:191], v[176:177]
    s_branch m_er105
m_eb106:
    v_pk_add_f32 v[160:161], v[160:161], v[16:17]
    v_pk_add_f32 v[172:173], v[172:173], v[16:17]
    v_pk_add_f32 v[162:163], v[162:163], v[18:19]
    v_pk_add_f32 v[174:175], v[174:175], v[18:19]
    v_mov_b32 v164, v9
    v_mov_b32 v165, v9
    v_mov_b64 v[166:167], v[164:165]
    s_branch m_er107
m_eb108:
    s_mov_b32 s91, s101
    s_mov_b32 s101, -1
    s_cmp_lg_u32 s16, 0
    s_cbranch_scc1 m_er109
    v_mov_b32 v60, s4
    v_mov_b32 v61, s5
    s_add_u32 s90, s91, 117440512
    s_mov_b64 exec, 1
    buffer_store_dwordx2 v[60:61], off, s[8:11], s90 sc1
    s_mov_b64 exec, -1
    s_branch m_er109
m_eb111:
    s_lshr_b32 s90, s32, 1
    s_lshl_b32 s90, s90, 7
    s_add_u32 s90, s90, 117440600
    v_min_u32 v0, 1, v1
    v_lshlrev_b32 v0, 5, v0
    buffer_load_dwordx2 v[4:5], v0, s[8:11], s90 offen sc1
    s_cmp_eq_u32 s17, -1
    s_cbranch_scc1 m_e110
    s_cmp_lg_u32 s16, 0
    s_cbranch_scc1 m_e110
    v_mov_b32 v60, s4
    v_mov_b32 v61, s5
    s_add_u32 s90, s17, 117440512
    s_mov_b64 exec, 1
    buffer_store_dwordx2 v[60:61], off, s[8:11], s90 sc1
    s_mov_b64 exec, -1
    s_branch m_e110
m_eb112:
    s_lshr_b32 s90, s32, 1
    s_lshl_b32 s90, s90, 7
    s_add_u32 s90, s90, 117440600
    v_min_u32 v0, 1, v1
    v_lshlrev_b32 v0, 5, v0
    buffer_load_dwordx2 v[4:5], v0, s[8:11], s90 offen sc1
    s_branch m_e110
m_eb113:
    s_waitcnt vmcnt(16)
    v_cmp_ne_u64 s[76:77], s[4:5], v[4:5]
    s_nop 3
    s_cmp_eq_u64 s[76:77], 0
    s_cbranch_scc1 m_e110
    s_mov_b32 s3, 262144
m_spin114:
    s_lshr_b32 s90, s32, 1
    s_lshl_b32 s90, s90, 7
    s_add_u32 s90, s90, 117440600
    v_min_u32 v0, 1, v1
    v_lshlrev_b32 v0, 5, v0
    buffer_load_dwordx2 v[4:5], v0, s[8:11], s90 offen sc1
    s_waitcnt vmcnt(0)
    v_cmp_ne_u64 s[76:77], s[4:5], v[4:5]
    s_nop 3
    s_cmp_eq_u64 s[76:77], 0
    s_cbranch_scc1 m_e110
    s_sleep 8
    s_sub_u32 s3, s3, 1
    s_cbranch_scc0 m_spin114
    s_branch m_e110
m_eb115:
    buffer_load_dwordx2 v[4:5], v10, s[8:11], 0 offen sc1
    s_branch m_e110
m_eb116:
    s_waitcnt vmcnt(16)
    v_cmp_ne_u64 s[76:77], s[4:5], v[4:5]
    s_nop 3
    s_cmp_eq_u64 s[76:77], 0
    s_cbranch_scc1 m_e110
    s_mov_b32 s3, 262144
m_spin117:
    buffer_load_dwordx2 v[4:5], v10, s[8:11], 0 offen sc1
    s_waitcnt vmcnt(0)
    v_cmp_ne_u64 s[76:77], s[4:5], v[4:5]
    s_nop 3
    s_cmp_eq_u64 s[76:77], 0
    s_cbranch_scc1 m_e110
    s_sleep 8
    s_sub_u32 s3, s3, 1
    s_cbranch_scc0 m_spin117
    s_branch m_e110
m_eb128:
    v_pk_add_f32 v[160:161], v[160:161], v[16:17]
    v_pk_add_f32 v[172:173], v[172:173], v[16:17]
    v_pk_add_f32 v[162:163], v[162:163], v[18:19]
    v_pk_add_f32 v[174:175], v[174:175], v[18:19]
    v_mov_b32 v164, v9
    v_mov_b32 v165, v9
    v_mov_b64 v[166:167], v[164:165]
    s_branch m_er129
m_eb130:
    v_mov_b32 v160, v9
    v_mov_b32 v161, v9
    v_mov_b64 v[162:163], v[160:161]
    v_mov_b64 v[164:165], v[160:161]
    v_mov_b64 v[166:167], v[160:161]
    v_mov_b64 v[168:169], v[160:161]
    v_mov_b64 v[170:171], v[160:161]
    v_mov_b64 v[172:173], v[160:161]
    v_mov_b64 v[174:175], v[160:161]
    s_branch m_er131
m_eb132:
    s_mov_b32 s91, s101
    s_mov_b32 s101, -1
    s_cmp_lg_u32 s16, 0
    s_cbranch_scc1 m_er133
    v_mov_b32 v60, s4
    v_mov_b32 v61, s5
    s_add_u32 s90, s91, 117440512
    s_mov_b64 exec, 1
    buffer_store_dwordx2 v[60:61], off, s[8:11], s90 sc1
    s_mov_b64 exec, -1
    s_branch m_er133
m_eb135:
    s_lshr_b32 s90, s32, 1
    s_lshl_b32 s90, s90, 7
    s_add_u32 s90, s90, 117440600
    v_min_u32 v0, 1, v1
    v_lshlrev_b32 v0, 5, v0
    buffer_load_dwordx2 v[4:5], v0, s[8:11], s90 offen sc1
    s_cmp_eq_u32 s17, -1
    s_cbranch_scc1 m_e134
    s_cmp_lg_u32 s16, 0
    s_cbranch_scc1 m_e134
    v_mov_b32 v60, s4
    v_mov_b32 v61, s5
    s_add_u32 s90, s17, 117440512
    s_mov_b64 exec, 1
    buffer_store_dwordx2 v[60:61], off, s[8:11], s90 sc1
    s_mov_b64 exec, -1
    s_branch m_e134
m_eb136:
    s_lshr_b32 s90, s32, 1
    s_lshl_b32 s90, s90, 7
    s_add_u32 s90, s90, 117440600
    v_min_u32 v0, 1, v1
    v_lshlrev_b32 v0, 5, v0
    buffer_load_dwordx2 v[4:5], v0, s[8:11], s90 offen sc1
    s_branch m_e134
m_eb137:
    s_waitcnt vmcnt(16)
    v_cmp_ne_u64 s[76:77], s[4:5], v[4:5]
    s_nop 3
    s_cmp_eq_u64 s[76:77], 0
    s_cbranch_scc1 m_e134
    s_mov_b32 s3, 262144
m_spin138:
    s_lshr_b32 s90, s32, 1
    s_lshl_b32 s90, s90, 7
    s_add_u32 s90, s90, 117440600
    v_min_u32 v0, 1, v1
    v_lshlrev_b32 v0, 5, v0
    buffer_load_dwordx2 v[4:5], v0, s[8:11], s90 offen sc1
    s_waitcnt vmcnt(0)
    v_cmp_ne_u64 s[76:77], s[4:5], v[4:5]
    s_nop 3
    s_cmp_eq_u64 s[76:77], 0
    s_cbranch_scc1 m_e134
    s_sleep 8
    s_sub_u32 s3, s3, 1
    s_cbranch_scc0 m_spin138
    s_branch m_e134
m_eb139:
    buffer_load_dwordx2 v[4:5], v10, s[8:11], 0 offen sc1
    s_branch m_e134
m_eb140:
    s_waitcnt vmcnt(16)
    v_cmp_ne_u64 s[76:77], s[4:5], v[4:5]
    s_nop 3
    s_cmp_eq_u64 s[76:77], 0
    s_cbranch_scc1 m_e134
    s_mov_b32 s3, 262144
m_spin141:
    buffer_load_dwordx2 v[4:5], v10, s[8:11], 0 offen sc1
    s_waitcnt vmcnt(0)
    v_cmp_ne_u64 s[76:77], s[4:5], v[4:5]
    s_nop 3
    s_cmp_eq_u64 s[76:77], 0
    s_cbranch_scc1 m_e134
    s_sleep 8
    s_sub_u32 s3, s3, 1
    s_cbranch_scc0 m_spin141
    s_branch m_e134
m_eb198:
    v_pk_add_f32 v[176:177], v[176:177], v[16:17]
    v_pk_add_f32 v[188:189], v[188:189], v[16:17]
    v_pk_add_f32 v[178:179], v[178:179], v[18:19]
    v_pk_add_f32 v[190:191], v[190:191], v[18:19]
    v_mov_b32 v180, v9
    v_mov_b32 v181, v9
    v_mov_b64 v[182:183], v[180:181]
    s_branch m_er199
m_eb200:
    v_mov_b32 v176, v9
    v_mov_b32 v177, v9
    v_mov_b64 v[178:179], v[176:177]
    v_mov_b64 v[180:181], v[176:177]
    v_mov_b64 v[182:183], v[176:177]
    v_mov_b64 v[184:185], v[176:177]
    v_mov_b64 v[186:187], v[176:177]
    v_mov_b64 v[188:189], v[176:177]
    v_mov_b64 v[190:191], v[176:177]
    s_branch m_er201
m_eb204:
    v_pk_add_f32 v[176:177], v[176:177], v[16:17]
    v_pk_add_f32 v[188:189], v[188:189], v[16:17]
    v_pk_add_f32 v[178:179], v[178:179], v[18:19]
    v_pk_add_f32 v[190:191], v[190:191], v[18:19]
    v_mov_b32 v180, v9
    v_mov_b32 v181, v9
    v_mov_b64 v[182:183], v[180:181]
    s_branch m_er205
m_eb206:
    v_mov_b32 v176, v9
    v_mov_b32 v177, v9
    v_mov_b64 v[178:179], v[176:177]
    v_mov_b64 v[180:181], v[176:177]
    v_mov_b64 v[182:183], v[176:177]
    v_mov_b64 v[184:185], v[176:177]
    v_mov_b64 v[186:187], v[176:177]
    v_mov_b64 v[188:189], v[176:177]
    v_mov_b64 v[190:191], v[176:177]
    s_branch m_er207
m_eb210:
    v_pk_add_f32 v[160:161], v[160:161], v[16:17]
    v_pk_add_f32 v[172:173], v[172:173], v[16:17]
    v_pk_add_f32 v[162:163], v[162:163], v[18:19]
    v_pk_add_f32 v[174:175], v[174:175], v[18:19]
    v_mov_b32 v164, v9
    v_mov_b32 v165, v9
    v_mov_b64 v[166:167], v[164:165]
    s_branch m_er211
m_eb212:
    v_mov_b32 v160, v9
    v_mov_b32 v161, v9
    v_mov_b64 v[162:163], v[160:161]
    v_mov_b64 v[164:165], v[160:161]
    v_mov_b64 v[166:167], v[160:161]
    v_mov_b64 v[168:169], v[160:161]
    v_mov_b64 v[170:171], v[160:161]
    v_mov_b64 v[172:173], v[160:161]
    v_mov_b64 v[174:175], v[160:161]
    s_branch m_er213
m_eb216:
    v_pk_add_f32 v[160:161], v[160:161], v[16:17]
    v_pk_add_f32 v[172:173], v[172:173], v[16:17]
    v_pk_add_f32 v[162:163], v[162:163], v[18:19]
    v_pk_add_f32 v[174:175], v[174:175], v[18:19]
    v_mov_b32 v164, v9
    v_mov_b32 v165, v9
    v_mov_b64 v[166:167], v[164:165]
    s_branch m_er217
m_eb218:
    v_mov_b32 v160, v9
    v_mov_b32 v161, v9
    v_mov_b64 v[162:163], v[160:161]
    v_mov_b64 v[164:165], v[160:161]
    v_mov_b64 v[166:167], v[160:161]
    v_mov_b64 v[168:169], v[160:161]
    v_mov_b64 v[170:171], v[160:161]
    v_mov_b64 v[172:173], v[160:161]
    v_mov_b64 v[174:175], v[160:161]
    s_branch m_er219
m_eb220:
    s_mov_b32 s91, s101
    s_mov_b32 s101, -1
    s_cmp_lg_u32 s16, 0
    s_cbranch_scc1 m_er221
    v_mov_b32 v60, s4
    v_mov_b32 v61, s5
    s_add_u32 s90, s91, 117440512
    s_mov_b64 exec, 1
    buffer_store_dwordx2 v[60:61], off, s[8:11], s90 sc1
    s_mov_b64 exec, -1
    s_branch m_er221
m_eb223:
    s_lshr_b32 s90, s32, 1
    s_lshl_b32 s90, s90, 7
    s_add_u32 s90, s90, 117440600
    v_min_u32 v0, 1, v1
    v_lshlrev_b32 v0, 5, v0
    buffer_load_dwordx2 v[4:5], v0, s[8:11], s90 offen sc1
    s_cmp_eq_u32 s17, -1
    s_cbranch_scc1 m_e222
    s_cmp_lg_u32 s16, 0
    s_cbranch_scc1 m_e222
    v_mov_b32 v60, s4
    v_mov_b32 v61, s5
    s_add_u32 s90, s17, 117440512
    s_mov_b64 exec, 1
    buffer_store_dwordx2 v[60:61], off, s[8:11], s90 sc1
    s_mov_b64 exec, -1
    s_branch m_e222
m_eb224:
    s_lshr_b32 s90, s32, 1
    s_lshl_b32 s90, s90, 7
    s_add_u32 s90, s90, 117440600
    v_min_u32 v0, 1, v1
    v_lshlrev_b32 v0, 5, v0
    buffer_load_dwordx2 v[4:5], v0, s[8:11], s90 offen sc1
    s_branch m_e222
m_eb225:
    s_waitcnt vmcnt(16)
    v_cmp_ne_u64 s[76:77], s[4:5], v[4:5]
    s_nop 3
    s_cmp_eq_u64 s[76:77], 0
    s_cbranch_scc1 m_e222
    s_mov_b32 s3, 262144
m_spin226:
    s_lshr_b32 s90, s32, 1
    s_lshl_b32 s90, s90, 7
    s_add_u32 s90, s90, 117440600
    v_min_u32 v0, 1, v1
    v_lshlrev_b32 v0, 5, v0
    buffer_load_dwordx2 v[4:5], v0, s[8:11], s90 offen sc1
    s_waitcnt vmcnt(0)
    v_cmp_ne_u64 s[76:77], s[4:5], v[4:5]
    s_nop 3
    s_cmp_eq_u64 s[76:77], 0
    s_cbranch_scc1 m_e222
    s_sleep 8
    s_sub_u32 s3, s3, 1
    s_cbranch_scc0 m_spin226
    s_branch m_e222
m_eb227:
    buffer_load_dwordx2 v[4:5], v10, s[8:11], 0 offen sc1
    s_branch m_e222
m_eb228:
    s_waitcnt vmcnt(16)
    v_cmp_ne_u64 s[76:77], s[4:5], v[4:5]
    s_nop 3
    s_cmp_eq_u64 s[76:77], 0
    s_cbranch_scc1 m_e222
    s_mov_b32 s3, 262144
m_spin229:
    buffer_load_dwordx2 v[4:5], v10, s[8:11], 0 offen sc1
    s_waitcnt vmcnt(0)
    v_cmp_ne_u64 s[76:77], s[4:5], v[4:5]
    s_nop 3
    s_cmp_eq_u64 s[76:77], 0
    s_cbranch_scc1 m_e222
    s_sleep 8
    s_sub_u32 s3, s3, 1
    s_cbranch_scc0 m_spin229
    s_branch m_e222
m_eb232:
    v_pk_add_f32 v[160:161], v[160:161], v[16:17]
    v_pk_add_f32 v[172:173], v[172:173], v[16:17]
    v_pk_add_f32 v[162:163], v[162:163], v[18:19]
    v_pk_add_f32 v[174:175], v[174:175], v[18:19]
    v_mov_b32 v164, v9
    v_mov_b32 v165, v9
    v_mov_b64 v[166:167], v[164:165]
    s_branch m_er233
m_eb234:
    v_mov_b32 v160, v9
    v_mov_b32 v161, v9
    v_mov_b64 v[162:163], v[160:161]
    v_mov_b64 v[164:165], v[160:161]
    v_mov_b64 v[166:167], v[160:161]
    v_mov_b64 v[168:169], v[160:161]
    v_mov_b64 v[170:171], v[160:161]
    v_mov_b64 v[172:173], v[160:161]
    v_mov_b64 v[174:175], v[160:161]
    s_branch m_er235
m_rc118:
    s_call_b64 s[74:75], m_rs0488
    s_branch m_sp101
m_rc142:
    s_call_b64 s[74:75], m_rs0287
    s_branch m_sp127
m_rc202:
    s_call_b64 s[74:75], m_rs0488
    s_branch m_sp197
m_rc208:
    s_call_b64 s[74:75], m_rs1490
    s_branch m_sp203
m_rc214:
    s_call_b64 s[74:75], m_rs1490
    s_branch m_sp209
m_rc230:
    s_call_b64 s[74:75], m_rs0287
    s_branch m_sp215
m_rc236:
    s_call_b64 s[74:75], m_rs1289
    s_branch m_sp231
m_rc238:
    s_call_b64 s[74:75], m_rs1289
    s_branch m_sp237
m_rs0287:
    s_nop 15
    v_max3_f32 v48, v64, v65, v66
    v_max3_f32 v48, v48, v67, v68
    v_max3_f32 v48, v48, v69, v70
    v_max3_f32 v48, v48, v71, 0
    v_mov_b32 v49, v48
    s_nop 1
    v_permlane32_swap_b32 v48, v49
    s_nop 1
    v_max_f32 v48, v48, v49
    v_mov_b32 v49, v48
    s_nop 1
    v_permlane16_swap_b32 v48, v49
    s_nop 1
    v_max_f32 v48, v48, v49
    v_exp_f32 v49, -v48
    v_sub_f32 v64, v64, v48
    v_sub_f32 v65, v65, v48
    v_sub_f32 v66, v66, v48
    v_sub_f32 v67, v67, v48
    v_sub_f32 v68, v68, v48
    v_sub_f32 v69, v69, v48
    v_sub_f32 v70, v70, v48
    v_sub_f32 v71, v71, v48
    v_sub_f32 v96, v96, v48
    v_sub_f32 v97, v97, v48
    v_sub_f32 v98, v98, v48
    v_sub_f32 v99, v99, v48
    v_sub_f32 v100, v100, v48
    v_sub_f32 v101, v101, v48
    v_sub_f32 v102, v102, v48
    v_sub_f32 v103, v103, v48
    v_sub_f32 v160, v160, v48
    v_sub_f32 v161, v161, v48
    v_sub_f32 v162, v162, v48
    v_sub_f32 v163, v163, v48
    v_sub_f32 v164, v164, v48
    v_sub_f32 v165, v165, v48
    v_sub_f32 v166, v166, v48
    v_sub_f32 v167, v167, v48
    v_mul_f32 v12, v12, v49
    v_accvgpr_read_b32 v52, a0
    v_accvgpr_read_b32 v53, a1
    v_accvgpr_read_b32 v54, a2
    v_accvgpr_read_b32 v55, a3
    v_accvgpr_read_b32 v56, a4
    v_accvgpr_read_b32 v57, a5
    v_accvgpr_read_b32 v58, a6
    v_accvgpr_read_b32 v59, a7
    v_mul_f32 v52, v52, v49
    v_mul_f32 v53, v53, v49
    v_mul_f32 v54, v54, v49
    v_mul_f32 v55, v55, v49
    v_mul_f32 v56, v56, v49
    v_mul_f32 v57, v57, v49
    v_mul_f32 v58, v58, v49
    v_mul_f32 v59, v59, v49
    v_accvgpr_write_b32 a0, v52
    v_accvgpr_write_b32 a1, v53
    v_accvgpr_write_b32 a2, v54
    v_accvgpr_write_b32 a3, v55
    v_accvgpr_write_b32 a4, v56
    v_accvgpr_write_b32 a5, v57
    v_accvgpr_write_b32 a6, v58
    v_accvgpr_write_b32 a7, v59
    v_accvgpr_read_b32 v52, a8
    v_accvgpr_read_b32 v53, a9
    v_accvgpr_read_b32 v54, a10
    v_accvgpr_read_b32 v55, a11
    v_accvgpr_read_b32 v56, a12
    v_accvgpr_read_b32 v57, a13
    v_accvgpr_read_b32 v58, a14
    v_accvgpr_read_b32 v59, a15
    v_mul_f32 v52, v52, v49
    v_mul_f32 v53, v53, v49
    v_mul_f32 v54, v54, v49
    v_mul_f32 v55, v55, v49
    v_mul_f32 v56, v56, v49
    v_mul_f32 v57, v57, v49
    v_mul_f32 v58, v58, v49
    v_mul_f32 v59, v59, v49
    v_accvgpr_write_b32 a8, v52
    v_accvgpr_write_b32 a9, v53
    v_accvgpr_write_b32 a10, v54
    v_accvgpr_write_b32 a11, v55
    v_accvgpr_write_b32 a12, v56
    v_accvgpr_write_b32 a13, v57
    v_accvgpr_write_b32 a14, v58
    v_accvgpr_write_b32 a15, v59
    v_accvgpr_read_b32 v52, a16
    v_accvgpr_read_b32 v53, a17
    v_accvgpr_read_b32 v54, a18
    v_accvgpr_read_b32 v55, a19
    v_accvgpr_read_b32 v56, a20
    v_accvgpr_read_b32 v57, a21
    v_accvgpr_read_b32 v58, a22
    v_accvgpr_read_b32 v59, a23
    v_mul_f32 v52, v52, v49
    v_mul_f32 v53, v53, v49
    v_mul_f32 v54, v54, v49
    v_mul_f32 v55, v55, v49
    v_mul_f32 v56, v56, v49
    v_mul_f32 v57, v57, v49
    v_mul_f32 v58, v58, v49
    v_mul_f32 v59, v59, v49
    v_accvgpr_write_b32 a16, v52
    v_accvgpr_write_b32 a17, v53
    v_accvgpr_write_b32 a18, v54
    v_accvgpr_write_b32 a19, v55
    v_accvgpr_write_b32 a20, v56
    v_accvgpr_write_b32 a21, v57
    v_accvgpr_write_b32 a22, v58
    v_accvgpr_write_b32 a23, v59
    v_accvgpr_read_b32 v52, a24
    v_accvgpr_read_b32 v53, a25
    v_accvgpr_read_b32 v54, a26
    v_accvgpr_read_b32 v55, a27
    v_accvgpr_read_b32 v56, a28
    v_accvgpr_read_b32 v57, a29
    v_accvgpr_read_b32 v58, a30
    v_accvgpr_read_b32 v59, a31
    v_mul_f32 v52, v52, v49
    v_mul_f32 v53, v53, v49
    v_mul_f32 v54, v54, v49
    v_mul_f32 v55, v55, v49
    v_mul_f32 v56, v56, v49
    v_mul_f32 v57, v57, v49
    v_mul_f32 v58, v58, v49
    v_mul_f32 v59, v59, v49
    v_accvgpr_write_b32 a24, v52
    v_accvgpr_write_b32 a25, v53
    v_accvgpr_write_b32 a26, v54
    v_accvgpr_write_b32 a27, v55
    v_accvgpr_write_b32 a28, v56
    v_accvgpr_write_b32 a29, v57
    v_accvgpr_write_b32 a30, v58
    v_accvgpr_write_b32 a31, v59
    v_exp_f32 v52, v64
    v_exp_f32 v53, v65
    v_exp_f32 v54, v66
    v_exp_f32 v55, v67
    v_exp_f32 v56, v68
    v_exp_f32 v57, v69
    v_exp_f32 v58, v70
    v_exp_f32 v59, v71
    s_nop 0
    v_cvt_pk_bf16_f32 v128, v52, v53
    v_cvt_pk_bf16_f32 v129, v54, v55
    v_cvt_pk_bf16_f32 v130, v56, v57
    v_cvt_pk_bf16_f32 v131, v58, v59
    s_nop 1
    v_mfma_f32_16x16x32_bf16 v[28:31], v[44:47], v[128:131], 0
    v_max3_f32 v48, v72, v73, v74
    v_max3_f32 v48, v48, v75, v76
    v_max3_f32 v48, v48, v77, v78
    v_max3_f32 v48, v48, v79, 0
    v_mov_b32 v49, v48
    s_nop 1
    v_permlane32_swap_b32 v48, v49
    s_nop 1
    v_max_f32 v48, v48, v49
    v_mov_b32 v49, v48
    s_nop 1
    v_permlane16_swap_b32 v48, v49
    s_nop 1
    v_max_f32 v48, v48, v49
    v_exp_f32 v49, -v48
    v_sub_f32 v72, v72, v48
    v_sub_f32 v73, v73, v48
    v_sub_f32 v74, v74, v48
    v_sub_f32 v75, v75, v48
    v_sub_f32 v76, v76, v48
    v_sub_f32 v77, v77, v48
    v_sub_f32 v78, v78, v48
    v_sub_f32 v79, v79, v48
    v_sub_f32 v104, v104, v48
    v_sub_f32 v105, v105, v48
    v_sub_f32 v106, v106, v48
    v_sub_f32 v107, v107, v48
    v_sub_f32 v108, v108, v48
    v_sub_f32 v109, v109, v48
    v_sub_f32 v110, v110, v48
    v_sub_f32 v111, v111, v48
    v_sub_f32 v168, v168, v48
    v_sub_f32 v169, v169, v48
    v_sub_f32 v170, v170, v48
    v_sub_f32 v171, v171, v48
    v_sub_f32 v172, v172, v48
    v_sub_f32 v173, v173, v48
    v_sub_f32 v174, v174, v48
    v_sub_f32 v175, v175, v48
    v_mul_f32 v13, v13, v49
    v_accvgpr_read_b32 v52, a32
    v_accvgpr_read_b32 v53, a33
    v_accvgpr_read_b32 v54, a34
    v_accvgpr_read_b32 v55, a35
    v_accvgpr_read_b32 v56, a36
    v_accvgpr_read_b32 v57, a37
    v_accvgpr_read_b32 v58, a38
    v_accvgpr_read_b32 v59, a39
    v_mul_f32 v52, v52, v49
    v_mul_f32 v53, v53, v49
    v_mul_f32 v54, v54, v49
    v_mul_f32 v55, v55, v49
    v_mul_f32 v56, v56, v49
    v_mul_f32 v57, v57, v49
    v_mul_f32 v58, v58, v49
    v_mul_f32 v59, v59, v49
    v_accvgpr_write_b32 a32, v52
    v_accvgpr_write_b32 a33, v53
    v_accvgpr_write_b32 a34, v54
    v_accvgpr_write_b32 a35, v55
    v_accvgpr_write_b32 a36, v56
    v_accvgpr_write_b32 a37, v57
    v_accvgpr_write_b32 a38, v58
    v_accvgpr_write_b32 a39, v59
    v_accvgpr_read_b32 v52, a40
    v_accvgpr_read_b32 v53, a41
    v_accvgpr_read_b32 v54, a42
    v_accvgpr_read_b32 v55, a43
    v_accvgpr_read_b32 v56, a44
    v_accvgpr_read_b32 v57, a45
    v_accvgpr_read_b32 v58, a46
    v_accvgpr_read_b32 v59, a47
    v_mul_f32 v52, v52, v49
    v_mul_f32 v53, v53, v49
    v_mul_f32 v54, v54, v49
    v_mul_f32 v55, v55, v49
    v_mul_f32 v56, v56, v49
    v_mul_f32 v57, v57, v49
    v_mul_f32 v58, v58, v49
    v_mul_f32 v59, v59, v49
    v_accvgpr_write_b32 a40, v52
    v_accvgpr_write_b32 a41, v53
    v_accvgpr_write_b32 a42, v54
    v_accvgpr_write_b32 a43, v55
    v_accvgpr_write_b32 a44, v56
    v_accvgpr_write_b32 a45, v57
    v_accvgpr_write_b32 a46, v58
    v_accvgpr_write_b32 a47, v59
    v_accvgpr_read_b32 v52, a48
    v_accvgpr_read_b32 v53, a49
    v_accvgpr_read_b32 v54, a50
    v_accvgpr_read_b32 v55, a51
    v_accvgpr_read_b32 v56, a52
    v_accvgpr_read_b32 v57, a53
    v_accvgpr_read_b32 v58, a54
    v_accvgpr_read_b32 v59, a55
    v_mul_f32 v52, v52, v49
    v_mul_f32 v53, v53, v49
    v_mul_f32 v54, v54, v49
    v_mul_f32 v55, v55, v49
    v_mul_f32 v56, v56, v49
    v_mul_f32 v57, v57, v49
    v_mul_f32 v58, v58, v49
    v_mul_f32 v59, v59, v49
    v_accvgpr_write_b32 a48, v52
    v_accvgpr_write_b32 a49, v53
    v_accvgpr_write_b32 a50, v54
    v_accvgpr_write_b32 a51, v55
    v_accvgpr_write_b32 a52, v56
    v_accvgpr_write_b32 a53, v57
    v_accvgpr_write_b32 a54, v58
    v_accvgpr_write_b32 a55, v59
    v_accvgpr_read_b32 v52, a56
    v_accvgpr_read_b32 v53, a57
    v_accvgpr_read_b32 v54, a58
    v_accvgpr_read_b32 v55, a59
    v_accvgpr_read_b32 v56, a60
    v_accvgpr_read_b32 v57, a61
    v_accvgpr_read_b32 v58, a62
    v_accvgpr_read_b32 v59, a63
    v_mul_f32 v52, v52, v49
    v_mul_f32 v53, v53, v49
    v_mul_f32 v54, v54, v49
    v_mul_f32 v55, v55, v49
    v_mul_f32 v56, v56, v49
    v_mul_f32 v57, v57, v49
    v_mul_f32 v58, v58, v49
    v_mul_f32 v59, v59, v49
    v_accvgpr_write_b32 a56, v52
    v_accvgpr_write_b32 a57, v53
    v_accvgpr_write_b32 a58, v54
    v_accvgpr_write_b32 a59, v55
    v_accvgpr_write_b32 a60, v56
    v_accvgpr_write_b32 a61, v57
    v_accvgpr_write_b32 a62, v58
    v_accvgpr_write_b32 a63, v59
    v_exp_f32 v52, v72
    v_exp_f32 v53, v73
    v_exp_f32 v54, v74
    v_exp_f32 v55, v75
    v_exp_f32 v56, v76
    v_exp_f32 v57, v77
    v_exp_f32 v58, v78
    v_exp_f32 v59, v79
    s_nop 0
    v_cvt_pk_bf16_f32 v132, v52, v53
    v_cvt_pk_bf16_f32 v133, v54, v55
    v_cvt_pk_bf16_f32 v134, v56, v57
    v_cvt_pk_bf16_f32 v135, v58, v59
    s_nop 1
    v_mfma_f32_16x16x32_bf16 v[32:35], v[44:47], v[132:135], 0
    s_nop 7
    s_setpc_b64 s[74:75]
m_rs0488:
    s_nop 15
    v_max3_f32 v48, v64, v65, v66
    v_max3_f32 v48, v48, v67, v68
    v_max3_f32 v48, v48, v69, v70
    v_max3_f32 v48, v48, v71, 0
    v_mov_b32 v49, v48
    s_nop 1
    v_permlane32_swap_b32 v48, v49
    s_nop 1
    v_max_f32 v48, v48, v49
    v_mov_b32 v49, v48
    s_nop 1
    v_permlane16_swap_b32 v48, v49
    s_nop 1
    v_max_f32 v48, v48, v49
    v_exp_f32 v49, -v48
    v_sub_f32 v64, v64, v48
    v_sub_f32 v65, v65, v48
    v_sub_f32 v66, v66, v48
    v_sub_f32 v67, v67, v48
    v_sub_f32 v68, v68, v48
    v_sub_f32 v69, v69, v48
    v_sub_f32 v70, v70, v48
    v_sub_f32 v71, v71, v48
    v_sub_f32 v96, v96, v48
    v_sub_f32 v97, v97, v48
    v_sub_f32 v98, v98, v48
    v_sub_f32 v99, v99, v48
    v_sub_f32 v100, v100, v48
    v_sub_f32 v101, v101, v48
    v_sub_f32 v102, v102, v48
    v_sub_f32 v103, v103, v48
    v_sub_f32 v160, v160, v48
    v_sub_f32 v161, v161, v48
    v_sub_f32 v162, v162, v48
    v_sub_f32 v163, v163, v48
    v_sub_f32 v164, v164, v48
    v_sub_f32 v165, v165, v48
    v_sub_f32 v166, v166, v48
    v_sub_f32 v167, v167, v48
    v_mul_f32 v12, v12, v49
    v_accvgpr_read_b32 v52, a0
    v_accvgpr_read_b32 v53, a1
    v_accvgpr_read_b32 v54, a2
    v_accvgpr_read_b32 v55, a3
    v_accvgpr_read_b32 v56, a4
    v_accvgpr_read_b32 v57, a5
    v_accvgpr_read_b32 v58, a6
    v_accvgpr_read_b32 v59, a7
    v_mul_f32 v52, v52, v49
    v_mul_f32 v53, v53, v49
    v_mul_f32 v54, v54, v49
    v_mul_f32 v55, v55, v49
    v_mul_f32 v56, v56, v49
    v_mul_f32 v57, v57, v49
    v_mul_f32 v58, v58, v49
    v_mul_f32 v59, v59, v49
    v_accvgpr_write_b32 a0, v52
    v_accvgpr_write_b32 a1, v53
    v_accvgpr_write_b32 a2, v54
    v_accvgpr_write_b32 a3, v55
    v_accvgpr_write_b32 a4, v56
    v_accvgpr_write_b32 a5, v57
    v_accvgpr_write_b32 a6, v58
    v_accvgpr_write_b32 a7, v59
    v_accvgpr_read_b32 v52, a8
    v_accvgpr_read_b32 v53, a9
    v_accvgpr_read_b32 v54, a10
    v_accvgpr_read_b32 v55, a11
    v_accvgpr_read_b32 v56, a12
    v_accvgpr_read_b32 v57, a13
    v_accvgpr_read_b32 v58, a14
    v_accvgpr_read_b32 v59, a15
    v_mul_f32 v52, v52, v49
    v_mul_f32 v53, v53, v49
    v_mul_f32 v54, v54, v49
    v_mul_f32 v55, v55, v49
    v_mul_f32 v56, v56, v49
    v_mul_f32 v57, v57, v49
    v_mul_f32 v58, v58, v49
    v_mul_f32 v59, v59, v49
    v_accvgpr_write_b32 a8, v52
    v_accvgpr_write_b32 a9, v53
    v_accvgpr_write_b32 a10, v54
    v_accvgpr_write_b32 a11, v55
    v_accvgpr_write_b32 a12, v56
    v_accvgpr_write_b32 a13, v57
    v_accvgpr_write_b32 a14, v58
    v_accvgpr_write_b32 a15, v59
    v_accvgpr_read_b32 v52, a16
    v_accvgpr_read_b32 v53, a17
    v_accvgpr_read_b32 v54, a18
    v_accvgpr_read_b32 v55, a19
    v_accvgpr_read_b32 v56, a20
    v_accvgpr_read_b32 v57, a21
    v_accvgpr_read_b32 v58, a22
    v_accvgpr_read_b32 v59, a23
    v_mul_f32 v52, v52, v49
    v_mul_f32 v53, v53, v49
    v_mul_f32 v54, v54, v49
    v_mul_f32 v55, v55, v49
    v_mul_f32 v56, v56, v49
    v_mul_f32 v57, v57, v49
    v_mul_f32 v58, v58, v49
    v_mul_f32 v59, v59, v49
    v_accvgpr_write_b32 a16, v52
    v_accvgpr_write_b32 a17, v53
    v_accvgpr_write_b32 a18, v54
    v_accvgpr_write_b32 a19, v55
    v_accvgpr_write_b32 a20, v56
    v_accvgpr_write_b32 a21, v57
    v_accvgpr_write_b32 a22, v58
    v_accvgpr_write_b32 a23, v59
    v_accvgpr_read_b32 v52, a24
    v_accvgpr_read_b32 v53, a25
    v_accvgpr_read_b32 v54, a26
    v_accvgpr_read_b32 v55, a27
    v_accvgpr_read_b32 v56, a28
    v_accvgpr_read_b32 v57, a29
    v_accvgpr_read_b32 v58, a30
    v_accvgpr_read_b32 v59, a31
    v_mul_f32 v52, v52, v49
    v_mul_f32 v53, v53, v49
    v_mul_f32 v54, v54, v49
    v_mul_f32 v55, v55, v49
    v_mul_f32 v56, v56, v49
    v_mul_f32 v57, v57, v49
    v_mul_f32 v58, v58, v49
    v_mul_f32 v59, v59, v49
    v_accvgpr_write_b32 a24, v52
    v_accvgpr_write_b32 a25, v53
    v_accvgpr_write_b32 a26, v54
    v_accvgpr_write_b32 a27, v55
    v_accvgpr_write_b32 a28, v56
    v_accvgpr_write_b32 a29, v57
    v_accvgpr_write_b32 a30, v58
    v_accvgpr_write_b32 a31, v59
    v_exp_f32 v52, v64
    v_exp_f32 v53, v65
    v_exp_f32 v54, v66
    v_exp_f32 v55, v67
    v_exp_f32 v56, v68
    v_exp_f32 v57, v69
    v_exp_f32 v58, v70
    v_exp_f32 v59, v71
    s_nop 0
    v_cvt_pk_bf16_f32 v128, v52, v53
    v_cvt_pk_bf16_f32 v129, v54, v55
    v_cvt_pk_bf16_f32 v130, v56, v57
    v_cvt_pk_bf16_f32 v131, v58, v59
    s_nop 1
    v_mfma_f32_16x16x32_bf16 v[28:31], v[44:47], v[128:131], 0
    v_max3_f32 v48, v72, v73, v74
    v_max3_f32 v48, v48, v75, v76
    v_max3_f32 v48, v48, v77, v78
    v_max3_f32 v48, v48, v79, 0
    v_mov_b32 v49, v48
    s_nop 1
    v_permlane32_swap_b32 v48, v49
    s_nop 1
    v_max_f32 v48, v48, v49
    v_mov_b32 v49, v48
    s_nop 1
    v_permlane16_swap_b32 v48, v49
    s_nop 1
    v_max_f32 v48, v48, v49
    v_exp_f32 v49, -v48
    v_sub_f32 v72, v72, v48
    v_sub_f32 v73, v73, v48
    v_sub_f32 v74, v74, v48
    v_sub_f32 v75, v75, v48
    v_sub_f32 v76, v76, v48
    v_sub_f32 v77, v77, v48
    v_sub_f32 v78, v78, v48
    v_sub_f32 v79, v79, v48
    v_sub_f32 v104, v104, v48
    v_sub_f32 v105, v105, v48
    v_sub_f32 v106, v106, v48
    v_sub_f32 v107, v107, v48
    v_sub_f32 v108, v108, v48
    v_sub_f32 v109, v109, v48
    v_sub_f32 v110, v110, v48
    v_sub_f32 v111, v111, v48
    v_sub_f32 v168, v168, v48
    v_sub_f32 v169, v169, v48
    v_sub_f32 v170, v170, v48
    v_sub_f32 v171, v171, v48
    v_sub_f32 v172, v172, v48
    v_sub_f32 v173, v173, v48
    v_sub_f32 v174, v174, v48
    v_sub_f32 v175, v175, v48
    v_mul_f32 v13, v13, v49
    v_accvgpr_read_b32 v52, a32
    v_accvgpr_read_b32 v53, a33
    v_accvgpr_read_b32 v54, a34
    v_accvgpr_read_b32 v55, a35
    v_accvgpr_read_b32 v56, a36
    v_accvgpr_read_b32 v57, a37
    v_accvgpr_read_b32 v58, a38
    v_accvgpr_read_b32 v59, a39
    v_mul_f32 v52, v52, v49
    v_mul_f32 v53, v53, v49
    v_mul_f32 v54, v54, v49
    v_mul_f32 v55, v55, v49
    v_mul_f32 v56, v56, v49
    v_mul_f32 v57, v57, v49
    v_mul_f32 v58, v58, v49
    v_mul_f32 v59, v59, v49
    v_accvgpr_write_b32 a32, v52
    v_accvgpr_write_b32 a33, v53
    v_accvgpr_write_b32 a34, v54
    v_accvgpr_write_b32 a35, v55
    v_accvgpr_write_b32 a36, v56
    v_accvgpr_write_b32 a37, v57
    v_accvgpr_write_b32 a38, v58
    v_accvgpr_write_b32 a39, v59
    v_accvgpr_read_b32 v52, a40
    v_accvgpr_read_b32 v53, a41
    v_accvgpr_read_b32 v54, a42
    v_accvgpr_read_b32 v55, a43
    v_accvgpr_read_b32 v56, a44
    v_accvgpr_read_b32 v57, a45
    v_accvgpr_read_b32 v58, a46
    v_accvgpr_read_b32 v59, a47
    v_mul_f32 v52, v52, v49
    v_mul_f32 v53, v53, v49
    v_mul_f32 v54, v54, v49
    v_mul_f32 v55, v55, v49
    v_mul_f32 v56, v56, v49
    v_mul_f32 v57, v57, v49
    v_mul_f32 v58, v58, v49
    v_mul_f32 v59, v59, v49
    v_accvgpr_write_b32 a40, v52
    v_accvgpr_write_b32 a41, v53
    v_accvgpr_write_b32 a42, v54
    v_accvgpr_write_b32 a43, v55
    v_accvgpr_write_b32 a44, v56
    v_accvgpr_write_b32 a45, v57
    v_accvgpr_write_b32 a46, v58
    v_accvgpr_write_b32 a47, v59
    v_accvgpr_read_b32 v52, a48
    v_accvgpr_read_b32 v53, a49
    v_accvgpr_read_b32 v54, a50
    v_accvgpr_read_b32 v55, a51
    v_accvgpr_read_b32 v56, a52
    v_accvgpr_read_b32 v57, a53
    v_accvgpr_read_b32 v58, a54
    v_accvgpr_read_b32 v59, a55
    v_mul_f32 v52, v52, v49
    v_mul_f32 v53, v53, v49
    v_mul_f32 v54, v54, v49
    v_mul_f32 v55, v55, v49
    v_mul_f32 v56, v56, v49
    v_mul_f32 v57, v57, v49
    v_mul_f32 v58, v58, v49
    v_mul_f32 v59, v59, v49
    v_accvgpr_write_b32 a48, v52
    v_accvgpr_write_b32 a49, v53
    v_accvgpr_write_b32 a50, v54
    v_accvgpr_write_b32 a51, v55
    v_accvgpr_write_b32 a52, v56
    v_accvgpr_write_b32 a53, v57
    v_accvgpr_write_b32 a54, v58
    v_accvgpr_write_b32 a55, v59
    v_accvgpr_read_b32 v52, a56
    v_accvgpr_read_b32 v53, a57
    v_accvgpr_read_b32 v54, a58
    v_accvgpr_read_b32 v55, a59
    v_accvgpr_read_b32 v56, a60
    v_accvgpr_read_b32 v57, a61
    v_accvgpr_read_b32 v58, a62
    v_accvgpr_read_b32 v59, a63
    v_mul_f32 v52, v52, v49
    v_mul_f32 v53, v53, v49
    v_mul_f32 v54, v54, v49
    v_mul_f32 v55, v55, v49
    v_mul_f32 v56, v56, v49
    v_mul_f32 v57, v57, v49
    v_mul_f32 v58, v58, v49
    v_mul_f32 v59, v59, v49
    v_accvgpr_write_b32 a56, v52
    v_accvgpr_write_b32 a57, v53
    v_accvgpr_write_b32 a58, v54
    v_accvgpr_write_b32 a59, v55
    v_accvgpr_write_b32 a60, v56
    v_accvgpr_write_b32 a61, v57
    v_accvgpr_write_b32 a62, v58
    v_accvgpr_write_b32 a63, v59
    v_exp_f32 v52, v72
    v_exp_f32 v53, v73
    v_exp_f32 v54, v74
    v_exp_f32 v55, v75
    v_exp_f32 v56, v76
    v_exp_f32 v57, v77
    v_exp_f32 v58, v78
    v_exp_f32 v59, v79
    s_nop 0
    v_cvt_pk_bf16_f32 v132, v52, v53
    v_cvt_pk_bf16_f32 v133, v54, v55
    v_cvt_pk_bf16_f32 v134, v56, v57
    v_cvt_pk_bf16_f32 v135, v58, v59
    s_nop 1
    v_mfma_f32_16x16x32_bf16 v[32:35], v[44:47], v[132:135], 0
    v_max3_f32 v48, v80, v81, v82
    v_max3_f32 v48, v48, v83, v84
    v_max3_f32 v48, v48, v85, v86
    v_max3_f32 v48, v48, v87, 0
    v_mov_b32 v49, v48
    s_nop 1
    v_permlane32_swap_b32 v48, v49
    s_nop 1
    v_max_f32 v48, v48, v49
    v_mov_b32 v49, v48
    s_nop 1
    v_permlane16_swap_b32 v48, v49
    s_nop 1
    v_max_f32 v48, v48, v49
    v_exp_f32 v49, -v48
    v_sub_f32 v80, v80, v48
    v_sub_f32 v81, v81, v48
    v_sub_f32 v82, v82, v48
    v_sub_f32 v83, v83, v48
    v_sub_f32 v84, v84, v48
    v_sub_f32 v85, v85, v48
    v_sub_f32 v86, v86, v48
    v_sub_f32 v87, v87, v48
    v_sub_f32 v112, v112, v48
    v_sub_f32 v113, v113, v48
    v_sub_f32 v114, v114, v48
    v_sub_f32 v115, v115, v48
    v_sub_f32 v116, v116, v48
    v_sub_f32 v117, v117, v48
    v_sub_f32 v118, v118, v48
    v_sub_f32 v119, v119, v48
    v_sub_f32 v176, v176, v48
    v_sub_f32 v177, v177, v48
    v_sub_f32 v178, v178, v48
    v_sub_f32 v179, v179, v48
    v_sub_f32 v180, v180, v48
    v_sub_f32 v181, v181, v48
    v_sub_f32 v182, v182, v48
    v_sub_f32 v183, v183, v48
    v_mul_f32 v14, v14, v49
    v_accvgpr_read_b32 v52, a64
    v_accvgpr_read_b32 v53, a65
    v_accvgpr_read_b32 v54, a66
    v_accvgpr_read_b32 v55, a67
    v_accvgpr_read_b32 v56, a68
    v_accvgpr_read_b32 v57, a69
    v_accvgpr_read_b32 v58, a70
    v_accvgpr_read_b32 v59, a71
    v_mul_f32 v52, v52, v49
    v_mul_f32 v53, v53, v49
    v_mul_f32 v54, v54, v49
    v_mul_f32 v55, v55, v49
    v_mul_f32 v56, v56, v49
    v_mul_f32 v57, v57, v49
    v_mul_f32 v58, v58, v49
    v_mul_f32 v59, v59, v49
    v_accvgpr_write_b32 a64, v52
    v_accvgpr_write_b32 a65, v53
    v_accvgpr_write_b32 a66, v54
    v_accvgpr_write_b32 a67, v55
    v_accvgpr_write_b32 a68, v56
    v_accvgpr_write_b32 a69, v57
    v_accvgpr_write_b32 a70, v58
    v_accvgpr_write_b32 a71, v59
    v_accvgpr_read_b32 v52, a72
    v_accvgpr_read_b32 v53, a73
    v_accvgpr_read_b32 v54, a74
    v_accvgpr_read_b32 v55, a75
    v_accvgpr_read_b32 v56, a76
    v_accvgpr_read_b32 v57, a77
    v_accvgpr_read_b32 v58, a78
    v_accvgpr_read_b32 v59, a79
    v_mul_f32 v52, v52, v49
    v_mul_f32 v53, v53, v49
    v_mul_f32 v54, v54, v49
    v_mul_f32 v55, v55, v49
    v_mul_f32 v56, v56, v49
    v_mul_f32 v57, v57, v49
    v_mul_f32 v58, v58, v49
    v_mul_f32 v59, v59, v49
    v_accvgpr_write_b32 a72, v52
    v_accvgpr_write_b32 a73, v53
    v_accvgpr_write_b32 a74, v54
    v_accvgpr_write_b32 a75, v55
    v_accvgpr_write_b32 a76, v56
    v_accvgpr_write_b32 a77, v57
    v_accvgpr_write_b32 a78, v58
    v_accvgpr_write_b32 a79, v59
    v_accvgpr_read_b32 v52, a80
    v_accvgpr_read_b32 v53, a81
    v_accvgpr_read_b32 v54, a82
    v_accvgpr_read_b32 v55, a83
    v_accvgpr_read_b32 v56, a84
    v_accvgpr_read_b32 v57, a85
    v_accvgpr_read_b32 v58, a86
    v_accvgpr_read_b32 v59, a87
    v_mul_f32 v52, v52, v49
    v_mul_f32 v53, v53, v49
    v_mul_f32 v54, v54, v49
    v_mul_f32 v55, v55, v49
    v_mul_f32 v56, v56, v49
    v_mul_f32 v57, v57, v49
    v_mul_f32 v58, v58, v49
    v_mul_f32 v59, v59, v49
    v_accvgpr_write_b32 a80, v52
    v_accvgpr_write_b32 a81, v53
    v_accvgpr_write_b32 a82, v54
    v_accvgpr_write_b32 a83, v55
    v_accvgpr_write_b32 a84, v56
    v_accvgpr_write_b32 a85, v57
    v_accvgpr_write_b32 a86, v58
    v_accvgpr_write_b32 a87, v59
    v_accvgpr_read_b32 v52, a88
    v_accvgpr_read_b32 v53, a89
    v_accvgpr_read_b32 v54, a90
    v_accvgpr_read_b32 v55, a91
    v_accvgpr_read_b32 v56, a92
    v_accvgpr_read_b32 v57, a93
    v_accvgpr_read_b32 v58, a94
    v_accvgpr_read_b32 v59, a95
    v_mul_f32 v52, v52, v49
    v_mul_f32 v53, v53, v49
    v_mul_f32 v54, v54, v49
    v_mul_f32 v55, v55, v49
    v_mul_f32 v56, v56, v49
    v_mul_f32 v57, v57, v49
    v_mul_f32 v58, v58, v49
    v_mul_f32 v59, v59, v49
    v_accvgpr_write_b32 a88, v52
    v_accvgpr_write_b32 a89, v53
    v_accvgpr_write_b32 a90, v54
    v_accvgpr_write_b32 a91, v55
    v_accvgpr_write_b32 a92, v56
    v_accvgpr_write_b32 a93, v57
    v_accvgpr_write_b32 a94, v58
    v_accvgpr_write_b32 a95, v59
    v_exp_f32 v52, v80
    v_exp_f32 v53, v81
    v_exp_f32 v54, v82
    v_exp_f32 v55, v83
    v_exp_f32 v56, v84
    v_exp_f32 v57, v85
    v_exp_f32 v58, v86
    v_exp_f32 v59, v87
    s_nop 0
    v_cvt_pk_bf16_f32 v136, v52, v53
    v_cvt_pk_bf16_f32 v137, v54, v55
    v_cvt_pk_bf16_f32 v138, v56, v57
    v_cvt_pk_bf16_f32 v139, v58, v59
    s_nop 1
    v_mfma_f32_16x16x32_bf16 v[36:39], v[44:47], v[136:139], 0
    v_max3_f32 v48, v88, v89, v90
    v_max3_f32 v48, v48, v91, v92
    v_max3_f32 v48, v48, v93, v94
    v_max3_f32 v48, v48, v95, 0
    v_mov_b32 v49, v48
    s_nop 1
    v_permlane32_swap_b32 v48, v49
    s_nop 1
    v_max_f32 v48, v48, v49
    v_mov_b32 v49, v48
    s_nop 1
    v_permlane16_swap_b32 v48, v49
    s_nop 1
    v_max_f32 v48, v48, v49
    v_exp_f32 v49, -v48
    v_sub_f32 v88, v88, v48
    v_sub_f32 v89, v89, v48
    v_sub_f32 v90, v90, v48
    v_sub_f32 v91, v91, v48
    v_sub_f32 v92, v92, v48
    v_sub_f32 v93, v93, v48
    v_sub_f32 v94, v94, v48
    v_sub_f32 v95, v95, v48
    v_sub_f32 v120, v120, v48
    v_sub_f32 v121, v121, v48
    v_sub_f32 v122, v122, v48
    v_sub_f32 v123, v123, v48
    v_sub_f32 v124, v124, v48
    v_sub_f32 v125, v125, v48
    v_sub_f32 v126, v126, v48
    v_sub_f32 v127, v127, v48
    v_sub_f32 v184, v184, v48
    v_sub_f32 v185, v185, v48
    v_sub_f32 v186, v186, v48
    v_sub_f32 v187, v187, v48
    v_sub_f32 v188, v188, v48
    v_sub_f32 v189, v189, v48
    v_sub_f32 v190, v190, v48
    v_sub_f32 v191, v191, v48
    v_mul_f32 v15, v15, v49
    v_accvgpr_read_b32 v52, a96
    v_accvgpr_read_b32 v53, a97
    v_accvgpr_read_b32 v54, a98
    v_accvgpr_read_b32 v55, a99
    v_accvgpr_read_b32 v56, a100
    v_accvgpr_read_b32 v57, a101
    v_accvgpr_read_b32 v58, a102
    v_accvgpr_read_b32 v59, a103
    v_mul_f32 v52, v52, v49
    v_mul_f32 v53, v53, v49
    v_mul_f32 v54, v54, v49
    v_mul_f32 v55, v55, v49
    v_mul_f32 v56, v56, v49
    v_mul_f32 v57, v57, v49
    v_mul_f32 v58, v58, v49
    v_mul_f32 v59, v59, v49
    v_accvgpr_write_b32 a96, v52
    v_accvgpr_write_b32 a97, v53
    v_accvgpr_write_b32 a98, v54
    v_accvgpr_write_b32 a99, v55
    v_accvgpr_write_b32 a100, v56
    v_accvgpr_write_b32 a101, v57
    v_accvgpr_write_b32 a102, v58
    v_accvgpr_write_b32 a103, v59
    v_accvgpr_read_b32 v52, a104
    v_accvgpr_read_b32 v53, a105
    v_accvgpr_read_b32 v54, a106
    v_accvgpr_read_b32 v55, a107
    v_accvgpr_read_b32 v56, a108
    v_accvgpr_read_b32 v57, a109
    v_accvgpr_read_b32 v58, a110
    v_accvgpr_read_b32 v59, a111
    v_mul_f32 v52, v52, v49
    v_mul_f32 v53, v53, v49
    v_mul_f32 v54, v54, v49
    v_mul_f32 v55, v55, v49
    v_mul_f32 v56, v56, v49
    v_mul_f32 v57, v57, v49
    v_mul_f32 v58, v58, v49
    v_mul_f32 v59, v59, v49
    v_accvgpr_write_b32 a104, v52
    v_accvgpr_write_b32 a105, v53
    v_accvgpr_write_b32 a106, v54
    v_accvgpr_write_b32 a107, v55
    v_accvgpr_write_b32 a108, v56
    v_accvgpr_write_b32 a109, v57
    v_accvgpr_write_b32 a110, v58
    v_accvgpr_write_b32 a111, v59
    v_accvgpr_read_b32 v52, a112
    v_accvgpr_read_b32 v53, a113
    v_accvgpr_read_b32 v54, a114
    v_accvgpr_read_b32 v55, a115
    v_accvgpr_read_b32 v56, a116
    v_accvgpr_read_b32 v57, a117
    v_accvgpr_read_b32 v58, a118
    v_accvgpr_read_b32 v59, a119
    v_mul_f32 v52, v52, v49
    v_mul_f32 v53, v53, v49
    v_mul_f32 v54, v54, v49
    v_mul_f32 v55, v55, v49
    v_mul_f32 v56, v56, v49
    v_mul_f32 v57, v57, v49
    v_mul_f32 v58, v58, v49
    v_mul_f32 v59, v59, v49
    v_accvgpr_write_b32 a112, v52
    v_accvgpr_write_b32 a113, v53
    v_accvgpr_write_b32 a114, v54
    v_accvgpr_write_b32 a115, v55
    v_accvgpr_write_b32 a116, v56
    v_accvgpr_write_b32 a117, v57
    v_accvgpr_write_b32 a118, v58
    v_accvgpr_write_b32 a119, v59
    v_accvgpr_read_b32 v52, a120
    v_accvgpr_read_b32 v53, a121
    v_accvgpr_read_b32 v54, a122
    v_accvgpr_read_b32 v55, a123
    v_accvgpr_read_b32 v56, a124
    v_accvgpr_read_b32 v57, a125
    v_accvgpr_read_b32 v58, a126
    v_accvgpr_read_b32 v59, a127
    v_mul_f32 v52, v52, v49
    v_mul_f32 v53, v53, v49
    v_mul_f32 v54, v54, v49
    v_mul_f32 v55, v55, v49
    v_mul_f32 v56, v56, v49
    v_mul_f32 v57, v57, v49
    v_mul_f32 v58, v58, v49
    v_mul_f32 v59, v59, v49
    v_accvgpr_write_b32 a120, v52
    v_accvgpr_write_b32 a121, v53
    v_accvgpr_write_b32 a122, v54
    v_accvgpr_write_b32 a123, v55
    v_accvgpr_write_b32 a124, v56
    v_accvgpr_write_b32 a125, v57
    v_accvgpr_write_b32 a126, v58
    v_accvgpr_write_b32 a127, v59
    v_exp_f32 v52, v88
    v_exp_f32 v53, v89
    v_exp_f32 v54, v90
    v_exp_f32 v55, v91
    v_exp_f32 v56, v92
    v_exp_f32 v57, v93
    v_exp_f32 v58, v94
    v_exp_f32 v59, v95
    s_nop 0
    v_cvt_pk_bf16_f32 v140, v52, v53
    v_cvt_pk_bf16_f32 v141, v54, v55
    v_cvt_pk_bf16_f32 v142, v56, v57
    v_cvt_pk_bf16_f32 v143, v58, v59
    s_nop 1
    v_mfma_f32_16x16x32_bf16 v[40:43], v[44:47], v[140:143], 0
    s_nop 7
    s_setpc_b64 s[74:75]
m_rs1289:
    s_nop 15
    v_max3_f32 v48, v96, v97, v98
    v_max3_f32 v48, v48, v99, v100
    v_max3_f32 v48, v48, v101, v102
    v_max3_f32 v48, v48, v103, 0
    v_mov_b32 v49, v48
    s_nop 1
    v_permlane32_swap_b32 v48, v49
    s_nop 1
    v_max_f32 v48, v48, v49
    v_mov_b32 v49, v48
    s_nop 1
    v_permlane16_swap_b32 v48, v49
    s_nop 1
    v_max_f32 v48, v48, v49
    v_exp_f32 v49, -v48
    v_sub_f32 v96, v96, v48
    v_sub_f32 v97, v97, v48
    v_sub_f32 v98, v98, v48
    v_sub_f32 v99, v99, v48
    v_sub_f32 v100, v100, v48
    v_sub_f32 v101, v101, v48
    v_sub_f32 v102, v102, v48
    v_sub_f32 v103, v103, v48
    v_sub_f32 v64, v64, v48
    v_sub_f32 v65, v65, v48
    v_sub_f32 v66, v66, v48
    v_sub_f32 v67, v67, v48
    v_sub_f32 v68, v68, v48
    v_sub_f32 v69, v69, v48
    v_sub_f32 v70, v70, v48
    v_sub_f32 v71, v71, v48
    v_sub_f32 v160, v160, v48
    v_sub_f32 v161, v161, v48
    v_sub_f32 v162, v162, v48
    v_sub_f32 v163, v163, v48
    v_sub_f32 v164, v164, v48
    v_sub_f32 v165, v165, v48
    v_sub_f32 v166, v166, v48
    v_sub_f32 v167, v167, v48
    v_mul_f32 v12, v12, v49
    v_accvgpr_read_b32 v52, a0
    v_accvgpr_read_b32 v53, a1
    v_accvgpr_read_b32 v54, a2
    v_accvgpr_read_b32 v55, a3
    v_accvgpr_read_b32 v56, a4
    v_accvgpr_read_b32 v57, a5
    v_accvgpr_read_b32 v58, a6
    v_accvgpr_read_b32 v59, a7
    v_mul_f32 v52, v52, v49
    v_mul_f32 v53, v53, v49
    v_mul_f32 v54, v54, v49
    v_mul_f32 v55, v55, v49
    v_mul_f32 v56, v56, v49
    v_mul_f32 v57, v57, v49
    v_mul_f32 v58, v58, v49
    v_mul_f32 v59, v59, v49
    v_accvgpr_write_b32 a0, v52
    v_accvgpr_write_b32 a1, v53
    v_accvgpr_write_b32 a2, v54
    v_accvgpr_write_b32 a3, v55
    v_accvgpr_write_b32 a4, v56
    v_accvgpr_write_b32 a5, v57
    v_accvgpr_write_b32 a6, v58
    v_accvgpr_write_b32 a7, v59
    v_accvgpr_read_b32 v52, a8
    v_accvgpr_read_b32 v53, a9
    v_accvgpr_read_b32 v54, a10
    v_accvgpr_read_b32 v55, a11
    v_accvgpr_read_b32 v56, a12
    v_accvgpr_read_b32 v57, a13
    v_accvgpr_read_b32 v58, a14
    v_accvgpr_read_b32 v59, a15
    v_mul_f32 v52, v52, v49
    v_mul_f32 v53, v53, v49
    v_mul_f32 v54, v54, v49
    v_mul_f32 v55, v55, v49
    v_mul_f32 v56, v56, v49
    v_mul_f32 v57, v57, v49
    v_mul_f32 v58, v58, v49
    v_mul_f32 v59, v59, v49
    v_accvgpr_write_b32 a8, v52
    v_accvgpr_write_b32 a9, v53
    v_accvgpr_write_b32 a10, v54
    v_accvgpr_write_b32 a11, v55
    v_accvgpr_write_b32 a12, v56
    v_accvgpr_write_b32 a13, v57
    v_accvgpr_write_b32 a14, v58
    v_accvgpr_write_b32 a15, v59
    v_accvgpr_read_b32 v52, a16
    v_accvgpr_read_b32 v53, a17
    v_accvgpr_read_b32 v54, a18
    v_accvgpr_read_b32 v55, a19
    v_accvgpr_read_b32 v56, a20
    v_accvgpr_read_b32 v57, a21
    v_accvgpr_read_b32 v58, a22
    v_accvgpr_read_b32 v59, a23
    v_mul_f32 v52, v52, v49
    v_mul_f32 v53, v53, v49
    v_mul_f32 v54, v54, v49
    v_mul_f32 v55, v55, v49
    v_mul_f32 v56, v56, v49
    v_mul_f32 v57, v57, v49
    v_mul_f32 v58, v58, v49
    v_mul_f32 v59, v59, v49
    v_accvgpr_write_b32 a16, v52
    v_accvgpr_write_b32 a17, v53
    v_accvgpr_write_b32 a18, v54
    v_accvgpr_write_b32 a19, v55
    v_accvgpr_write_b32 a20, v56
    v_accvgpr_write_b32 a21, v57
    v_accvgpr_write_b32 a22, v58
    v_accvgpr_write_b32 a23, v59
    v_accvgpr_read_b32 v52, a24
    v_accvgpr_read_b32 v53, a25
    v_accvgpr_read_b32 v54, a26
    v_accvgpr_read_b32 v55, a27
    v_accvgpr_read_b32 v56, a28
    v_accvgpr_read_b32 v57, a29
    v_accvgpr_read_b32 v58, a30
    v_accvgpr_read_b32 v59, a31
    v_mul_f32 v52, v52, v49
    v_mul_f32 v53, v53, v49
    v_mul_f32 v54, v54, v49
    v_mul_f32 v55, v55, v49
    v_mul_f32 v56, v56, v49
    v_mul_f32 v57, v57, v49
    v_mul_f32 v58, v58, v49
    v_mul_f32 v59, v59, v49
    v_accvgpr_write_b32 a24, v52
    v_accvgpr_write_b32 a25, v53
    v_accvgpr_write_b32 a26, v54
    v_accvgpr_write_b32 a27, v55
    v_accvgpr_write_b32 a28, v56
    v_accvgpr_write_b32 a29, v57
    v_accvgpr_write_b32 a30, v58
    v_accvgpr_write_b32 a31, v59
    v_exp_f32 v52, v96
    v_exp_f32 v53, v97
    v_exp_f32 v54, v98
    v_exp_f32 v55, v99
    v_exp_f32 v56, v100
    v_exp_f32 v57, v101
    v_exp_f32 v58, v102
    v_exp_f32 v59, v103
    s_nop 0
    v_cvt_pk_bf16_f32 v144, v52, v53
    v_cvt_pk_bf16_f32 v145, v54, v55
    v_cvt_pk_bf16_f32 v146, v56, v57
    v_cvt_pk_bf16_f32 v147, v58, v59
    s_nop 1
    v_mfma_f32_16x16x32_bf16 v[28:31], v[44:47], v[144:147], 0
    v_max3_f32 v48, v104, v105, v106
    v_max3_f32 v48, v48, v107, v108
    v_max3_f32 v48, v48, v109, v110
    v_max3_f32 v48, v48, v111, 0
    v_mov_b32 v49, v48
    s_nop 1
    v_permlane32_swap_b32 v48, v49
    s_nop 1
    v_max_f32 v48, v48, v49
    v_mov_b32 v49, v48
    s_nop 1
    v_permlane16_swap_b32 v48, v49
    s_nop 1
    v_max_f32 v48, v48, v49
    v_exp_f32 v49, -v48
    v_sub_f32 v104, v104, v48
    v_sub_f32 v105, v105, v48
    v_sub_f32 v106, v106, v48
    v_sub_f32 v107, v107, v48
    v_sub_f32 v108, v108, v48
    v_sub_f32 v109, v109, v48
    v_sub_f32 v110, v110, v48
    v_sub_f32 v111, v111, v48
    v_sub_f32 v72, v72, v48
    v_sub_f32 v73, v73, v48
    v_sub_f32 v74, v74, v48
    v_sub_f32 v75, v75, v48
    v_sub_f32 v76, v76, v48
    v_sub_f32 v77, v77, v48
    v_sub_f32 v78, v78, v48
    v_sub_f32 v79, v79, v48
    v_sub_f32 v168, v168, v48
    v_sub_f32 v169, v169, v48
    v_sub_f32 v170, v170, v48
    v_sub_f32 v171, v171, v48
    v_sub_f32 v172, v172, v48
    v_sub_f32 v173, v173, v48
    v_sub_f32 v174, v174, v48
    v_sub_f32 v175, v175, v48
    v_mul_f32 v13, v13, v49
    v_accvgpr_read_b32 v52, a32
    v_accvgpr_read_b32 v53, a33
    v_accvgpr_read_b32 v54, a34
    v_accvgpr_read_b32 v55, a35
    v_accvgpr_read_b32 v56, a36
    v_accvgpr_read_b32 v57, a37
    v_accvgpr_read_b32 v58, a38
    v_accvgpr_read_b32 v59, a39
    v_mul_f32 v52, v52, v49
    v_mul_f32 v53, v53, v49
    v_mul_f32 v54, v54, v49
    v_mul_f32 v55, v55, v49
    v_mul_f32 v56, v56, v49
    v_mul_f32 v57, v57, v49
    v_mul_f32 v58, v58, v49
    v_mul_f32 v59, v59, v49
    v_accvgpr_write_b32 a32, v52
    v_accvgpr_write_b32 a33, v53
    v_accvgpr_write_b32 a34, v54
    v_accvgpr_write_b32 a35, v55
    v_accvgpr_write_b32 a36, v56
    v_accvgpr_write_b32 a37, v57
    v_accvgpr_write_b32 a38, v58
    v_accvgpr_write_b32 a39, v59
    v_accvgpr_read_b32 v52, a40
    v_accvgpr_read_b32 v53, a41
    v_accvgpr_read_b32 v54, a42
    v_accvgpr_read_b32 v55, a43
    v_accvgpr_read_b32 v56, a44
    v_accvgpr_read_b32 v57, a45
    v_accvgpr_read_b32 v58, a46
    v_accvgpr_read_b32 v59, a47
    v_mul_f32 v52, v52, v49
    v_mul_f32 v53, v53, v49
    v_mul_f32 v54, v54, v49
    v_mul_f32 v55, v55, v49
    v_mul_f32 v56, v56, v49
    v_mul_f32 v57, v57, v49
    v_mul_f32 v58, v58, v49
    v_mul_f32 v59, v59, v49
    v_accvgpr_write_b32 a40, v52
    v_accvgpr_write_b32 a41, v53
    v_accvgpr_write_b32 a42, v54
    v_accvgpr_write_b32 a43, v55
    v_accvgpr_write_b32 a44, v56
    v_accvgpr_write_b32 a45, v57
    v_accvgpr_write_b32 a46, v58
    v_accvgpr_write_b32 a47, v59
    v_accvgpr_read_b32 v52, a48
    v_accvgpr_read_b32 v53, a49
    v_accvgpr_read_b32 v54, a50
    v_accvgpr_read_b32 v55, a51
    v_accvgpr_read_b32 v56, a52
    v_accvgpr_read_b32 v57, a53
    v_accvgpr_read_b32 v58, a54
    v_accvgpr_read_b32 v59, a55
    v_mul_f32 v52, v52, v49
    v_mul_f32 v53, v53, v49
    v_mul_f32 v54, v54, v49
    v_mul_f32 v55, v55, v49
    v_mul_f32 v56, v56, v49
    v_mul_f32 v57, v57, v49
    v_mul_f32 v58, v58, v49
    v_mul_f32 v59, v59, v49
    v_accvgpr_write_b32 a48, v52
    v_accvgpr_write_b32 a49, v53
    v_accvgpr_write_b32 a50, v54
    v_accvgpr_write_b32 a51, v55
    v_accvgpr_write_b32 a52, v56
    v_accvgpr_write_b32 a53, v57
    v_accvgpr_write_b32 a54, v58
    v_accvgpr_write_b32 a55, v59
    v_accvgpr_read_b32 v52, a56
    v_accvgpr_read_b32 v53, a57
    v_accvgpr_read_b32 v54, a58
    v_accvgpr_read_b32 v55, a59
    v_accvgpr_read_b32 v56, a60
    v_accvgpr_read_b32 v57, a61
    v_accvgpr_read_b32 v58, a62
    v_accvgpr_read_b32 v59, a63
    v_mul_f32 v52, v52, v49
    v_mul_f32 v53, v53, v49
    v_mul_f32 v54, v54, v49
    v_mul_f32 v55, v55, v49
    v_mul_f32 v56, v56, v49
    v_mul_f32 v57, v57, v49
    v_mul_f32 v58, v58, v49
    v_mul_f32 v59, v59, v49
    v_accvgpr_write_b32 a56, v52
    v_accvgpr_write_b32 a57, v53
    v_accvgpr_write_b32 a58, v54
    v_accvgpr_write_b32 a59, v55
    v_accvgpr_write_b32 a60, v56
    v_accvgpr_write_b32 a61, v57
    v_accvgpr_write_b32 a62, v58
    v_accvgpr_write_b32 a63, v59
    v_exp_f32 v52, v104
    v_exp_f32 v53, v105
    v_exp_f32 v54, v106
    v_exp_f32 v55, v107
    v_exp_f32 v56, v108
    v_exp_f32 v57, v109
    v_exp_f32 v58, v110
    v_exp_f32 v59, v111
    s_nop 0
    v_cvt_pk_bf16_f32 v148, v52, v53
    v_cvt_pk_bf16_f32 v149, v54, v55
    v_cvt_pk_bf16_f32 v150, v56, v57
    v_cvt_pk_bf16_f32 v151, v58, v59
    s_nop 1
    v_mfma_f32_16x16x32_bf16 v[32:35], v[44:47], v[148:151], 0
    s_nop 7
    s_setpc_b64 s[74:75]
m_rs1490:
    s_nop 15
    v_max3_f32 v48, v96, v97, v98
    v_max3_f32 v48, v48, v99, v100
    v_max3_f32 v48, v48, v101, v102
    v_max3_f32 v48, v48, v103, 0
    v_mov_b32 v49, v48
    s_nop 1
    v_permlane32_swap_b32 v48, v49
    s_nop 1
    v_max_f32 v48, v48, v49
    v_mov_b32 v49, v48
    s_nop 1
    v_permlane16_swap_b32 v48, v49
    s_nop 1
    v_max_f32 v48, v48, v49
    v_exp_f32 v49, -v48
    v_sub_f32 v96, v96, v48
    v_sub_f32 v97, v97, v48
    v_sub_f32 v98, v98, v48
    v_sub_f32 v99, v99, v48
    v_sub_f32 v100, v100, v48
    v_sub_f32 v101, v101, v48
    v_sub_f32 v102, v102, v48
    v_sub_f32 v103, v103, v48
    v_sub_f32 v64, v64, v48
    v_sub_f32 v65, v65, v48
    v_sub_f32 v66, v66, v48
    v_sub_f32 v67, v67, v48
    v_sub_f32 v68, v68, v48
    v_sub_f32 v69, v69, v48
    v_sub_f32 v70, v70, v48
    v_sub_f32 v71, v71, v48
    v_sub_f32 v160, v160, v48
    v_sub_f32 v161, v161, v48
    v_sub_f32 v162, v162, v48
    v_sub_f32 v163, v163, v48
    v_sub_f32 v164, v164, v48
    v_sub_f32 v165, v165, v48
    v_sub_f32 v166, v166, v48
    v_sub_f32 v167, v167, v48
    v_mul_f32 v12, v12, v49
    v_accvgpr_read_b32 v52, a0
    v_accvgpr_read_b32 v53, a1
    v_accvgpr_read_b32 v54, a2
    v_accvgpr_read_b32 v55, a3
    v_accvgpr_read_b32 v56, a4
    v_accvgpr_read_b32 v57, a5
    v_accvgpr_read_b32 v58, a6
    v_accvgpr_read_b32 v59, a7
    v_mul_f32 v52, v52, v49
    v_mul_f32 v53, v53, v49
    v_mul_f32 v54, v54, v49
    v_mul_f32 v55, v55, v49
    v_mul_f32 v56, v56, v49
    v_mul_f32 v57, v57, v49
    v_mul_f32 v58, v58, v49
    v_mul_f32 v59, v59, v49
    v_accvgpr_write_b32 a0, v52
    v_accvgpr_write_b32 a1, v53
    v_accvgpr_write_b32 a2, v54
    v_accvgpr_write_b32 a3, v55
    v_accvgpr_write_b32 a4, v56
    v_accvgpr_write_b32 a5, v57
    v_accvgpr_write_b32 a6, v58
    v_accvgpr_write_b32 a7, v59
    v_accvgpr_read_b32 v52, a8
    v_accvgpr_read_b32 v53, a9
    v_accvgpr_read_b32 v54, a10
    v_accvgpr_read_b32 v55, a11
    v_accvgpr_read_b32 v56, a12
    v_accvgpr_read_b32 v57, a13
    v_accvgpr_read_b32 v58, a14
    v_accvgpr_read_b32 v59, a15
    v_mul_f32 v52, v52, v49
    v_mul_f32 v53, v53, v49
    v_mul_f32 v54, v54, v49
    v_mul_f32 v55, v55, v49
    v_mul_f32 v56, v56, v49
    v_mul_f32 v57, v57, v49
    v_mul_f32 v58, v58, v49
    v_mul_f32 v59, v59, v49
    v_accvgpr_write_b32 a8, v52
    v_accvgpr_write_b32 a9, v53
    v_accvgpr_write_b32 a10, v54
    v_accvgpr_write_b32 a11, v55
    v_accvgpr_write_b32 a12, v56
    v_accvgpr_write_b32 a13, v57
    v_accvgpr_write_b32 a14, v58
    v_accvgpr_write_b32 a15, v59
    v_accvgpr_read_b32 v52, a16
    v_accvgpr_read_b32 v53, a17
    v_accvgpr_read_b32 v54, a18
    v_accvgpr_read_b32 v55, a19
    v_accvgpr_read_b32 v56, a20
    v_accvgpr_read_b32 v57, a21
    v_accvgpr_read_b32 v58, a22
    v_accvgpr_read_b32 v59, a23
    v_mul_f32 v52, v52, v49
    v_mul_f32 v53, v53, v49
    v_mul_f32 v54, v54, v49
    v_mul_f32 v55, v55, v49
    v_mul_f32 v56, v56, v49
    v_mul_f32 v57, v57, v49
    v_mul_f32 v58, v58, v49
    v_mul_f32 v59, v59, v49
    v_accvgpr_write_b32 a16, v52
    v_accvgpr_write_b32 a17, v53
    v_accvgpr_write_b32 a18, v54
    v_accvgpr_write_b32 a19, v55
    v_accvgpr_write_b32 a20, v56
    v_accvgpr_write_b32 a21, v57
    v_accvgpr_write_b32 a22, v58
    v_accvgpr_write_b32 a23, v59
    v_accvgpr_read_b32 v52, a24
    v_accvgpr_read_b32 v53, a25
    v_accvgpr_read_b32 v54, a26
    v_accvgpr_read_b32 v55, a27
    v_accvgpr_read_b32 v56, a28
    v_accvgpr_read_b32 v57, a29
    v_accvgpr_read_b32 v58, a30
    v_accvgpr_read_b32 v59, a31
    v_mul_f32 v52, v52, v49
    v_mul_f32 v53, v53, v49
    v_mul_f32 v54, v54, v49
    v_mul_f32 v55, v55, v49
    v_mul_f32 v56, v56, v49
    v_mul_f32 v57, v57, v49
    v_mul_f32 v58, v58, v49
    v_mul_f32 v59, v59, v49
    v_accvgpr_write_b32 a24, v52
    v_accvgpr_write_b32 a25, v53
    v_accvgpr_write_b32 a26, v54
    v_accvgpr_write_b32 a27, v55
    v_accvgpr_write_b32 a28, v56
    v_accvgpr_write_b32 a29, v57
    v_accvgpr_write_b32 a30, v58
    v_accvgpr_write_b32 a31, v59
    v_exp_f32 v52, v96
    v_exp_f32 v53, v97
    v_exp_f32 v54, v98
    v_exp_f32 v55, v99
    v_exp_f32 v56, v100
    v_exp_f32 v57, v101
    v_exp_f32 v58, v102
    v_exp_f32 v59, v103
    s_nop 0
    v_cvt_pk_bf16_f32 v144, v52, v53
    v_cvt_pk_bf16_f32 v145, v54, v55
    v_cvt_pk_bf16_f32 v146, v56, v57
    v_cvt_pk_bf16_f32 v147, v58, v59
    s_nop 1
    v_mfma_f32_16x16x32_bf16 v[28:31], v[44:47], v[144:147], 0
    v_max3_f32 v48, v104, v105, v106
    v_max3_f32 v48, v48, v107, v108
    v_max3_f32 v48, v48, v109, v110
    v_max3_f32 v48, v48, v111, 0
    v_mov_b32 v49, v48
    s_nop 1
    v_permlane32_swap_b32 v48, v49
    s_nop 1
    v_max_f32 v48, v48, v49
    v_mov_b32 v49, v48
    s_nop 1
    v_permlane16_swap_b32 v48, v49
    s_nop 1
    v_max_f32 v48, v48, v49
    v_exp_f32 v49, -v48
    v_sub_f32 v104, v104, v48
    v_sub_f32 v105, v105, v48
    v_sub_f32 v106, v106, v48
    v_sub_f32 v107, v107, v48
    v_sub_f32 v108, v108, v48
    v_sub_f32 v109, v109, v48
    v_sub_f32 v110, v110, v48
    v_sub_f32 v111, v111, v48
    v_sub_f32 v72, v72, v48
    v_sub_f32 v73, v73, v48
    v_sub_f32 v74, v74, v48
    v_sub_f32 v75, v75, v48
    v_sub_f32 v76, v76, v48
    v_sub_f32 v77, v77, v48
    v_sub_f32 v78, v78, v48
    v_sub_f32 v79, v79, v48
    v_sub_f32 v168, v168, v48
    v_sub_f32 v169, v169, v48
    v_sub_f32 v170, v170, v48
    v_sub_f32 v171, v171, v48
    v_sub_f32 v172, v172, v48
    v_sub_f32 v173, v173, v48
    v_sub_f32 v174, v174, v48
    v_sub_f32 v175, v175, v48
    v_mul_f32 v13, v13, v49
    v_accvgpr_read_b32 v52, a32
    v_accvgpr_read_b32 v53, a33
    v_accvgpr_read_b32 v54, a34
    v_accvgpr_read_b32 v55, a35
    v_accvgpr_read_b32 v56, a36
    v_accvgpr_read_b32 v57, a37
    v_accvgpr_read_b32 v58, a38
    v_accvgpr_read_b32 v59, a39
    v_mul_f32 v52, v52, v49
    v_mul_f32 v53, v53, v49
    v_mul_f32 v54, v54, v49
    v_mul_f32 v55, v55, v49
    v_mul_f32 v56, v56, v49
    v_mul_f32 v57, v57, v49
    v_mul_f32 v58, v58, v49
    v_mul_f32 v59, v59, v49
    v_accvgpr_write_b32 a32, v52
    v_accvgpr_write_b32 a33, v53
    v_accvgpr_write_b32 a34, v54
    v_accvgpr_write_b32 a35, v55
    v_accvgpr_write_b32 a36, v56
    v_accvgpr_write_b32 a37, v57
    v_accvgpr_write_b32 a38, v58
    v_accvgpr_write_b32 a39, v59
    v_accvgpr_read_b32 v52, a40
    v_accvgpr_read_b32 v53, a41
    v_accvgpr_read_b32 v54, a42
    v_accvgpr_read_b32 v55, a43
    v_accvgpr_read_b32 v56, a44
    v_accvgpr_read_b32 v57, a45
    v_accvgpr_read_b32 v58, a46
    v_accvgpr_read_b32 v59, a47
    v_mul_f32 v52, v52, v49
    v_mul_f32 v53, v53, v49
    v_mul_f32 v54, v54, v49
    v_mul_f32 v55, v55, v49
    v_mul_f32 v56, v56, v49
    v_mul_f32 v57, v57, v49
    v_mul_f32 v58, v58, v49
    v_mul_f32 v59, v59, v49
    v_accvgpr_write_b32 a40, v52
    v_accvgpr_write_b32 a41, v53
    v_accvgpr_write_b32 a42, v54
    v_accvgpr_write_b32 a43, v55
    v_accvgpr_write_b32 a44, v56
    v_accvgpr_write_b32 a45, v57
    v_accvgpr_write_b32 a46, v58
    v_accvgpr_write_b32 a47, v59
    v_accvgpr_read_b32 v52, a48
    v_accvgpr_read_b32 v53, a49
    v_accvgpr_read_b32 v54, a50
    v_accvgpr_read_b32 v55, a51
    v_accvgpr_read_b32 v56, a52
    v_accvgpr_read_b32 v57, a53
    v_accvgpr_read_b32 v58, a54
    v_accvgpr_read_b32 v59, a55
    v_mul_f32 v52, v52, v49
    v_mul_f32 v53, v53, v49
    v_mul_f32 v54, v54, v49
    v_mul_f32 v55, v55, v49
    v_mul_f32 v56, v56, v49
    v_mul_f32 v57, v57, v49
    v_mul_f32 v58, v58, v49
    v_mul_f32 v59, v59, v49
    v_accvgpr_write_b32 a48, v52
    v_accvgpr_write_b32 a49, v53
    v_accvgpr_write_b32 a50, v54
    v_accvgpr_write_b32 a51, v55
    v_accvgpr_write_b32 a52, v56
    v_accvgpr_write_b32 a53, v57
    v_accvgpr_write_b32 a54, v58
    v_accvgpr_write_b32 a55, v59
    v_accvgpr_read_b32 v52, a56
    v_accvgpr_read_b32 v53, a57
    v_accvgpr_read_b32 v54, a58
    v_accvgpr_read_b32 v55, a59
    v_accvgpr_read_b32 v56, a60
    v_accvgpr_read_b32 v57, a61
    v_accvgpr_read_b32 v58, a62
    v_accvgpr_read_b32 v59, a63
    v_mul_f32 v52, v52, v49
    v_mul_f32 v53, v53, v49
    v_mul_f32 v54, v54, v49
    v_mul_f32 v55, v55, v49
    v_mul_f32 v56, v56, v49
    v_mul_f32 v57, v57, v49
    v_mul_f32 v58, v58, v49
    v_mul_f32 v59, v59, v49
    v_accvgpr_write_b32 a56, v52
    v_accvgpr_write_b32 a57, v53
    v_accvgpr_write_b32 a58, v54
    v_accvgpr_write_b32 a59, v55
    v_accvgpr_write_b32 a60, v56
    v_accvgpr_write_b32 a61, v57
    v_accvgpr_write_b32 a62, v58
    v_accvgpr_write_b32 a63, v59
    v_exp_f32 v52, v104
    v_exp_f32 v53, v105
    v_exp_f32 v54, v106
    v_exp_f32 v55, v107
    v_exp_f32 v56, v108
    v_exp_f32 v57, v109
    v_exp_f32 v58, v110
    v_exp_f32 v59, v111
    s_nop 0
    v_cvt_pk_bf16_f32 v148, v52, v53
    v_cvt_pk_bf16_f32 v149, v54, v55
    v_cvt_pk_bf16_f32 v150, v56, v57
    v_cvt_pk_bf16_f32 v151, v58, v59
    s_nop 1
    v_mfma_f32_16x16x32_bf16 v[32:35], v[44:47], v[148:151], 0
    v_max3_f32 v48, v112, v113, v114
    v_max3_f32 v48, v48, v115, v116
    v_max3_f32 v48, v48, v117, v118
    v_max3_f32 v48, v48, v119, 0
    v_mov_b32 v49, v48
    s_nop 1
    v_permlane32_swap_b32 v48, v49
    s_nop 1
    v_max_f32 v48, v48, v49
    v_mov_b32 v49, v48
    s_nop 1
    v_permlane16_swap_b32 v48, v49
    s_nop 1
    v_max_f32 v48, v48, v49
    v_exp_f32 v49, -v48
    v_sub_f32 v112, v112, v48
    v_sub_f32 v113, v113, v48
    v_sub_f32 v114, v114, v48
    v_sub_f32 v115, v115, v48
    v_sub_f32 v116, v116, v48
    v_sub_f32 v117, v117, v48
    v_sub_f32 v118, v118, v48
    v_sub_f32 v119, v119, v48
    v_sub_f32 v80, v80, v48
    v_sub_f32 v81, v81, v48
    v_sub_f32 v82, v82, v48
    v_sub_f32 v83, v83, v48
    v_sub_f32 v84, v84, v48
    v_sub_f32 v85, v85, v48
    v_sub_f32 v86, v86, v48
    v_sub_f32 v87, v87, v48
    v_sub_f32 v176, v176, v48
    v_sub_f32 v177, v177, v48
    v_sub_f32 v178, v178, v48
    v_sub_f32 v179, v179, v48
    v_sub_f32 v180, v180, v48
    v_sub_f32 v181, v181, v48
    v_sub_f32 v182, v182, v48
    v_sub_f32 v183, v183, v48
    v_mul_f32 v14, v14, v49
    v_accvgpr_read_b32 v52, a64
    v_accvgpr_read_b32 v53, a65
    v_accvgpr_read_b32 v54, a66
    v_accvgpr_read_b32 v55, a67
    v_accvgpr_read_b32 v56, a68
    v_accvgpr_read_b32 v57, a69
    v_accvgpr_read_b32 v58, a70
    v_accvgpr_read_b32 v59, a71
    v_mul_f32 v52, v52, v49
    v_mul_f32 v53, v53, v49
    v_mul_f32 v54, v54, v49
    v_mul_f32 v55, v55, v49
    v_mul_f32 v56, v56, v49
    v_mul_f32 v57, v57, v49
    v_mul_f32 v58, v58, v49
    v_mul_f32 v59, v59, v49
    v_accvgpr_write_b32 a64, v52
    v_accvgpr_write_b32 a65, v53
    v_accvgpr_write_b32 a66, v54
    v_accvgpr_write_b32 a67, v55
    v_accvgpr_write_b32 a68, v56
    v_accvgpr_write_b32 a69, v57
    v_accvgpr_write_b32 a70, v58
    v_accvgpr_write_b32 a71, v59
    v_accvgpr_read_b32 v52, a72
    v_accvgpr_read_b32 v53, a73
    v_accvgpr_read_b32 v54, a74
    v_accvgpr_read_b32 v55, a75
    v_accvgpr_read_b32 v56, a76
    v_accvgpr_read_b32 v57, a77
    v_accvgpr_read_b32 v58, a78
    v_accvgpr_read_b32 v59, a79
    v_mul_f32 v52, v52, v49
    v_mul_f32 v53, v53, v49
    v_mul_f32 v54, v54, v49
    v_mul_f32 v55, v55, v49
    v_mul_f32 v56, v56, v49
    v_mul_f32 v57, v57, v49
    v_mul_f32 v58, v58, v49
    v_mul_f32 v59, v59, v49
    v_accvgpr_write_b32 a72, v52
    v_accvgpr_write_b32 a73, v53
    v_accvgpr_write_b32 a74, v54
    v_accvgpr_write_b32 a75, v55
    v_accvgpr_write_b32 a76, v56
    v_accvgpr_write_b32 a77, v57
    v_accvgpr_write_b32 a78, v58
    v_accvgpr_write_b32 a79, v59
    v_accvgpr_read_b32 v52, a80
    v_accvgpr_read_b32 v53, a81
    v_accvgpr_read_b32 v54, a82
    v_accvgpr_read_b32 v55, a83
    v_accvgpr_read_b32 v56, a84
    v_accvgpr_read_b32 v57, a85
    v_accvgpr_read_b32 v58, a86
    v_accvgpr_read_b32 v59, a87
    v_mul_f32 v52, v52, v49
    v_mul_f32 v53, v53, v49
    v_mul_f32 v54, v54, v49
    v_mul_f32 v55, v55, v49
    v_mul_f32 v56, v56, v49
    v_mul_f32 v57, v57, v49
    v_mul_f32 v58, v58, v49
    v_mul_f32 v59, v59, v49
    v_accvgpr_write_b32 a80, v52
    v_accvgpr_write_b32 a81, v53
    v_accvgpr_write_b32 a82, v54
    v_accvgpr_write_b32 a83, v55
    v_accvgpr_write_b32 a84, v56
    v_accvgpr_write_b32 a85, v57
    v_accvgpr_write_b32 a86, v58
    v_accvgpr_write_b32 a87, v59
    v_accvgpr_read_b32 v52, a88
    v_accvgpr_read_b32 v53, a89
    v_accvgpr_read_b32 v54, a90
    v_accvgpr_read_b32 v55, a91
    v_accvgpr_read_b32 v56, a92
    v_accvgpr_read_b32 v57, a93
    v_accvgpr_read_b32 v58, a94
    v_accvgpr_read_b32 v59, a95
    v_mul_f32 v52, v52, v49
    v_mul_f32 v53, v53, v49
    v_mul_f32 v54, v54, v49
    v_mul_f32 v55, v55, v49
    v_mul_f32 v56, v56, v49
    v_mul_f32 v57, v57, v49
    v_mul_f32 v58, v58, v49
    v_mul_f32 v59, v59, v49
    v_accvgpr_write_b32 a88, v52
    v_accvgpr_write_b32 a89, v53
    v_accvgpr_write_b32 a90, v54
    v_accvgpr_write_b32 a91, v55
    v_accvgpr_write_b32 a92, v56
    v_accvgpr_write_b32 a93, v57
    v_accvgpr_write_b32 a94, v58
    v_accvgpr_write_b32 a95, v59
    v_exp_f32 v52, v112
    v_exp_f32 v53, v113
    v_exp_f32 v54, v114
    v_exp_f32 v55, v115
    v_exp_f32 v56, v116
    v_exp_f32 v57, v117
    v_exp_f32 v58, v118
    v_exp_f32 v59, v119
    s_nop 0
    v_cvt_pk_bf16_f32 v152, v52, v53
    v_cvt_pk_bf16_f32 v153, v54, v55
    v_cvt_pk_bf16_f32 v154, v56, v57
    v_cvt_pk_bf16_f32 v155, v58, v59
    s_nop 1
    v_mfma_f32_16x16x32_bf16 v[36:39], v[44:47], v[152:155], 0
    v_max3_f32 v48, v120, v121, v122
    v_max3_f32 v48, v48, v123, v124
    v_max3_f32 v48, v48, v125, v126
    v_max3_f32 v48, v48, v127, 0
    v_mov_b32 v49, v48
    s_nop 1
    v_permlane32_swap_b32 v48, v49
    s_nop 1
    v_max_f32 v48, v48, v49
    v_mov_b32 v49, v48
    s_nop 1
    v_permlane16_swap_b32 v48, v49
    s_nop 1
    v_max_f32 v48, v48, v49
    v_exp_f32 v49, -v48
    v_sub_f32 v120, v120, v48
    v_sub_f32 v121, v121, v48
    v_sub_f32 v122, v122, v48
    v_sub_f32 v123, v123, v48
    v_sub_f32 v124, v124, v48
    v_sub_f32 v125, v125, v48
    v_sub_f32 v126, v126, v48
    v_sub_f32 v127, v127, v48
    v_sub_f32 v88, v88, v48
    v_sub_f32 v89, v89, v48
    v_sub_f32 v90, v90, v48
    v_sub_f32 v91, v91, v48
    v_sub_f32 v92, v92, v48
    v_sub_f32 v93, v93, v48
    v_sub_f32 v94, v94, v48
    v_sub_f32 v95, v95, v48
    v_sub_f32 v184, v184, v48
    v_sub_f32 v185, v185, v48
    v_sub_f32 v186, v186, v48
    v_sub_f32 v187, v187, v48
    v_sub_f32 v188, v188, v48
    v_sub_f32 v189, v189, v48
    v_sub_f32 v190, v190, v48
    v_sub_f32 v191, v191, v48
    v_mul_f32 v15, v15, v49
    v_accvgpr_read_b32 v52, a96
    v_accvgpr_read_b32 v53, a97
    v_accvgpr_read_b32 v54, a98
    v_accvgpr_read_b32 v55, a99
    v_accvgpr_read_b32 v56, a100
    v_accvgpr_read_b32 v57, a101
    v_accvgpr_read_b32 v58, a102
    v_accvgpr_read_b32 v59, a103
    v_mul_f32 v52, v52, v49
    v_mul_f32 v53, v53, v49
    v_mul_f32 v54, v54, v49
    v_mul_f32 v55, v55, v49
    v_mul_f32 v56, v56, v49
    v_mul_f32 v57, v57, v49
    v_mul_f32 v58, v58, v49
    v_mul_f32 v59, v59, v49
    v_accvgpr_write_b32 a96, v52
    v_accvgpr_write_b32 a97, v53
    v_accvgpr_write_b32 a98, v54
    v_accvgpr_write_b32 a99, v55
    v_accvgpr_write_b32 a100, v56
    v_accvgpr_write_b32 a101, v57
    v_accvgpr_write_b32 a102, v58
    v_accvgpr_write_b32 a103, v59
    v_accvgpr_read_b32 v52, a104
    v_accvgpr_read_b32 v53, a105
    v_accvgpr_read_b32 v54, a106
    v_accvgpr_read_b32 v55, a107
    v_accvgpr_read_b32 v56, a108
    v_accvgpr_read_b32 v57, a109
    v_accvgpr_read_b32 v58, a110
    v_accvgpr_read_b32 v59, a111
    v_mul_f32 v52, v52, v49
    v_mul_f32 v53, v53, v49
    v_mul_f32 v54, v54, v49
    v_mul_f32 v55, v55, v49
    v_mul_f32 v56, v56, v49
    v_mul_f32 v57, v57, v49
    v_mul_f32 v58, v58, v49
    v_mul_f32 v59, v59, v49
    v_accvgpr_write_b32 a104, v52
    v_accvgpr_write_b32 a105, v53
    v_accvgpr_write_b32 a106, v54
    v_accvgpr_write_b32 a107, v55
    v_accvgpr_write_b32 a108, v56
    v_accvgpr_write_b32 a109, v57
    v_accvgpr_write_b32 a110, v58
    v_accvgpr_write_b32 a111, v59
    v_accvgpr_read_b32 v52, a112
    v_accvgpr_read_b32 v53, a113
    v_accvgpr_read_b32 v54, a114
    v_accvgpr_read_b32 v55, a115
    v_accvgpr_read_b32 v56, a116
    v_accvgpr_read_b32 v57, a117
    v_accvgpr_read_b32 v58, a118
    v_accvgpr_read_b32 v59, a119
    v_mul_f32 v52, v52, v49
    v_mul_f32 v53, v53, v49
    v_mul_f32 v54, v54, v49
    v_mul_f32 v55, v55, v49
    v_mul_f32 v56, v56, v49
    v_mul_f32 v57, v57, v49
    v_mul_f32 v58, v58, v49
    v_mul_f32 v59, v59, v49
    v_accvgpr_write_b32 a112, v52
    v_accvgpr_write_b32 a113, v53
    v_accvgpr_write_b32 a114, v54
    v_accvgpr_write_b32 a115, v55
    v_accvgpr_write_b32 a116, v56
    v_accvgpr_write_b32 a117, v57
    v_accvgpr_write_b32 a118, v58
    v_accvgpr_write_b32 a119, v59
    v_accvgpr_read_b32 v52, a120
    v_accvgpr_read_b32 v53, a121
    v_accvgpr_read_b32 v54, a122
    v_accvgpr_read_b32 v55, a123
    v_accvgpr_read_b32 v56, a124
    v_accvgpr_read_b32 v57, a125
    v_accvgpr_read_b32 v58, a126
    v_accvgpr_read_b32 v59, a127
    v_mul_f32 v52, v52, v49
    v_mul_f32 v53, v53, v49
    v_mul_f32 v54, v54, v49
    v_mul_f32 v55, v55, v49
    v_mul_f32 v56, v56, v49
    v_mul_f32 v57, v57, v49
    v_mul_f32 v58, v58, v49
    v_mul_f32 v59, v59, v49
    v_accvgpr_write_b32 a120, v52
    v_accvgpr_write_b32 a121, v53
    v_accvgpr_write_b32 a122, v54
    v_accvgpr_write_b32 a123, v55
    v_accvgpr_write_b32 a124, v56
    v_accvgpr_write_b32 a125, v57
    v_accvgpr_write_b32 a126, v58
    v_accvgpr_write_b32 a127, v59
    v_exp_f32 v52, v120
    v_exp_f32 v53, v121
    v_exp_f32 v54, v122
    v_exp_f32 v55, v123
    v_exp_f32 v56, v124
    v_exp_f32 v57, v125
    v_exp_f32 v58, v126
    v_exp_f32 v59, v127
    s_nop 0
    v_cvt_pk_bf16_f32 v156, v52, v53
    v_cvt_pk_bf16_f32 v157, v54, v55
    v_cvt_pk_bf16_f32 v158, v56, v57
    v_cvt_pk_bf16_f32 v159, v58, v59
    s_nop 1
    v_mfma_f32_16x16x32_bf16 v[40:43], v[44:47], v[156:159], 0
    s_nop 7
    s_setpc_b64 s[74:75]
m_hook18:
    s_cmp_lg_u32 s16, 0
    s_cbranch_scc1 m_np37
    v_mov_b32 v4, s4
    v_mov_b32 v5, s5
    s_add_u32 s90, s17, 117440512
    s_mov_b64 exec, 1
    buffer_store_dwordx2 v[4:5], off, s[8:11], s90 sc1
    s_mov_b64 exec, -1
m_np37:
    s_mov_b32 s17, -1
    s_branch m_hookr19
m_hook23:
    s_cmp_lg_u32 s16, 0
    s_cbranch_scc1 m_np38
    v_mov_b32 v4, s4
    v_mov_b32 v5, s5
    s_add_u32 s90, s17, 117440512
    s_mov_b64 exec, 1
    buffer_store_dwordx2 v[4:5], off, s[8:11], s90 sc1
    s_mov_b64 exec, -1
m_np38:
    s_mov_b32 s17, -1
    s_branch m_hookr24
m_pf7:
    s_mov_b32 s15, 0x20000
    s_sub_u32 s93, s2, 224
    s_lshl_b32 s93, s93, 2
    s_add_u32 s93, s93, s16
    v_lshlrev_b32 v24, 7, v1
    v_lshrrev_b32 v25, 3, v1
    v_lshlrev_b32 v25, 11, v25
    v_and_b32 v26, 7, v1
    v_lshl_add_u32 v25, v26, 7, v25
    s_lshl_b32 s92, s93, 13
    s_lshl_b32 s93, s93, 14
    s_add_u32 s93, s93, 1024
    s_mov_b32 s12, s26
    s_mov_b32 s13, s27
    s_mov_b32 s14, 6291456
    s_add_u32 s90, s92, 0
    buffer_load_dword v22, v24, s[12:15], s90 offen
    s_add_u32 s90, s92, 1048576
    buffer_load_dword v22, v24, s[12:15], s90 offen
    s_mov_b32 s12, s24
    s_mov_b32 s13, s25
    s_mov_b32 s14, 4194304
    s_add_u32 s90, s92, 0
    buffer_load_dword v22, v24, s[12:15], s90 offen
    s_add_u32 s90, s92, 1048576
    buffer_load_dword v22, v24, s[12:15], s90 offen
    s_add_u32 s90, s92, 2097152
    buffer_load_dword v22, v24, s[12:15], s90 offen
    s_add_u32 s90, s92, 3145728
    buffer_load_dword v22, v24, s[12:15], s90 offen
    s_mov_b32 s12, s34
    s_mov_b32 s13, s35
    s_mov_b32 s14, 8388608
    s_add_u32 s90, s92, 4194304
    buffer_load_dword v22, v24, s[12:15], s90 offen
    s_add_u32 s90, s92, 5242880
    buffer_load_dword v22, v24, s[12:15], s90 offen
    s_mov_b32 s12, s30
    s_mov_b32 s13, s31
    s_mov_b32 s14, 4194304
    s_add_u32 s90, s93, 0
    buffer_load_dword v22, v25, s[12:15], s90 offen
    s_add_u32 s90, s93, 2097152
    buffer_load_dword v22, v25, s[12:15], s90 offen
    s_mov_b32 s12, s26
    s_mov_b32 s13, s27
    s_mov_b32 s14, 6291456
    s_add_u32 s90, s92, 2097152
    buffer_load_dword v22, v24, s[12:15], s90 offen
    s_mov_b32 s12, s34
    s_mov_b32 s13, s35
    s_mov_b32 s14, 8388608
    s_add_u32 s90, s92, 6291456
    buffer_load_dword v22, v24, s[12:15], s90 offen
    s_add_u32 s90, s92, 7340032
    buffer_load_dword v22, v24, s[12:15], s90 offen
    s_mov_b32 s12, s26
    s_mov_b32 s13, s27
    s_mov_b32 s14, 6291456
    s_add_u32 s90, s92, 3145728
    buffer_load_dword v22, v24, s[12:15], s90 offen
    s_add_u32 s90, s92, 4194304
    buffer_load_dword v22, v24, s[12:15], s90 offen
    s_add_u32 s90, s92, 5242880
    buffer_load_dword v22, v24, s[12:15], s90 offen
    s_mov_b32 s12, s32
    s_mov_b32 s13, s33
    s_mov_b32 s14, 2097152
    s_add_u32 s90, s92, 1048576
    buffer_load_dword v22, v24, s[12:15], s90 offen
    s_add_u32 s61, s61, 32768
    s_branch m_nopf6
concat_heads__sliding_local_dilated__compressed_kv_cla__prompt_kernel_end:
.section .rodata,"a"
.p2align 6
.amdhsa_kernel concat_heads__sliding_local_dilated__compressed_kv_cla__prompt_kernel
  .amdhsa_next_free_vgpr 512
  .amdhsa_next_free_sgpr 102
  .amdhsa_accum_offset 256
  .amdhsa_group_segment_fixed_size 0
  .amdhsa_kernarg_size 96
  .amdhsa_user_sgpr_count 2
  .amdhsa_user_sgpr_kernarg_segment_ptr 1
  .amdhsa_system_sgpr_workgroup_id_x 1
.end_amdhsa_kernel
```
